```python
import torch

def _softmax(x, axis=-1):
    return torch.softmax(x, dim=axis)
def _gelu(x):
    return torch.nn.functional.gelu(x, approximate="tanh")
def _silu(x):
    return torch.nn.functional.silu(x)
def _sigmoid(x):
    return torch.sigmoid(x)
def _layernorm(x, axis=-1, eps=1e-5):
    m = x.mean(dim=axis, keepdim=True)
    v = x.var(dim=axis, keepdim=True, unbiased=False)
    return (x - m) / torch.sqrt(v + eps)
def _scatter_add(tgt, idx, src, axis=0):
    return tgt.clone().index_add_(axis, idx, src)
def _segment_sum(src, seg, n):
    out = torch.zeros((n,) + src.shape[1:], dtype=src.dtype)
    return out.index_add_(0, seg, src)
def _pad(x, pw):
    flat = tuple(v for pair in reversed(pw) for v in pair)
    return torch.nn.functional.pad(x, flat)

kernel_name = 'parallel_sum__linear_kernel_hedgehog__glu_gated_reglu__prompt'

def setup_inputs():

    _w = (lambda a: (lambda t: t.to(torch.bfloat16) if t.is_floating_point() else t)(torch.as_tensor(a)))
    def _A_setup():
        B, S, D, H = 1, 2048, 512, 32
        Dh = D // H
        return {
            "x": _w((lambda *s: torch.randn(*s, dtype=torch.bfloat16) * 0.05)(B, S, D)),
            "wqkv": _w((lambda *s: torch.randn(*s, dtype=torch.bfloat16) * 0.2)(D, 3 * D)),
            "w_phi": _w((lambda *s: torch.randn(*s, dtype=torch.bfloat16) * 0.2)(H, Dh, Dh) * (Dh ** -0.5)),
            "wo": _w((lambda *s: torch.randn(*s, dtype=torch.bfloat16) * 0.05)(D, D)),
        }
    _A_in = _A_setup()

    def _B_setup():
        B, S, D, F = 1, 2048, 512, 1792
        return {
            "x": _w((lambda *s: torch.randn(*s, dtype=torch.bfloat16) * 0.05)(B, S, D)),
            "W_gate": _w((lambda *s: torch.randn(*s, dtype=torch.bfloat16) * 0.4)(D, F) * (2.0 / D) ** 0.5),
            "W_up": _w((lambda *s: torch.randn(*s, dtype=torch.bfloat16) * 0.4)(D, F) * (2.0 / D) ** 0.5),
            "W_down": _w((lambda *s: torch.randn(*s, dtype=torch.bfloat16) * 0.4)(F, D) * (1.0 / F) ** 0.5),
        }
    _B_in = _B_setup()

    return {
        "A_x": _A_in["x"],
        "A_wqkv": _A_in["wqkv"],
        "A_w_phi": _A_in["w_phi"],
        "A_wo": _A_in["wo"],
        "B_x": _B_in["x"],
        "B_W_gate": _B_in["W_gate"],
        "B_W_up": _B_in["W_up"],
        "B_W_down": _B_in["W_down"],
    }

def reference(A_x, A_wqkv, A_w_phi, A_wo, B_x, B_W_gate, B_W_up, B_W_down):
    def _A_ref(x, wqkv, w_phi, wo):
        B, S, D = x.shape
        H = 32; Dh = D // H
        qkv = (lambda x, *d: x.permute(*d))((x @ wqkv).reshape(B, S, 3, H, Dh), 2, 0, 3, 1, 4)
        q, k, v = qkv[0], qkv[1], qkv[2]
        pq = torch.einsum("bhsd,hdf->bhsf", q, w_phi)
        pk = torch.einsum("bhsd,hdf->bhsf", k, w_phi)
        phi_q = torch.concatenate([_softmax(pq, axis=-1), _softmax(-pq, axis=-1)], axis=-1)
        phi_k = torch.concatenate([_softmax(pk, axis=-1), _softmax(-pk, axis=-1)], axis=-1)
        kv = torch.einsum("bhsf,bhsd->bhfd", phi_k, v)
        z  = torch.einsum("bhsf->bhf", phi_k)
        num = torch.einsum("bhqf,bhfd->bhqd", phi_q, kv)
        den = torch.einsum("bhqf,bhf->bhq", phi_q, z)[..., None] + 1e-6
        o = num / den
        return (lambda x, *d: x.permute(*d))(o, 0, 2, 1, 3).reshape(B, S, D) @ wo

    def _B_ref(x, W_gate, W_up, W_down):
        gate = torch.einsum("bsd,df->bsf", x, W_gate)
        up = torch.einsum("bsd,df->bsf", x, W_up)
        gate = gate * (lambda x, dt: x.to(dt))(gate > 0, gate.dtype)
        h = gate * up
        return torch.einsum("bsf,fd->bsd", h, W_down)

    x = A_x
    xn = _layernorm(x, axis=-1)
    return x + _A_ref(xn, A_wqkv, A_w_phi, A_wo) + _B_ref(xn, B_W_gate, B_W_up, B_W_down)
```

```asm
; @launch kernel=ln_kernel grid=(256,1,1) block=(256,1,1) lds=0
; @launch kernel=gemm1_kernel grid=(640,1,1) block=(256,1,1) lds=65536
; @launch kernel=gemm2_kernel grid=(256,1,1) block=(256,1,1) lds=98304
.amdgcn_target "amdgcn-amd-amdhsa--gfx950"
.text
.globl ln_kernel
.p2align 8
.type ln_kernel,@function
ln_kernel:
    s_cmp_ge_u32 s2, 256
    s_cbranch_scc1 LN_END
    s_load_dwordx2 s[4:5], s[0:1], 0
    s_load_dwordx2 s[6:7], s[0:1], 80
    s_waitcnt lgkmcnt(0)
    s_mov_b32 s8, s4
    s_mov_b32 s9, s5
    s_mov_b32 s10, 2097152
    s_mov_b32 s11, 0x00020000
    s_mov_b32 s12, s6
    s_mov_b32 s13, s7
    s_mov_b32 s14, 13701120
    s_mov_b32 s15, 0x00020000
    v_lshrrev_b32 v1, 6, v0
    v_and_b32 v2, 63, v0
    s_lshl_b32 s3, s2, 3
    v_lshlrev_b32 v1, 1, v1
    v_add_u32 v1, s3, v1
    v_lshlrev_b32 v1, 10, v1
    v_lshlrev_b32 v3, 4, v2
    v_add_u32 v1, v1, v3
    buffer_load_dwordx4 v[4:7], v1, s[8:11], 0 offen
    buffer_load_dwordx4 v[8:11], v1, s[8:11], 0 offen offset:1024
    v_xor_b32 v40, 1, v2
    v_lshlrev_b32 v40, 2, v40
    v_xor_b32 v41, 2, v2
    v_lshlrev_b32 v41, 2, v41
    v_xor_b32 v42, 4, v2
    v_lshlrev_b32 v42, 2, v42
    v_xor_b32 v43, 8, v2
    v_lshlrev_b32 v43, 2, v43
    v_xor_b32 v44, 16, v2
    v_lshlrev_b32 v44, 2, v44
    v_xor_b32 v45, 32, v2
    v_lshlrev_b32 v45, 2, v45
    v_mov_b32 v60, 0
    s_mul_i32 s16, s2, 272
    v_lshlrev_b32 v61, 2, v0
    v_add_u32 v61, s16, v61
    v_cmp_gt_u32 vcc, 68, v0
    s_and_saveexec_b64 s[18:19], vcc
    s_mov_b32 s17, 13631488
    buffer_store_dword v60, v61, s[12:15], s17 offen
    s_mov_b64 exec, s[18:19]
    s_waitcnt vmcnt(1)
    v_lshlrev_b32 v16, 16, v4
    v_and_b32 v17, 0xffff0000, v4
    v_lshlrev_b32 v18, 16, v5
    v_and_b32 v19, 0xffff0000, v5
    v_lshlrev_b32 v20, 16, v6
    v_and_b32 v21, 0xffff0000, v6
    v_lshlrev_b32 v22, 16, v7
    v_and_b32 v23, 0xffff0000, v7
    s_waitcnt vmcnt(1)
    v_lshlrev_b32 v24, 16, v8
    v_and_b32 v25, 0xffff0000, v8
    v_lshlrev_b32 v26, 16, v9
    v_and_b32 v27, 0xffff0000, v9
    v_lshlrev_b32 v28, 16, v10
    v_and_b32 v29, 0xffff0000, v10
    v_lshlrev_b32 v30, 16, v11
    v_and_b32 v31, 0xffff0000, v11
    v_add_f32 v32, v16, v17
    v_add_f32 v32, v32, v18
    v_add_f32 v32, v32, v19
    v_add_f32 v32, v32, v20
    v_add_f32 v32, v32, v21
    v_add_f32 v32, v32, v22
    v_add_f32 v32, v32, v23
    v_add_f32 v33, v24, v25
    v_add_f32 v33, v33, v26
    v_add_f32 v33, v33, v27
    v_add_f32 v33, v33, v28
    v_add_f32 v33, v33, v29
    v_add_f32 v33, v33, v30
    v_add_f32 v33, v33, v31
    ds_bpermute_b32 v50, v40, v32
    ds_bpermute_b32 v51, v40, v33
    s_waitcnt lgkmcnt(0)
    v_add_f32 v32, v32, v50
    v_add_f32 v33, v33, v51
    ds_bpermute_b32 v50, v41, v32
    ds_bpermute_b32 v51, v41, v33
    s_waitcnt lgkmcnt(0)
    v_add_f32 v32, v32, v50
    v_add_f32 v33, v33, v51
    ds_bpermute_b32 v50, v42, v32
    ds_bpermute_b32 v51, v42, v33
    s_waitcnt lgkmcnt(0)
    v_add_f32 v32, v32, v50
    v_add_f32 v33, v33, v51
    ds_bpermute_b32 v50, v43, v32
    ds_bpermute_b32 v51, v43, v33
    s_waitcnt lgkmcnt(0)
    v_add_f32 v32, v32, v50
    v_add_f32 v33, v33, v51
    ds_bpermute_b32 v50, v44, v32
    ds_bpermute_b32 v51, v44, v33
    s_waitcnt lgkmcnt(0)
    v_add_f32 v32, v32, v50
    v_add_f32 v33, v33, v51
    ds_bpermute_b32 v50, v45, v32
    ds_bpermute_b32 v51, v45, v33
    s_waitcnt lgkmcnt(0)
    v_add_f32 v32, v32, v50
    v_add_f32 v33, v33, v51
    s_mov_b32 s20, 0x3b000000
    v_mul_f32 v32, s20, v32
    v_mul_f32 v33, s20, v33
    v_mov_b32 v34, 0
    v_sub_f32 v52, v16, v32
    v_fmac_f32 v34, v52, v52
    v_sub_f32 v52, v17, v32
    v_fmac_f32 v34, v52, v52
    v_sub_f32 v52, v18, v32
    v_fmac_f32 v34, v52, v52
    v_sub_f32 v52, v19, v32
    v_fmac_f32 v34, v52, v52
    v_sub_f32 v52, v20, v32
    v_fmac_f32 v34, v52, v52
    v_sub_f32 v52, v21, v32
    v_fmac_f32 v34, v52, v52
    v_sub_f32 v52, v22, v32
    v_fmac_f32 v34, v52, v52
    v_sub_f32 v52, v23, v32
    v_fmac_f32 v34, v52, v52
    v_mov_b32 v35, 0
    v_sub_f32 v52, v24, v33
    v_fmac_f32 v35, v52, v52
    v_sub_f32 v52, v25, v33
    v_fmac_f32 v35, v52, v52
    v_sub_f32 v52, v26, v33
    v_fmac_f32 v35, v52, v52
    v_sub_f32 v52, v27, v33
    v_fmac_f32 v35, v52, v52
    v_sub_f32 v52, v28, v33
    v_fmac_f32 v35, v52, v52
    v_sub_f32 v52, v29, v33
    v_fmac_f32 v35, v52, v52
    v_sub_f32 v52, v30, v33
    v_fmac_f32 v35, v52, v52
    v_sub_f32 v52, v31, v33
    v_fmac_f32 v35, v52, v52
    ds_bpermute_b32 v50, v40, v34
    ds_bpermute_b32 v51, v40, v35
    s_waitcnt lgkmcnt(0)
    v_add_f32 v34, v34, v50
    v_add_f32 v35, v35, v51
    ds_bpermute_b32 v50, v41, v34
    ds_bpermute_b32 v51, v41, v35
    s_waitcnt lgkmcnt(0)
    v_add_f32 v34, v34, v50
    v_add_f32 v35, v35, v51
    ds_bpermute_b32 v50, v42, v34
    ds_bpermute_b32 v51, v42, v35
    s_waitcnt lgkmcnt(0)
    v_add_f32 v34, v34, v50
    v_add_f32 v35, v35, v51
    ds_bpermute_b32 v50, v43, v34
    ds_bpermute_b32 v51, v43, v35
    s_waitcnt lgkmcnt(0)
    v_add_f32 v34, v34, v50
    v_add_f32 v35, v35, v51
    ds_bpermute_b32 v50, v44, v34
    ds_bpermute_b32 v51, v44, v35
    s_waitcnt lgkmcnt(0)
    v_add_f32 v34, v34, v50
    v_add_f32 v35, v35, v51
    ds_bpermute_b32 v50, v45, v34
    ds_bpermute_b32 v51, v45, v35
    s_waitcnt lgkmcnt(0)
    v_add_f32 v34, v34, v50
    v_add_f32 v35, v35, v51
    v_mul_f32 v34, s20, v34
    v_mul_f32 v35, s20, v35
    s_mov_b32 s21, 0x3727c5ac
    v_cvt_pk_bf16_f32 v52, v32, v34
    v_lshlrev_b32 v32, 16, v52
    v_and_b32 v34, 0xffff0000, v52
    v_add_f32 v34, s21, v34
    v_cvt_pk_bf16_f32 v52, v34, v34
    v_and_b32 v34, 0xffff0000, v52
    v_sqrt_f32 v34, v34
    s_nop 0
    v_cvt_pk_bf16_f32 v52, v34, v34
    v_and_b32 v34, 0xffff0000, v52
    v_rcp_f32 v34, v34
    s_nop 0
    v_cvt_pk_bf16_f32 v52, v33, v35
    v_lshlrev_b32 v33, 16, v52
    v_and_b32 v35, 0xffff0000, v52
    v_add_f32 v35, s21, v35
    v_cvt_pk_bf16_f32 v52, v35, v35
    v_and_b32 v35, 0xffff0000, v52
    v_sqrt_f32 v35, v35
    s_nop 0
    v_cvt_pk_bf16_f32 v52, v35, v35
    v_and_b32 v35, 0xffff0000, v52
    v_rcp_f32 v35, v35
    s_nop 0
    v_sub_f32 v52, v16, v32
    v_sub_f32 v53, v17, v32
    v_cvt_pk_bf16_f32 v54, v52, v53
    v_lshlrev_b32 v52, 16, v54
    v_and_b32 v53, 0xffff0000, v54
    v_mul_f32 v52, v52, v34
    v_mul_f32 v53, v53, v34
    v_cvt_pk_bf16_f32 v4, v52, v53
    v_sub_f32 v52, v18, v32
    v_sub_f32 v53, v19, v32
    v_cvt_pk_bf16_f32 v54, v52, v53
    v_lshlrev_b32 v52, 16, v54
    v_and_b32 v53, 0xffff0000, v54
    v_mul_f32 v52, v52, v34
    v_mul_f32 v53, v53, v34
    v_cvt_pk_bf16_f32 v5, v52, v53
    v_sub_f32 v52, v20, v32
    v_sub_f32 v53, v21, v32
    v_cvt_pk_bf16_f32 v54, v52, v53
    v_lshlrev_b32 v52, 16, v54
    v_and_b32 v53, 0xffff0000, v54
    v_mul_f32 v52, v52, v34
    v_mul_f32 v53, v53, v34
    v_cvt_pk_bf16_f32 v6, v52, v53
    v_sub_f32 v52, v22, v32
    v_sub_f32 v53, v23, v32
    v_cvt_pk_bf16_f32 v54, v52, v53
    v_lshlrev_b32 v52, 16, v54
    v_and_b32 v53, 0xffff0000, v54
    v_mul_f32 v52, v52, v34
    v_mul_f32 v53, v53, v34
    v_cvt_pk_bf16_f32 v7, v52, v53
    v_sub_f32 v52, v24, v33
    v_sub_f32 v53, v25, v33
    v_cvt_pk_bf16_f32 v54, v52, v53
    v_lshlrev_b32 v52, 16, v54
    v_and_b32 v53, 0xffff0000, v54
    v_mul_f32 v52, v52, v35
    v_mul_f32 v53, v53, v35
    v_cvt_pk_bf16_f32 v8, v52, v53
    v_sub_f32 v52, v26, v33
    v_sub_f32 v53, v27, v33
    v_cvt_pk_bf16_f32 v54, v52, v53
    v_lshlrev_b32 v52, 16, v54
    v_and_b32 v53, 0xffff0000, v54
    v_mul_f32 v52, v52, v35
    v_mul_f32 v53, v53, v35
    v_cvt_pk_bf16_f32 v9, v52, v53
    v_sub_f32 v52, v28, v33
    v_sub_f32 v53, v29, v33
    v_cvt_pk_bf16_f32 v54, v52, v53
    v_lshlrev_b32 v52, 16, v54
    v_and_b32 v53, 0xffff0000, v54
    v_mul_f32 v52, v52, v35
    v_mul_f32 v53, v53, v35
    v_cvt_pk_bf16_f32 v10, v52, v53
    v_sub_f32 v52, v30, v33
    v_sub_f32 v53, v31, v33
    v_cvt_pk_bf16_f32 v54, v52, v53
    v_lshlrev_b32 v52, 16, v54
    v_and_b32 v53, 0xffff0000, v54
    v_mul_f32 v52, v52, v35
    v_mul_f32 v53, v53, v35
    v_cvt_pk_bf16_f32 v11, v52, v53
    buffer_store_dwordx4 v[4:7], v1, s[12:15], 0 offen
    buffer_store_dwordx4 v[8:11], v1, s[12:15], 0 offen offset:1024
    s_waitcnt vmcnt(0)
LN_END:
    s_endpgm
.globl gemm1_kernel
.p2align 8
.type gemm1_kernel,@function
gemm1_kernel:
    s_cmp_ge_u32 s2, 640
    s_cbranch_scc1 K1_END
    s_load_dwordx4 s[4:7], s[0:1], 8
    s_load_dwordx4 s[8:11], s[0:1], 40
    s_load_dwordx2 s[12:13], s[0:1], 80
    s_and_b32 s28, s2, 15
    s_lshr_b32 s29, s2, 4
    s_mov_b32 s24, 0
    s_mov_b32 s25, 32768
    s_mov_b32 s26, 65536
    s_mov_b32 s27, 98304
    v_and_b32 v1, 63, v0
    v_lshrrev_b32 v2, 6, v0
    s_waitcnt lgkmcnt(0)
    s_mov_b32 s16, s12
    s_mov_b32 s17, s13
    s_mov_b32 s18, 13701120
    s_mov_b32 s19, 0x00020000
    s_mov_b32 s20, s6
    s_mov_b32 s21, s7
    s_mov_b32 s22, 16384
    s_mov_b32 s23, 0x00020000
    s_lshl_b32 s32, s28, 17
    v_lshrrev_b32 v3, 3, v0
    v_lshlrev_b32 v3, 10, v3
    v_and_b32 v4, 7, v0
    v_lshlrev_b32 v5, 4, v4
    v_add_u32 v3, v3, v5
    v_add_u32 v232, s32, v3
    v_lshrrev_b32 v3, 3, v0
    v_and_b32 v5, 7, v3
    v_xor_b32 v5, v5, v4
    v_lshlrev_b32 v5, 4, v5
    v_lshlrev_b32 v3, 7, v3
    v_add_u32 v233, v3, v5
    v_lshrrev_b32 v3, 4, v0
    v_and_b32 v4, 15, v0
    v_and_b32 v5, 3, v3
    v_lshrrev_b32 v6, 3, v3
    v_and_b32 v6, 1, v6
    v_lshl_or_b32 v5, v6, 2, v5
    v_lshrrev_b32 v6, 1, v4
    v_xor_b32 v5, v5, v6
    v_lshlrev_b32 v5, 5, v5
    v_and_b32 v6, 1, v4
    v_lshlrev_b32 v6, 4, v6
    v_lshlrev_b32 v7, 8, v3
    v_add3_u32 v234, v5, v6, v7
    v_add_u32 v234, 32768, v234
    v_lshrrev_b32 v3, 1, v2
    v_lshlrev_b32 v3, 6, v3
    v_and_b32 v4, 15, v1
    v_add_u32 v3, v3, v4
    v_lshlrev_b32 v3, 7, v3
    v_lshrrev_b32 v5, 4, v1
    v_and_b32 v6, 7, v1
    v_xor_b32 v7, v5, v6
    v_lshlrev_b32 v7, 4, v7
    v_add_u32 v235, v3, v7
    v_add_u32 v5, 4, v5
    v_xor_b32 v7, v5, v6
    v_lshlrev_b32 v7, 4, v7
    v_add_u32 v236, v3, v7
    v_and_b32 v3, 15, v1
    v_lshrrev_b32 v4, 2, v3
    v_and_b32 v5, 3, v3
    v_lshrrev_b32 v6, 4, v1
    v_lshlrev_b32 v7, 3, v6
    v_add_u32 v7, v7, v4
    v_lshlrev_b32 v7, 8, v7
    v_lshlrev_b32 v5, 3, v5
    v_add_u32 v7, v7, v5
    v_add_u32 v7, 32768, v7
    v_and_b32 v6, 1, v6
    v_lshl_or_b32 v4, v6, 2, v4
    v_and_b32 v8, 1, v2
    v_lshlrev_b32 v8, 2, v8
    v_add_u32 v9, 0, v8
    v_xor_b32 v9, v9, v4
    v_lshlrev_b32 v9, 5, v9
    v_add_u32 v237, v7, v9
    v_add_u32 v9, 1, v8
    v_xor_b32 v9, v9, v4
    v_lshlrev_b32 v9, 5, v9
    v_add_u32 v238, v7, v9
    v_add_u32 v9, 2, v8
    v_xor_b32 v9, v9, v4
    v_lshlrev_b32 v9, 5, v9
    v_add_u32 v239, v7, v9
    v_add_u32 v9, 3, v8
    v_xor_b32 v9, v9, v4
    v_lshlrev_b32 v9, 5, v9
    v_add_u32 v240, v7, v9
    v_xor_b32 v20, 16, v1
    v_lshlrev_b32 v20, 2, v20
    v_xor_b32 v21, 32, v1
    v_lshlrev_b32 v21, 2, v21
    v_lshrrev_b32 v22, 4, v1
    v_lshlrev_b32 v22, 7, v22
    v_and_b32 v3, 15, v1
    v_lshl_add_u32 v22, v3, 1, v22
    v_and_b32 v4, 15, v0
    v_lshrrev_b32 v5, 1, v4
    v_and_b32 v6, 1, v4
    s_cmp_lt_u32 s29, 8
    s_cbranch_scc1 K1_KV
    s_cmp_lt_u32 s29, 12
    s_cbranch_scc1 K1_Q
    s_sub_u32 s33, s29, 12
    s_lshl_b32 s34, s33, 7
    v_lshrrev_b32 v7, 2, v5
    v_lshlrev_b32 v7, 6, v7
    v_and_b32 v8, 1, v5
    v_lshlrev_b32 v8, 5, v8
    v_lshlrev_b32 v9, 4, v6
    v_add3_u32 v10, v7, v8, v9
    v_add_u32 v10, s34, v10
    v_and_b32 v7, 2, v5
    v_cmp_ne_u32 vcc, 0, v7
    v_mov_b32 v11, s8
    v_mov_b32 v12, s9
    v_mov_b32 v13, s10
    v_mov_b32 v14, s11
    v_cndmask_b32 v11, v11, v13, vcc
    v_cndmask_b32 v12, v12, v14, vcc
    s_mov_b32 s30, 3584
    s_branch K1_COMMON
K1_Q:
    s_sub_u32 s33, s29, 8
    s_lshl_b32 s34, s33, 8
    v_lshlrev_b32 v10, 4, v4
    v_add_u32 v10, s34, v10
    v_mov_b32 v11, s4
    v_mov_b32 v12, s5
    s_mov_b32 s30, 3072
    s_branch K1_COMMON
K1_KV:
    s_lshl_b32 s34, s29, 7
    s_add_u32 s34, s34, 1024
    v_and_b32 v7, 1, v5
    v_lshlrev_b32 v7, 10, v7
    v_lshrrev_b32 v8, 1, v5
    v_lshlrev_b32 v8, 5, v8
    v_lshlrev_b32 v9, 4, v6
    v_add3_u32 v10, v7, v8, v9
    v_add_u32 v10, s34, v10
    v_mov_b32 v11, s4
    v_mov_b32 v12, s5
    s_mov_b32 s30, 3072
K1_COMMON:
    s_lshl_b32 s31, s30, 6
    v_lshrrev_b32 v3, 4, v0
    v_mul_lo_u32 v3, v3, s30
    v_add_u32 v3, v3, v10
    s_lshl_b32 s35, s30, 4
    v_add_co_u32 v224, vcc, v11, v3
    v_addc_co_u32 v225, vcc, 0, v12, vcc
    v_add_u32 v3, s35, v3
    v_add_co_u32 v226, vcc, v11, v3
    v_addc_co_u32 v227, vcc, 0, v12, vcc
    v_add_u32 v3, s35, v3
    v_add_co_u32 v228, vcc, v11, v3
    v_addc_co_u32 v229, vcc, 0, v12, vcc
    v_add_u32 v3, s35, v3
    v_add_co_u32 v230, vcc, v11, v3
    v_addc_co_u32 v231, vcc, 0, v12, vcc
    v_add_u32 v3, s35, v3
    buffer_load_dwordx4 v[192:195], v232, s[16:19], s24 offen offset:0
    buffer_load_dwordx4 v[196:199], v232, s[16:19], s25 offen offset:0
    buffer_load_dwordx4 v[200:203], v232, s[16:19], s26 offen offset:0
    buffer_load_dwordx4 v[204:207], v232, s[16:19], s27 offen offset:0
    global_load_dwordx4 v[208:211], v[224:225], off
    global_load_dwordx4 v[212:215], v[226:227], off
    global_load_dwordx4 v[216:219], v[228:229], off
    global_load_dwordx4 v[220:223], v[230:231], off
    v_add_co_u32 v224, vcc, s31, v224
    v_addc_co_u32 v225, vcc, 0, v225, vcc
    v_add_co_u32 v226, vcc, s31, v226
    v_addc_co_u32 v227, vcc, 0, v227, vcc
    v_add_co_u32 v228, vcc, s31, v228
    v_addc_co_u32 v229, vcc, 0, v229, vcc
    v_add_co_u32 v230, vcc, s31, v230
    v_addc_co_u32 v231, vcc, 0, v231, vcc
    buffer_load_dwordx4 v[32:35], v232, s[16:19], s24 offen offset:128
    buffer_load_dwordx4 v[36:39], v232, s[16:19], s25 offen offset:128
    buffer_load_dwordx4 v[40:43], v232, s[16:19], s26 offen offset:128
    buffer_load_dwordx4 v[44:47], v232, s[16:19], s27 offen offset:128
    global_load_dwordx4 v[48:51], v[224:225], off
    global_load_dwordx4 v[52:55], v[226:227], off
    global_load_dwordx4 v[56:59], v[228:229], off
    global_load_dwordx4 v[60:63], v[230:231], off
    v_add_co_u32 v224, vcc, s31, v224
    v_addc_co_u32 v225, vcc, 0, v225, vcc
    v_add_co_u32 v226, vcc, s31, v226
    v_addc_co_u32 v227, vcc, 0, v227, vcc
    v_add_co_u32 v228, vcc, s31, v228
    v_addc_co_u32 v229, vcc, 0, v229, vcc
    v_add_co_u32 v230, vcc, s31, v230
    v_addc_co_u32 v231, vcc, 0, v231, vcc
    s_waitcnt vmcnt(8)
    ds_write_b128 v233, v[192:195] offset:0
    ds_write_b128 v233, v[196:199] offset:4096
    ds_write_b128 v233, v[200:203] offset:8192
    ds_write_b128 v233, v[204:207] offset:12288
    ds_write_b128 v234, v[208:211] offset:0
    ds_write_b128 v234, v[212:215] offset:4096
    ds_write_b128 v234, v[216:219] offset:8192
    ds_write_b128 v234, v[220:223] offset:12288
    s_waitcnt lgkmcnt(0)
    buffer_load_dwordx4 v[192:195], v232, s[16:19], s24 offen offset:256
    buffer_load_dwordx4 v[196:199], v232, s[16:19], s25 offen offset:256
    buffer_load_dwordx4 v[200:203], v232, s[16:19], s26 offen offset:256
    buffer_load_dwordx4 v[204:207], v232, s[16:19], s27 offen offset:256
    global_load_dwordx4 v[208:211], v[224:225], off
    global_load_dwordx4 v[212:215], v[226:227], off
    global_load_dwordx4 v[216:219], v[228:229], off
    global_load_dwordx4 v[220:223], v[230:231], off
    v_add_co_u32 v224, vcc, s31, v224
    v_addc_co_u32 v225, vcc, 0, v225, vcc
    v_add_co_u32 v226, vcc, s31, v226
    v_addc_co_u32 v227, vcc, 0, v227, vcc
    v_add_co_u32 v228, vcc, s31, v228
    v_addc_co_u32 v229, vcc, 0, v229, vcc
    v_add_co_u32 v230, vcc, s31, v230
    v_addc_co_u32 v231, vcc, 0, v231, vcc
    s_barrier
    s_cmp_lt_u32 s29, 8
    s_cbranch_scc1 K1_LOOP_KV
    ds_read_b128 v[128:131], v235 offset:0
    ds_read_b128 v[132:135], v235 offset:2048
    ds_read_b128 v[136:139], v235 offset:4096
    ds_read_b128 v[140:143], v235 offset:6144
    ds_read_b64_tr_b16 v[160:161], v237 offset:0
    ds_read_b64_tr_b16 v[162:163], v237 offset:1024
    ds_read_b64_tr_b16 v[164:165], v238 offset:0
    ds_read_b64_tr_b16 v[166:167], v238 offset:1024
    ds_read_b64_tr_b16 v[168:169], v239 offset:0
    ds_read_b64_tr_b16 v[170:171], v239 offset:1024
    ds_read_b64_tr_b16 v[172:173], v240 offset:0
    ds_read_b64_tr_b16 v[174:175], v240 offset:1024
    ds_read_b128 v[144:147], v236 offset:0
    ds_read_b128 v[148:151], v236 offset:2048
    ds_read_b128 v[152:155], v236 offset:4096
    ds_read_b128 v[156:159], v236 offset:6144
    ds_read_b64_tr_b16 v[176:177], v237 offset:8192
    ds_read_b64_tr_b16 v[178:179], v237 offset:9216
    ds_read_b64_tr_b16 v[180:181], v238 offset:8192
    ds_read_b64_tr_b16 v[182:183], v238 offset:9216
    ds_read_b64_tr_b16 v[184:185], v239 offset:8192
    ds_read_b64_tr_b16 v[186:187], v239 offset:9216
    ds_read_b64_tr_b16 v[188:189], v240 offset:8192
    ds_read_b64_tr_b16 v[190:191], v240 offset:9216
    s_waitcnt lgkmcnt(12)
    v_mfma_f32_16x16x32_bf16 v[64:67], v[160:163], v[128:131], 0
    v_mfma_f32_16x16x32_bf16 v[68:71], v[160:163], v[132:135], 0
    v_mfma_f32_16x16x32_bf16 v[72:75], v[160:163], v[136:139], 0
    v_mfma_f32_16x16x32_bf16 v[76:79], v[160:163], v[140:143], 0
    v_mfma_f32_16x16x32_bf16 v[80:83], v[164:167], v[128:131], 0
    v_mfma_f32_16x16x32_bf16 v[84:87], v[164:167], v[132:135], 0
    v_mfma_f32_16x16x32_bf16 v[88:91], v[164:167], v[136:139], 0
    v_mfma_f32_16x16x32_bf16 v[92:95], v[164:167], v[140:143], 0
    v_mfma_f32_16x16x32_bf16 v[96:99], v[168:171], v[128:131], 0
    v_mfma_f32_16x16x32_bf16 v[100:103], v[168:171], v[132:135], 0
    v_mfma_f32_16x16x32_bf16 v[104:107], v[168:171], v[136:139], 0
    v_mfma_f32_16x16x32_bf16 v[108:111], v[168:171], v[140:143], 0
    v_mfma_f32_16x16x32_bf16 v[112:115], v[172:175], v[128:131], 0
    v_mfma_f32_16x16x32_bf16 v[116:119], v[172:175], v[132:135], 0
    v_mfma_f32_16x16x32_bf16 v[120:123], v[172:175], v[136:139], 0
    v_mfma_f32_16x16x32_bf16 v[124:127], v[172:175], v[140:143], 0
    s_waitcnt lgkmcnt(0)
    v_mfma_f32_16x16x32_bf16 v[64:67], v[176:179], v[144:147], v[64:67]
    v_mfma_f32_16x16x32_bf16 v[68:71], v[176:179], v[148:151], v[68:71]
    v_mfma_f32_16x16x32_bf16 v[72:75], v[176:179], v[152:155], v[72:75]
    v_mfma_f32_16x16x32_bf16 v[76:79], v[176:179], v[156:159], v[76:79]
    v_mfma_f32_16x16x32_bf16 v[80:83], v[180:183], v[144:147], v[80:83]
    v_mfma_f32_16x16x32_bf16 v[84:87], v[180:183], v[148:151], v[84:87]
    v_mfma_f32_16x16x32_bf16 v[88:91], v[180:183], v[152:155], v[88:91]
    v_mfma_f32_16x16x32_bf16 v[92:95], v[180:183], v[156:159], v[92:95]
    v_mfma_f32_16x16x32_bf16 v[96:99], v[184:187], v[144:147], v[96:99]
    v_mfma_f32_16x16x32_bf16 v[100:103], v[184:187], v[148:151], v[100:103]
    v_mfma_f32_16x16x32_bf16 v[104:107], v[184:187], v[152:155], v[104:107]
    v_mfma_f32_16x16x32_bf16 v[108:111], v[184:187], v[156:159], v[108:111]
    v_mfma_f32_16x16x32_bf16 v[112:115], v[188:191], v[144:147], v[112:115]
    v_mfma_f32_16x16x32_bf16 v[116:119], v[188:191], v[148:151], v[116:119]
    v_mfma_f32_16x16x32_bf16 v[120:123], v[188:191], v[152:155], v[120:123]
    v_mfma_f32_16x16x32_bf16 v[124:127], v[188:191], v[156:159], v[124:127]
    s_waitcnt vmcnt(8)
    ds_write_b128 v233, v[32:35] offset:16384
    ds_write_b128 v233, v[36:39] offset:20480
    ds_write_b128 v233, v[40:43] offset:24576
    ds_write_b128 v233, v[44:47] offset:28672
    ds_write_b128 v234, v[48:51] offset:16384
    ds_write_b128 v234, v[52:55] offset:20480
    ds_write_b128 v234, v[56:59] offset:24576
    ds_write_b128 v234, v[60:63] offset:28672
    s_waitcnt lgkmcnt(0)
    buffer_load_dwordx4 v[32:35], v232, s[16:19], s24 offen offset:384
    buffer_load_dwordx4 v[36:39], v232, s[16:19], s25 offen offset:384
    buffer_load_dwordx4 v[40:43], v232, s[16:19], s26 offen offset:384
    buffer_load_dwordx4 v[44:47], v232, s[16:19], s27 offen offset:384
    global_load_dwordx4 v[48:51], v[224:225], off
    global_load_dwordx4 v[52:55], v[226:227], off
    global_load_dwordx4 v[56:59], v[228:229], off
    global_load_dwordx4 v[60:63], v[230:231], off
    v_add_co_u32 v224, vcc, s31, v224
    v_addc_co_u32 v225, vcc, 0, v225, vcc
    v_add_co_u32 v226, vcc, s31, v226
    v_addc_co_u32 v227, vcc, 0, v227, vcc
    v_add_co_u32 v228, vcc, s31, v228
    v_addc_co_u32 v229, vcc, 0, v229, vcc
    v_add_co_u32 v230, vcc, s31, v230
    v_addc_co_u32 v231, vcc, 0, v231, vcc
    s_barrier
    ds_read_b128 v[128:131], v235 offset:16384
    ds_read_b128 v[132:135], v235 offset:18432
    ds_read_b128 v[136:139], v235 offset:20480
    ds_read_b128 v[140:143], v235 offset:22528
    ds_read_b64_tr_b16 v[160:161], v237 offset:16384
    ds_read_b64_tr_b16 v[162:163], v237 offset:17408
    ds_read_b64_tr_b16 v[164:165], v238 offset:16384
    ds_read_b64_tr_b16 v[166:167], v238 offset:17408
    ds_read_b64_tr_b16 v[168:169], v239 offset:16384
    ds_read_b64_tr_b16 v[170:171], v239 offset:17408
    ds_read_b64_tr_b16 v[172:173], v240 offset:16384
    ds_read_b64_tr_b16 v[174:175], v240 offset:17408
    ds_read_b128 v[144:147], v236 offset:16384
    ds_read_b128 v[148:151], v236 offset:18432
    ds_read_b128 v[152:155], v236 offset:20480
    ds_read_b128 v[156:159], v236 offset:22528
    ds_read_b64_tr_b16 v[176:177], v237 offset:24576
    ds_read_b64_tr_b16 v[178:179], v237 offset:25600
    ds_read_b64_tr_b16 v[180:181], v238 offset:24576
    ds_read_b64_tr_b16 v[182:183], v238 offset:25600
    ds_read_b64_tr_b16 v[184:185], v239 offset:24576
    ds_read_b64_tr_b16 v[186:187], v239 offset:25600
    ds_read_b64_tr_b16 v[188:189], v240 offset:24576
    ds_read_b64_tr_b16 v[190:191], v240 offset:25600
    s_waitcnt lgkmcnt(12)
    v_mfma_f32_16x16x32_bf16 v[64:67], v[160:163], v[128:131], v[64:67]
    v_mfma_f32_16x16x32_bf16 v[68:71], v[160:163], v[132:135], v[68:71]
    v_mfma_f32_16x16x32_bf16 v[72:75], v[160:163], v[136:139], v[72:75]
    v_mfma_f32_16x16x32_bf16 v[76:79], v[160:163], v[140:143], v[76:79]
    v_mfma_f32_16x16x32_bf16 v[80:83], v[164:167], v[128:131], v[80:83]
    v_mfma_f32_16x16x32_bf16 v[84:87], v[164:167], v[132:135], v[84:87]
    v_mfma_f32_16x16x32_bf16 v[88:91], v[164:167], v[136:139], v[88:91]
    v_mfma_f32_16x16x32_bf16 v[92:95], v[164:167], v[140:143], v[92:95]
    v_mfma_f32_16x16x32_bf16 v[96:99], v[168:171], v[128:131], v[96:99]
    v_mfma_f32_16x16x32_bf16 v[100:103], v[168:171], v[132:135], v[100:103]
    v_mfma_f32_16x16x32_bf16 v[104:107], v[168:171], v[136:139], v[104:107]
    v_mfma_f32_16x16x32_bf16 v[108:111], v[168:171], v[140:143], v[108:111]
    v_mfma_f32_16x16x32_bf16 v[112:115], v[172:175], v[128:131], v[112:115]
    v_mfma_f32_16x16x32_bf16 v[116:119], v[172:175], v[132:135], v[116:119]
    v_mfma_f32_16x16x32_bf16 v[120:123], v[172:175], v[136:139], v[120:123]
    v_mfma_f32_16x16x32_bf16 v[124:127], v[172:175], v[140:143], v[124:127]
    s_waitcnt lgkmcnt(0)
    v_mfma_f32_16x16x32_bf16 v[64:67], v[176:179], v[144:147], v[64:67]
    v_mfma_f32_16x16x32_bf16 v[68:71], v[176:179], v[148:151], v[68:71]
    v_mfma_f32_16x16x32_bf16 v[72:75], v[176:179], v[152:155], v[72:75]
    v_mfma_f32_16x16x32_bf16 v[76:79], v[176:179], v[156:159], v[76:79]
    v_mfma_f32_16x16x32_bf16 v[80:83], v[180:183], v[144:147], v[80:83]
    v_mfma_f32_16x16x32_bf16 v[84:87], v[180:183], v[148:151], v[84:87]
    v_mfma_f32_16x16x32_bf16 v[88:91], v[180:183], v[152:155], v[88:91]
    v_mfma_f32_16x16x32_bf16 v[92:95], v[180:183], v[156:159], v[92:95]
    v_mfma_f32_16x16x32_bf16 v[96:99], v[184:187], v[144:147], v[96:99]
    v_mfma_f32_16x16x32_bf16 v[100:103], v[184:187], v[148:151], v[100:103]
    v_mfma_f32_16x16x32_bf16 v[104:107], v[184:187], v[152:155], v[104:107]
    v_mfma_f32_16x16x32_bf16 v[108:111], v[184:187], v[156:159], v[108:111]
    v_mfma_f32_16x16x32_bf16 v[112:115], v[188:191], v[144:147], v[112:115]
    v_mfma_f32_16x16x32_bf16 v[116:119], v[188:191], v[148:151], v[116:119]
    v_mfma_f32_16x16x32_bf16 v[120:123], v[188:191], v[152:155], v[120:123]
    v_mfma_f32_16x16x32_bf16 v[124:127], v[188:191], v[156:159], v[124:127]
    s_waitcnt vmcnt(8)
    ds_write_b128 v233, v[192:195] offset:0
    ds_write_b128 v233, v[196:199] offset:4096
    ds_write_b128 v233, v[200:203] offset:8192
    ds_write_b128 v233, v[204:207] offset:12288
    ds_write_b128 v234, v[208:211] offset:0
    ds_write_b128 v234, v[212:215] offset:4096
    ds_write_b128 v234, v[216:219] offset:8192
    ds_write_b128 v234, v[220:223] offset:12288
    s_waitcnt lgkmcnt(0)
    buffer_load_dwordx4 v[192:195], v232, s[16:19], s24 offen offset:512
    buffer_load_dwordx4 v[196:199], v232, s[16:19], s25 offen offset:512
    buffer_load_dwordx4 v[200:203], v232, s[16:19], s26 offen offset:512
    buffer_load_dwordx4 v[204:207], v232, s[16:19], s27 offen offset:512
    global_load_dwordx4 v[208:211], v[224:225], off
    global_load_dwordx4 v[212:215], v[226:227], off
    global_load_dwordx4 v[216:219], v[228:229], off
    global_load_dwordx4 v[220:223], v[230:231], off
    v_add_co_u32 v224, vcc, s31, v224
    v_addc_co_u32 v225, vcc, 0, v225, vcc
    v_add_co_u32 v226, vcc, s31, v226
    v_addc_co_u32 v227, vcc, 0, v227, vcc
    v_add_co_u32 v228, vcc, s31, v228
    v_addc_co_u32 v229, vcc, 0, v229, vcc
    v_add_co_u32 v230, vcc, s31, v230
    v_addc_co_u32 v231, vcc, 0, v231, vcc
    s_barrier
    ds_read_b128 v[128:131], v235 offset:0
    ds_read_b128 v[132:135], v235 offset:2048
    ds_read_b128 v[136:139], v235 offset:4096
    ds_read_b128 v[140:143], v235 offset:6144
    ds_read_b64_tr_b16 v[160:161], v237 offset:0
    ds_read_b64_tr_b16 v[162:163], v237 offset:1024
    ds_read_b64_tr_b16 v[164:165], v238 offset:0
    ds_read_b64_tr_b16 v[166:167], v238 offset:1024
    ds_read_b64_tr_b16 v[168:169], v239 offset:0
    ds_read_b64_tr_b16 v[170:171], v239 offset:1024
    ds_read_b64_tr_b16 v[172:173], v240 offset:0
    ds_read_b64_tr_b16 v[174:175], v240 offset:1024
    ds_read_b128 v[144:147], v236 offset:0
    ds_read_b128 v[148:151], v236 offset:2048
    ds_read_b128 v[152:155], v236 offset:4096
    ds_read_b128 v[156:159], v236 offset:6144
    ds_read_b64_tr_b16 v[176:177], v237 offset:8192
    ds_read_b64_tr_b16 v[178:179], v237 offset:9216
    ds_read_b64_tr_b16 v[180:181], v238 offset:8192
    ds_read_b64_tr_b16 v[182:183], v238 offset:9216
    ds_read_b64_tr_b16 v[184:185], v239 offset:8192
    ds_read_b64_tr_b16 v[186:187], v239 offset:9216
    ds_read_b64_tr_b16 v[188:189], v240 offset:8192
    ds_read_b64_tr_b16 v[190:191], v240 offset:9216
    s_waitcnt lgkmcnt(12)
    v_mfma_f32_16x16x32_bf16 v[64:67], v[160:163], v[128:131], v[64:67]
    v_mfma_f32_16x16x32_bf16 v[68:71], v[160:163], v[132:135], v[68:71]
    v_mfma_f32_16x16x32_bf16 v[72:75], v[160:163], v[136:139], v[72:75]
    v_mfma_f32_16x16x32_bf16 v[76:79], v[160:163], v[140:143], v[76:79]
    v_mfma_f32_16x16x32_bf16 v[80:83], v[164:167], v[128:131], v[80:83]
    v_mfma_f32_16x16x32_bf16 v[84:87], v[164:167], v[132:135], v[84:87]
    v_mfma_f32_16x16x32_bf16 v[88:91], v[164:167], v[136:139], v[88:91]
    v_mfma_f32_16x16x32_bf16 v[92:95], v[164:167], v[140:143], v[92:95]
    v_mfma_f32_16x16x32_bf16 v[96:99], v[168:171], v[128:131], v[96:99]
    v_mfma_f32_16x16x32_bf16 v[100:103], v[168:171], v[132:135], v[100:103]
    v_mfma_f32_16x16x32_bf16 v[104:107], v[168:171], v[136:139], v[104:107]
    v_mfma_f32_16x16x32_bf16 v[108:111], v[168:171], v[140:143], v[108:111]
    v_mfma_f32_16x16x32_bf16 v[112:115], v[172:175], v[128:131], v[112:115]
    v_mfma_f32_16x16x32_bf16 v[116:119], v[172:175], v[132:135], v[116:119]
    v_mfma_f32_16x16x32_bf16 v[120:123], v[172:175], v[136:139], v[120:123]
    v_mfma_f32_16x16x32_bf16 v[124:127], v[172:175], v[140:143], v[124:127]
    s_waitcnt lgkmcnt(0)
    v_mfma_f32_16x16x32_bf16 v[64:67], v[176:179], v[144:147], v[64:67]
    v_mfma_f32_16x16x32_bf16 v[68:71], v[176:179], v[148:151], v[68:71]
    v_mfma_f32_16x16x32_bf16 v[72:75], v[176:179], v[152:155], v[72:75]
    v_mfma_f32_16x16x32_bf16 v[76:79], v[176:179], v[156:159], v[76:79]
    v_mfma_f32_16x16x32_bf16 v[80:83], v[180:183], v[144:147], v[80:83]
    v_mfma_f32_16x16x32_bf16 v[84:87], v[180:183], v[148:151], v[84:87]
    v_mfma_f32_16x16x32_bf16 v[88:91], v[180:183], v[152:155], v[88:91]
    v_mfma_f32_16x16x32_bf16 v[92:95], v[180:183], v[156:159], v[92:95]
    v_mfma_f32_16x16x32_bf16 v[96:99], v[184:187], v[144:147], v[96:99]
    v_mfma_f32_16x16x32_bf16 v[100:103], v[184:187], v[148:151], v[100:103]
    v_mfma_f32_16x16x32_bf16 v[104:107], v[184:187], v[152:155], v[104:107]
    v_mfma_f32_16x16x32_bf16 v[108:111], v[184:187], v[156:159], v[108:111]
    v_mfma_f32_16x16x32_bf16 v[112:115], v[188:191], v[144:147], v[112:115]
    v_mfma_f32_16x16x32_bf16 v[116:119], v[188:191], v[148:151], v[116:119]
    v_mfma_f32_16x16x32_bf16 v[120:123], v[188:191], v[152:155], v[120:123]
    v_mfma_f32_16x16x32_bf16 v[124:127], v[188:191], v[156:159], v[124:127]
    s_waitcnt vmcnt(8)
    ds_write_b128 v233, v[32:35] offset:16384
    ds_write_b128 v233, v[36:39] offset:20480
    ds_write_b128 v233, v[40:43] offset:24576
    ds_write_b128 v233, v[44:47] offset:28672
    ds_write_b128 v234, v[48:51] offset:16384
    ds_write_b128 v234, v[52:55] offset:20480
    ds_write_b128 v234, v[56:59] offset:24576
    ds_write_b128 v234, v[60:63] offset:28672
    s_waitcnt lgkmcnt(0)
    buffer_load_dwordx4 v[32:35], v232, s[16:19], s24 offen offset:640
    buffer_load_dwordx4 v[36:39], v232, s[16:19], s25 offen offset:640
    buffer_load_dwordx4 v[40:43], v232, s[16:19], s26 offen offset:640
    buffer_load_dwordx4 v[44:47], v232, s[16:19], s27 offen offset:640
    global_load_dwordx4 v[48:51], v[224:225], off
    global_load_dwordx4 v[52:55], v[226:227], off
    global_load_dwordx4 v[56:59], v[228:229], off
    global_load_dwordx4 v[60:63], v[230:231], off
    v_add_co_u32 v224, vcc, s31, v224
    v_addc_co_u32 v225, vcc, 0, v225, vcc
    v_add_co_u32 v226, vcc, s31, v226
    v_addc_co_u32 v227, vcc, 0, v227, vcc
    v_add_co_u32 v228, vcc, s31, v228
    v_addc_co_u32 v229, vcc, 0, v229, vcc
    v_add_co_u32 v230, vcc, s31, v230
    v_addc_co_u32 v231, vcc, 0, v231, vcc
    s_barrier
    ds_read_b128 v[128:131], v235 offset:16384
    ds_read_b128 v[132:135], v235 offset:18432
    ds_read_b128 v[136:139], v235 offset:20480
    ds_read_b128 v[140:143], v235 offset:22528
    ds_read_b64_tr_b16 v[160:161], v237 offset:16384
    ds_read_b64_tr_b16 v[162:163], v237 offset:17408
    ds_read_b64_tr_b16 v[164:165], v238 offset:16384
    ds_read_b64_tr_b16 v[166:167], v238 offset:17408
    ds_read_b64_tr_b16 v[168:169], v239 offset:16384
    ds_read_b64_tr_b16 v[170:171], v239 offset:17408
    ds_read_b64_tr_b16 v[172:173], v240 offset:16384
    ds_read_b64_tr_b16 v[174:175], v240 offset:17408
    ds_read_b128 v[144:147], v236 offset:16384
    ds_read_b128 v[148:151], v236 offset:18432
    ds_read_b128 v[152:155], v236 offset:20480
    ds_read_b128 v[156:159], v236 offset:22528
    ds_read_b64_tr_b16 v[176:177], v237 offset:24576
    ds_read_b64_tr_b16 v[178:179], v237 offset:25600
    ds_read_b64_tr_b16 v[180:181], v238 offset:24576
    ds_read_b64_tr_b16 v[182:183], v238 offset:25600
    ds_read_b64_tr_b16 v[184:185], v239 offset:24576
    ds_read_b64_tr_b16 v[186:187], v239 offset:25600
    ds_read_b64_tr_b16 v[188:189], v240 offset:24576
    ds_read_b64_tr_b16 v[190:191], v240 offset:25600
    s_waitcnt lgkmcnt(12)
    v_mfma_f32_16x16x32_bf16 v[64:67], v[160:163], v[128:131], v[64:67]
    v_mfma_f32_16x16x32_bf16 v[68:71], v[160:163], v[132:135], v[68:71]
    v_mfma_f32_16x16x32_bf16 v[72:75], v[160:163], v[136:139], v[72:75]
    v_mfma_f32_16x16x32_bf16 v[76:79], v[160:163], v[140:143], v[76:79]
    v_mfma_f32_16x16x32_bf16 v[80:83], v[164:167], v[128:131], v[80:83]
    v_mfma_f32_16x16x32_bf16 v[84:87], v[164:167], v[132:135], v[84:87]
    v_mfma_f32_16x16x32_bf16 v[88:91], v[164:167], v[136:139], v[88:91]
    v_mfma_f32_16x16x32_bf16 v[92:95], v[164:167], v[140:143], v[92:95]
    v_mfma_f32_16x16x32_bf16 v[96:99], v[168:171], v[128:131], v[96:99]
    v_mfma_f32_16x16x32_bf16 v[100:103], v[168:171], v[132:135], v[100:103]
    v_mfma_f32_16x16x32_bf16 v[104:107], v[168:171], v[136:139], v[104:107]
    v_mfma_f32_16x16x32_bf16 v[108:111], v[168:171], v[140:143], v[108:111]
    v_mfma_f32_16x16x32_bf16 v[112:115], v[172:175], v[128:131], v[112:115]
    v_mfma_f32_16x16x32_bf16 v[116:119], v[172:175], v[132:135], v[116:119]
    v_mfma_f32_16x16x32_bf16 v[120:123], v[172:175], v[136:139], v[120:123]
    v_mfma_f32_16x16x32_bf16 v[124:127], v[172:175], v[140:143], v[124:127]
    s_waitcnt lgkmcnt(0)
    v_mfma_f32_16x16x32_bf16 v[64:67], v[176:179], v[144:147], v[64:67]
    v_mfma_f32_16x16x32_bf16 v[68:71], v[176:179], v[148:151], v[68:71]
    v_mfma_f32_16x16x32_bf16 v[72:75], v[176:179], v[152:155], v[72:75]
    v_mfma_f32_16x16x32_bf16 v[76:79], v[176:179], v[156:159], v[76:79]
    v_mfma_f32_16x16x32_bf16 v[80:83], v[180:183], v[144:147], v[80:83]
    v_mfma_f32_16x16x32_bf16 v[84:87], v[180:183], v[148:151], v[84:87]
    v_mfma_f32_16x16x32_bf16 v[88:91], v[180:183], v[152:155], v[88:91]
    v_mfma_f32_16x16x32_bf16 v[92:95], v[180:183], v[156:159], v[92:95]
    v_mfma_f32_16x16x32_bf16 v[96:99], v[184:187], v[144:147], v[96:99]
    v_mfma_f32_16x16x32_bf16 v[100:103], v[184:187], v[148:151], v[100:103]
    v_mfma_f32_16x16x32_bf16 v[104:107], v[184:187], v[152:155], v[104:107]
    v_mfma_f32_16x16x32_bf16 v[108:111], v[184:187], v[156:159], v[108:111]
    v_mfma_f32_16x16x32_bf16 v[112:115], v[188:191], v[144:147], v[112:115]
    v_mfma_f32_16x16x32_bf16 v[116:119], v[188:191], v[148:151], v[116:119]
    v_mfma_f32_16x16x32_bf16 v[120:123], v[188:191], v[152:155], v[120:123]
    v_mfma_f32_16x16x32_bf16 v[124:127], v[188:191], v[156:159], v[124:127]
    s_waitcnt vmcnt(8)
    ds_write_b128 v233, v[192:195] offset:0
    ds_write_b128 v233, v[196:199] offset:4096
    ds_write_b128 v233, v[200:203] offset:8192
    ds_write_b128 v233, v[204:207] offset:12288
    ds_write_b128 v234, v[208:211] offset:0
    ds_write_b128 v234, v[212:215] offset:4096
    ds_write_b128 v234, v[216:219] offset:8192
    ds_write_b128 v234, v[220:223] offset:12288
    s_waitcnt lgkmcnt(0)
    buffer_load_dwordx4 v[192:195], v232, s[16:19], s24 offen offset:768
    buffer_load_dwordx4 v[196:199], v232, s[16:19], s25 offen offset:768
    buffer_load_dwordx4 v[200:203], v232, s[16:19], s26 offen offset:768
    buffer_load_dwordx4 v[204:207], v232, s[16:19], s27 offen offset:768
    global_load_dwordx4 v[208:211], v[224:225], off
    global_load_dwordx4 v[212:215], v[226:227], off
    global_load_dwordx4 v[216:219], v[228:229], off
    global_load_dwordx4 v[220:223], v[230:231], off
    v_add_co_u32 v224, vcc, s31, v224
    v_addc_co_u32 v225, vcc, 0, v225, vcc
    v_add_co_u32 v226, vcc, s31, v226
    v_addc_co_u32 v227, vcc, 0, v227, vcc
    v_add_co_u32 v228, vcc, s31, v228
    v_addc_co_u32 v229, vcc, 0, v229, vcc
    v_add_co_u32 v230, vcc, s31, v230
    v_addc_co_u32 v231, vcc, 0, v231, vcc
    s_barrier
    ds_read_b128 v[128:131], v235 offset:0
    ds_read_b128 v[132:135], v235 offset:2048
    ds_read_b128 v[136:139], v235 offset:4096
    ds_read_b128 v[140:143], v235 offset:6144
    ds_read_b64_tr_b16 v[160:161], v237 offset:0
    ds_read_b64_tr_b16 v[162:163], v237 offset:1024
    ds_read_b64_tr_b16 v[164:165], v238 offset:0
    ds_read_b64_tr_b16 v[166:167], v238 offset:1024
    ds_read_b64_tr_b16 v[168:169], v239 offset:0
    ds_read_b64_tr_b16 v[170:171], v239 offset:1024
    ds_read_b64_tr_b16 v[172:173], v240 offset:0
    ds_read_b64_tr_b16 v[174:175], v240 offset:1024
    ds_read_b128 v[144:147], v236 offset:0
    ds_read_b128 v[148:151], v236 offset:2048
    ds_read_b128 v[152:155], v236 offset:4096
    ds_read_b128 v[156:159], v236 offset:6144
    ds_read_b64_tr_b16 v[176:177], v237 offset:8192
    ds_read_b64_tr_b16 v[178:179], v237 offset:9216
    ds_read_b64_tr_b16 v[180:181], v238 offset:8192
    ds_read_b64_tr_b16 v[182:183], v238 offset:9216
    ds_read_b64_tr_b16 v[184:185], v239 offset:8192
    ds_read_b64_tr_b16 v[186:187], v239 offset:9216
    ds_read_b64_tr_b16 v[188:189], v240 offset:8192
    ds_read_b64_tr_b16 v[190:191], v240 offset:9216
    s_waitcnt lgkmcnt(12)
    v_mfma_f32_16x16x32_bf16 v[64:67], v[160:163], v[128:131], v[64:67]
    v_mfma_f32_16x16x32_bf16 v[68:71], v[160:163], v[132:135], v[68:71]
    v_mfma_f32_16x16x32_bf16 v[72:75], v[160:163], v[136:139], v[72:75]
    v_mfma_f32_16x16x32_bf16 v[76:79], v[160:163], v[140:143], v[76:79]
    v_mfma_f32_16x16x32_bf16 v[80:83], v[164:167], v[128:131], v[80:83]
    v_mfma_f32_16x16x32_bf16 v[84:87], v[164:167], v[132:135], v[84:87]
    v_mfma_f32_16x16x32_bf16 v[88:91], v[164:167], v[136:139], v[88:91]
    v_mfma_f32_16x16x32_bf16 v[92:95], v[164:167], v[140:143], v[92:95]
    v_mfma_f32_16x16x32_bf16 v[96:99], v[168:171], v[128:131], v[96:99]
    v_mfma_f32_16x16x32_bf16 v[100:103], v[168:171], v[132:135], v[100:103]
    v_mfma_f32_16x16x32_bf16 v[104:107], v[168:171], v[136:139], v[104:107]
    v_mfma_f32_16x16x32_bf16 v[108:111], v[168:171], v[140:143], v[108:111]
    v_mfma_f32_16x16x32_bf16 v[112:115], v[172:175], v[128:131], v[112:115]
    v_mfma_f32_16x16x32_bf16 v[116:119], v[172:175], v[132:135], v[116:119]
    v_mfma_f32_16x16x32_bf16 v[120:123], v[172:175], v[136:139], v[120:123]
    v_mfma_f32_16x16x32_bf16 v[124:127], v[172:175], v[140:143], v[124:127]
    s_waitcnt lgkmcnt(0)
    v_mfma_f32_16x16x32_bf16 v[64:67], v[176:179], v[144:147], v[64:67]
    v_mfma_f32_16x16x32_bf16 v[68:71], v[176:179], v[148:151], v[68:71]
    v_mfma_f32_16x16x32_bf16 v[72:75], v[176:179], v[152:155], v[72:75]
    v_mfma_f32_16x16x32_bf16 v[76:79], v[176:179], v[156:159], v[76:79]
    v_mfma_f32_16x16x32_bf16 v[80:83], v[180:183], v[144:147], v[80:83]
    v_mfma_f32_16x16x32_bf16 v[84:87], v[180:183], v[148:151], v[84:87]
    v_mfma_f32_16x16x32_bf16 v[88:91], v[180:183], v[152:155], v[88:91]
    v_mfma_f32_16x16x32_bf16 v[92:95], v[180:183], v[156:159], v[92:95]
    v_mfma_f32_16x16x32_bf16 v[96:99], v[184:187], v[144:147], v[96:99]
    v_mfma_f32_16x16x32_bf16 v[100:103], v[184:187], v[148:151], v[100:103]
    v_mfma_f32_16x16x32_bf16 v[104:107], v[184:187], v[152:155], v[104:107]
    v_mfma_f32_16x16x32_bf16 v[108:111], v[184:187], v[156:159], v[108:111]
    v_mfma_f32_16x16x32_bf16 v[112:115], v[188:191], v[144:147], v[112:115]
    v_mfma_f32_16x16x32_bf16 v[116:119], v[188:191], v[148:151], v[116:119]
    v_mfma_f32_16x16x32_bf16 v[120:123], v[188:191], v[152:155], v[120:123]
    v_mfma_f32_16x16x32_bf16 v[124:127], v[188:191], v[156:159], v[124:127]
    s_waitcnt vmcnt(8)
    ds_write_b128 v233, v[32:35] offset:16384
    ds_write_b128 v233, v[36:39] offset:20480
    ds_write_b128 v233, v[40:43] offset:24576
    ds_write_b128 v233, v[44:47] offset:28672
    ds_write_b128 v234, v[48:51] offset:16384
    ds_write_b128 v234, v[52:55] offset:20480
    ds_write_b128 v234, v[56:59] offset:24576
    ds_write_b128 v234, v[60:63] offset:28672
    s_waitcnt lgkmcnt(0)
    buffer_load_dwordx4 v[32:35], v232, s[16:19], s24 offen offset:896
    buffer_load_dwordx4 v[36:39], v232, s[16:19], s25 offen offset:896
    buffer_load_dwordx4 v[40:43], v232, s[16:19], s26 offen offset:896
    buffer_load_dwordx4 v[44:47], v232, s[16:19], s27 offen offset:896
    global_load_dwordx4 v[48:51], v[224:225], off
    global_load_dwordx4 v[52:55], v[226:227], off
    global_load_dwordx4 v[56:59], v[228:229], off
    global_load_dwordx4 v[60:63], v[230:231], off
    v_add_co_u32 v224, vcc, s31, v224
    v_addc_co_u32 v225, vcc, 0, v225, vcc
    v_add_co_u32 v226, vcc, s31, v226
    v_addc_co_u32 v227, vcc, 0, v227, vcc
    v_add_co_u32 v228, vcc, s31, v228
    v_addc_co_u32 v229, vcc, 0, v229, vcc
    v_add_co_u32 v230, vcc, s31, v230
    v_addc_co_u32 v231, vcc, 0, v231, vcc
    s_barrier
    ds_read_b128 v[128:131], v235 offset:16384
    ds_read_b128 v[132:135], v235 offset:18432
    ds_read_b128 v[136:139], v235 offset:20480
    ds_read_b128 v[140:143], v235 offset:22528
    ds_read_b64_tr_b16 v[160:161], v237 offset:16384
    ds_read_b64_tr_b16 v[162:163], v237 offset:17408
    ds_read_b64_tr_b16 v[164:165], v238 offset:16384
    ds_read_b64_tr_b16 v[166:167], v238 offset:17408
    ds_read_b64_tr_b16 v[168:169], v239 offset:16384
    ds_read_b64_tr_b16 v[170:171], v239 offset:17408
    ds_read_b64_tr_b16 v[172:173], v240 offset:16384
    ds_read_b64_tr_b16 v[174:175], v240 offset:17408
    ds_read_b128 v[144:147], v236 offset:16384
    ds_read_b128 v[148:151], v236 offset:18432
    ds_read_b128 v[152:155], v236 offset:20480
    ds_read_b128 v[156:159], v236 offset:22528
    ds_read_b64_tr_b16 v[176:177], v237 offset:24576
    ds_read_b64_tr_b16 v[178:179], v237 offset:25600
    ds_read_b64_tr_b16 v[180:181], v238 offset:24576
    ds_read_b64_tr_b16 v[182:183], v238 offset:25600
    ds_read_b64_tr_b16 v[184:185], v239 offset:24576
    ds_read_b64_tr_b16 v[186:187], v239 offset:25600
    ds_read_b64_tr_b16 v[188:189], v240 offset:24576
    ds_read_b64_tr_b16 v[190:191], v240 offset:25600
    s_waitcnt lgkmcnt(12)
    v_mfma_f32_16x16x32_bf16 v[64:67], v[160:163], v[128:131], v[64:67]
    v_mfma_f32_16x16x32_bf16 v[68:71], v[160:163], v[132:135], v[68:71]
    v_mfma_f32_16x16x32_bf16 v[72:75], v[160:163], v[136:139], v[72:75]
    v_mfma_f32_16x16x32_bf16 v[76:79], v[160:163], v[140:143], v[76:79]
    v_mfma_f32_16x16x32_bf16 v[80:83], v[164:167], v[128:131], v[80:83]
    v_mfma_f32_16x16x32_bf16 v[84:87], v[164:167], v[132:135], v[84:87]
    v_mfma_f32_16x16x32_bf16 v[88:91], v[164:167], v[136:139], v[88:91]
    v_mfma_f32_16x16x32_bf16 v[92:95], v[164:167], v[140:143], v[92:95]
    v_mfma_f32_16x16x32_bf16 v[96:99], v[168:171], v[128:131], v[96:99]
    v_mfma_f32_16x16x32_bf16 v[100:103], v[168:171], v[132:135], v[100:103]
    v_mfma_f32_16x16x32_bf16 v[104:107], v[168:171], v[136:139], v[104:107]
    v_mfma_f32_16x16x32_bf16 v[108:111], v[168:171], v[140:143], v[108:111]
    v_mfma_f32_16x16x32_bf16 v[112:115], v[172:175], v[128:131], v[112:115]
    v_mfma_f32_16x16x32_bf16 v[116:119], v[172:175], v[132:135], v[116:119]
    v_mfma_f32_16x16x32_bf16 v[120:123], v[172:175], v[136:139], v[120:123]
    v_mfma_f32_16x16x32_bf16 v[124:127], v[172:175], v[140:143], v[124:127]
    s_waitcnt lgkmcnt(0)
    v_mfma_f32_16x16x32_bf16 v[64:67], v[176:179], v[144:147], v[64:67]
    v_mfma_f32_16x16x32_bf16 v[68:71], v[176:179], v[148:151], v[68:71]
    v_mfma_f32_16x16x32_bf16 v[72:75], v[176:179], v[152:155], v[72:75]
    v_mfma_f32_16x16x32_bf16 v[76:79], v[176:179], v[156:159], v[76:79]
    v_mfma_f32_16x16x32_bf16 v[80:83], v[180:183], v[144:147], v[80:83]
    v_mfma_f32_16x16x32_bf16 v[84:87], v[180:183], v[148:151], v[84:87]
    v_mfma_f32_16x16x32_bf16 v[88:91], v[180:183], v[152:155], v[88:91]
    v_mfma_f32_16x16x32_bf16 v[92:95], v[180:183], v[156:159], v[92:95]
    v_mfma_f32_16x16x32_bf16 v[96:99], v[184:187], v[144:147], v[96:99]
    v_mfma_f32_16x16x32_bf16 v[100:103], v[184:187], v[148:151], v[100:103]
    v_mfma_f32_16x16x32_bf16 v[104:107], v[184:187], v[152:155], v[104:107]
    v_mfma_f32_16x16x32_bf16 v[108:111], v[184:187], v[156:159], v[108:111]
    v_mfma_f32_16x16x32_bf16 v[112:115], v[188:191], v[144:147], v[112:115]
    v_mfma_f32_16x16x32_bf16 v[116:119], v[188:191], v[148:151], v[116:119]
    v_mfma_f32_16x16x32_bf16 v[120:123], v[188:191], v[152:155], v[120:123]
    v_mfma_f32_16x16x32_bf16 v[124:127], v[188:191], v[156:159], v[124:127]
    s_waitcnt vmcnt(8)
    ds_write_b128 v233, v[192:195] offset:0
    ds_write_b128 v233, v[196:199] offset:4096
    ds_write_b128 v233, v[200:203] offset:8192
    ds_write_b128 v233, v[204:207] offset:12288
    ds_write_b128 v234, v[208:211] offset:0
    ds_write_b128 v234, v[212:215] offset:4096
    ds_write_b128 v234, v[216:219] offset:8192
    ds_write_b128 v234, v[220:223] offset:12288
    s_waitcnt lgkmcnt(0)
    s_barrier
    ds_read_b128 v[128:131], v235 offset:0
    ds_read_b128 v[132:135], v235 offset:2048
    ds_read_b128 v[136:139], v235 offset:4096
    ds_read_b128 v[140:143], v235 offset:6144
    ds_read_b64_tr_b16 v[160:161], v237 offset:0
    ds_read_b64_tr_b16 v[162:163], v237 offset:1024
    ds_read_b64_tr_b16 v[164:165], v238 offset:0
    ds_read_b64_tr_b16 v[166:167], v238 offset:1024
    ds_read_b64_tr_b16 v[168:169], v239 offset:0
    ds_read_b64_tr_b16 v[170:171], v239 offset:1024
    ds_read_b64_tr_b16 v[172:173], v240 offset:0
    ds_read_b64_tr_b16 v[174:175], v240 offset:1024
    ds_read_b128 v[144:147], v236 offset:0
    ds_read_b128 v[148:151], v236 offset:2048
    ds_read_b128 v[152:155], v236 offset:4096
    ds_read_b128 v[156:159], v236 offset:6144
    ds_read_b64_tr_b16 v[176:177], v237 offset:8192
    ds_read_b64_tr_b16 v[178:179], v237 offset:9216
    ds_read_b64_tr_b16 v[180:181], v238 offset:8192
    ds_read_b64_tr_b16 v[182:183], v238 offset:9216
    ds_read_b64_tr_b16 v[184:185], v239 offset:8192
    ds_read_b64_tr_b16 v[186:187], v239 offset:9216
    ds_read_b64_tr_b16 v[188:189], v240 offset:8192
    ds_read_b64_tr_b16 v[190:191], v240 offset:9216
    s_waitcnt lgkmcnt(12)
    v_mfma_f32_16x16x32_bf16 v[64:67], v[160:163], v[128:131], v[64:67]
    v_mfma_f32_16x16x32_bf16 v[68:71], v[160:163], v[132:135], v[68:71]
    v_mfma_f32_16x16x32_bf16 v[72:75], v[160:163], v[136:139], v[72:75]
    v_mfma_f32_16x16x32_bf16 v[76:79], v[160:163], v[140:143], v[76:79]
    v_mfma_f32_16x16x32_bf16 v[80:83], v[164:167], v[128:131], v[80:83]
    v_mfma_f32_16x16x32_bf16 v[84:87], v[164:167], v[132:135], v[84:87]
    v_mfma_f32_16x16x32_bf16 v[88:91], v[164:167], v[136:139], v[88:91]
    v_mfma_f32_16x16x32_bf16 v[92:95], v[164:167], v[140:143], v[92:95]
    v_mfma_f32_16x16x32_bf16 v[96:99], v[168:171], v[128:131], v[96:99]
    v_mfma_f32_16x16x32_bf16 v[100:103], v[168:171], v[132:135], v[100:103]
    v_mfma_f32_16x16x32_bf16 v[104:107], v[168:171], v[136:139], v[104:107]
    v_mfma_f32_16x16x32_bf16 v[108:111], v[168:171], v[140:143], v[108:111]
    v_mfma_f32_16x16x32_bf16 v[112:115], v[172:175], v[128:131], v[112:115]
    v_mfma_f32_16x16x32_bf16 v[116:119], v[172:175], v[132:135], v[116:119]
    v_mfma_f32_16x16x32_bf16 v[120:123], v[172:175], v[136:139], v[120:123]
    v_mfma_f32_16x16x32_bf16 v[124:127], v[172:175], v[140:143], v[124:127]
    s_waitcnt lgkmcnt(0)
    v_mfma_f32_16x16x32_bf16 v[64:67], v[176:179], v[144:147], v[64:67]
    v_mfma_f32_16x16x32_bf16 v[68:71], v[176:179], v[148:151], v[68:71]
    v_mfma_f32_16x16x32_bf16 v[72:75], v[176:179], v[152:155], v[72:75]
    v_mfma_f32_16x16x32_bf16 v[76:79], v[176:179], v[156:159], v[76:79]
    v_mfma_f32_16x16x32_bf16 v[80:83], v[180:183], v[144:147], v[80:83]
    v_mfma_f32_16x16x32_bf16 v[84:87], v[180:183], v[148:151], v[84:87]
    v_mfma_f32_16x16x32_bf16 v[88:91], v[180:183], v[152:155], v[88:91]
    v_mfma_f32_16x16x32_bf16 v[92:95], v[180:183], v[156:159], v[92:95]
    v_mfma_f32_16x16x32_bf16 v[96:99], v[184:187], v[144:147], v[96:99]
    v_mfma_f32_16x16x32_bf16 v[100:103], v[184:187], v[148:151], v[100:103]
    v_mfma_f32_16x16x32_bf16 v[104:107], v[184:187], v[152:155], v[104:107]
    v_mfma_f32_16x16x32_bf16 v[108:111], v[184:187], v[156:159], v[108:111]
    v_mfma_f32_16x16x32_bf16 v[112:115], v[188:191], v[144:147], v[112:115]
    v_mfma_f32_16x16x32_bf16 v[116:119], v[188:191], v[148:151], v[116:119]
    v_mfma_f32_16x16x32_bf16 v[120:123], v[188:191], v[152:155], v[120:123]
    v_mfma_f32_16x16x32_bf16 v[124:127], v[188:191], v[156:159], v[124:127]
    s_waitcnt vmcnt(0)
    ds_write_b128 v233, v[32:35] offset:16384
    ds_write_b128 v233, v[36:39] offset:20480
    ds_write_b128 v233, v[40:43] offset:24576
    ds_write_b128 v233, v[44:47] offset:28672
    ds_write_b128 v234, v[48:51] offset:16384
    ds_write_b128 v234, v[52:55] offset:20480
    ds_write_b128 v234, v[56:59] offset:24576
    ds_write_b128 v234, v[60:63] offset:28672
    s_waitcnt lgkmcnt(0)
    s_barrier
    ds_read_b128 v[128:131], v235 offset:16384
    ds_read_b128 v[132:135], v235 offset:18432
    ds_read_b128 v[136:139], v235 offset:20480
    ds_read_b128 v[140:143], v235 offset:22528
    ds_read_b64_tr_b16 v[160:161], v237 offset:16384
    ds_read_b64_tr_b16 v[162:163], v237 offset:17408
    ds_read_b64_tr_b16 v[164:165], v238 offset:16384
    ds_read_b64_tr_b16 v[166:167], v238 offset:17408
    ds_read_b64_tr_b16 v[168:169], v239 offset:16384
    ds_read_b64_tr_b16 v[170:171], v239 offset:17408
    ds_read_b64_tr_b16 v[172:173], v240 offset:16384
    ds_read_b64_tr_b16 v[174:175], v240 offset:17408
    ds_read_b128 v[144:147], v236 offset:16384
    ds_read_b128 v[148:151], v236 offset:18432
    ds_read_b128 v[152:155], v236 offset:20480
    ds_read_b128 v[156:159], v236 offset:22528
    ds_read_b64_tr_b16 v[176:177], v237 offset:24576
    ds_read_b64_tr_b16 v[178:179], v237 offset:25600
    ds_read_b64_tr_b16 v[180:181], v238 offset:24576
    ds_read_b64_tr_b16 v[182:183], v238 offset:25600
    ds_read_b64_tr_b16 v[184:185], v239 offset:24576
    ds_read_b64_tr_b16 v[186:187], v239 offset:25600
    ds_read_b64_tr_b16 v[188:189], v240 offset:24576
    ds_read_b64_tr_b16 v[190:191], v240 offset:25600
    s_waitcnt lgkmcnt(12)
    v_mfma_f32_16x16x32_bf16 v[64:67], v[160:163], v[128:131], v[64:67]
    v_mfma_f32_16x16x32_bf16 v[68:71], v[160:163], v[132:135], v[68:71]
    v_mfma_f32_16x16x32_bf16 v[72:75], v[160:163], v[136:139], v[72:75]
    v_mfma_f32_16x16x32_bf16 v[76:79], v[160:163], v[140:143], v[76:79]
    v_mfma_f32_16x16x32_bf16 v[80:83], v[164:167], v[128:131], v[80:83]
    v_mfma_f32_16x16x32_bf16 v[84:87], v[164:167], v[132:135], v[84:87]
    v_mfma_f32_16x16x32_bf16 v[88:91], v[164:167], v[136:139], v[88:91]
    v_mfma_f32_16x16x32_bf16 v[92:95], v[164:167], v[140:143], v[92:95]
    v_mfma_f32_16x16x32_bf16 v[96:99], v[168:171], v[128:131], v[96:99]
    v_mfma_f32_16x16x32_bf16 v[100:103], v[168:171], v[132:135], v[100:103]
    v_mfma_f32_16x16x32_bf16 v[104:107], v[168:171], v[136:139], v[104:107]
    v_mfma_f32_16x16x32_bf16 v[108:111], v[168:171], v[140:143], v[108:111]
    v_mfma_f32_16x16x32_bf16 v[112:115], v[172:175], v[128:131], v[112:115]
    v_mfma_f32_16x16x32_bf16 v[116:119], v[172:175], v[132:135], v[116:119]
    v_mfma_f32_16x16x32_bf16 v[120:123], v[172:175], v[136:139], v[120:123]
    v_mfma_f32_16x16x32_bf16 v[124:127], v[172:175], v[140:143], v[124:127]
    s_waitcnt lgkmcnt(0)
    v_mfma_f32_16x16x32_bf16 v[64:67], v[176:179], v[144:147], v[64:67]
    v_mfma_f32_16x16x32_bf16 v[68:71], v[176:179], v[148:151], v[68:71]
    v_mfma_f32_16x16x32_bf16 v[72:75], v[176:179], v[152:155], v[72:75]
    v_mfma_f32_16x16x32_bf16 v[76:79], v[176:179], v[156:159], v[76:79]
    v_mfma_f32_16x16x32_bf16 v[80:83], v[180:183], v[144:147], v[80:83]
    v_mfma_f32_16x16x32_bf16 v[84:87], v[180:183], v[148:151], v[84:87]
    v_mfma_f32_16x16x32_bf16 v[88:91], v[180:183], v[152:155], v[88:91]
    v_mfma_f32_16x16x32_bf16 v[92:95], v[180:183], v[156:159], v[92:95]
    v_mfma_f32_16x16x32_bf16 v[96:99], v[184:187], v[144:147], v[96:99]
    v_mfma_f32_16x16x32_bf16 v[100:103], v[184:187], v[148:151], v[100:103]
    v_mfma_f32_16x16x32_bf16 v[104:107], v[184:187], v[152:155], v[104:107]
    v_mfma_f32_16x16x32_bf16 v[108:111], v[184:187], v[156:159], v[108:111]
    v_mfma_f32_16x16x32_bf16 v[112:115], v[188:191], v[144:147], v[112:115]
    v_mfma_f32_16x16x32_bf16 v[116:119], v[188:191], v[148:151], v[116:119]
    v_mfma_f32_16x16x32_bf16 v[120:123], v[188:191], v[152:155], v[120:123]
    v_mfma_f32_16x16x32_bf16 v[124:127], v[188:191], v[156:159], v[124:127]
    s_barrier
    s_nop 7
    s_nop 7
    s_cmp_lt_u32 s29, 12
    s_cbranch_scc1 K1_EPI_Q
    v_lshrrev_b32 v3, 1, v2
    v_lshlrev_b32 v3, 6, v3
    v_and_b32 v4, 15, v1
    v_add_u32 v3, v3, v4
    s_lshl_b32 s32, s28, 7
    v_add_u32 v3, s32, v3
    s_mov_b32 s36, 3584
    v_mul_lo_u32 v3, v3, s36
    v_and_b32 v4, 1, v2
    v_lshlrev_b32 v4, 6, v4
    v_lshrrev_b32 v5, 4, v1
    v_lshlrev_b32 v5, 3, v5
    v_add3_u32 v3, v3, v4, v5
    s_lshl_b32 s32, s33, 7
    s_add_u32 s32, s32, 6291456
    v_cvt_pk_bf16_f32 v5, v64, v65
    v_lshlrev_b32 v64, 16, v5
    v_and_b32 v65, 0xffff0000, v5
    v_cvt_pk_bf16_f32 v5, v66, v67
    v_lshlrev_b32 v66, 16, v5
    v_and_b32 v67, 0xffff0000, v5
    v_cvt_pk_bf16_f32 v5, v96, v97
    v_lshlrev_b32 v96, 16, v5
    v_and_b32 v97, 0xffff0000, v5
    v_cvt_pk_bf16_f32 v5, v98, v99
    v_lshlrev_b32 v98, 16, v5
    v_and_b32 v99, 0xffff0000, v5
    v_max_f32 v64, 0, v64
    v_mul_f32 v64, v64, v96
    v_max_f32 v65, 0, v65
    v_mul_f32 v65, v65, v97
    v_max_f32 v66, 0, v66
    v_mul_f32 v66, v66, v98
    v_max_f32 v67, 0, v67
    v_mul_f32 v67, v67, v99
    v_cvt_pk_bf16_f32 v6, v64, v65
    v_cvt_pk_bf16_f32 v7, v66, v67
    buffer_store_dwordx2 v[6:7], v3, s[16:19], s32 offen offset:0
    v_cvt_pk_bf16_f32 v5, v80, v81
    v_lshlrev_b32 v80, 16, v5
    v_and_b32 v81, 0xffff0000, v5
    v_cvt_pk_bf16_f32 v5, v82, v83
    v_lshlrev_b32 v82, 16, v5
    v_and_b32 v83, 0xffff0000, v5
    v_cvt_pk_bf16_f32 v5, v112, v113
    v_lshlrev_b32 v112, 16, v5
    v_and_b32 v113, 0xffff0000, v5
    v_cvt_pk_bf16_f32 v5, v114, v115
    v_lshlrev_b32 v114, 16, v5
    v_and_b32 v115, 0xffff0000, v5
    v_max_f32 v80, 0, v80
    v_mul_f32 v80, v80, v112
    v_max_f32 v81, 0, v81
    v_mul_f32 v81, v81, v113
    v_max_f32 v82, 0, v82
    v_mul_f32 v82, v82, v114
    v_max_f32 v83, 0, v83
    v_mul_f32 v83, v83, v115
    v_cvt_pk_bf16_f32 v6, v80, v81
    v_cvt_pk_bf16_f32 v7, v82, v83
    buffer_store_dwordx2 v[6:7], v3, s[16:19], s32 offen offset:32
    v_add_u32 v3, 57344, v3
    v_cvt_pk_bf16_f32 v5, v68, v69
    v_lshlrev_b32 v68, 16, v5
    v_and_b32 v69, 0xffff0000, v5
    v_cvt_pk_bf16_f32 v5, v70, v71
    v_lshlrev_b32 v70, 16, v5
    v_and_b32 v71, 0xffff0000, v5
    v_cvt_pk_bf16_f32 v5, v100, v101
    v_lshlrev_b32 v100, 16, v5
    v_and_b32 v101, 0xffff0000, v5
    v_cvt_pk_bf16_f32 v5, v102, v103
    v_lshlrev_b32 v102, 16, v5
    v_and_b32 v103, 0xffff0000, v5
    v_max_f32 v68, 0, v68
    v_mul_f32 v68, v68, v100
    v_max_f32 v69, 0, v69
    v_mul_f32 v69, v69, v101
    v_max_f32 v70, 0, v70
    v_mul_f32 v70, v70, v102
    v_max_f32 v71, 0, v71
    v_mul_f32 v71, v71, v103
    v_cvt_pk_bf16_f32 v6, v68, v69
    v_cvt_pk_bf16_f32 v7, v70, v71
    buffer_store_dwordx2 v[6:7], v3, s[16:19], s32 offen offset:0
    v_cvt_pk_bf16_f32 v5, v84, v85
    v_lshlrev_b32 v84, 16, v5
    v_and_b32 v85, 0xffff0000, v5
    v_cvt_pk_bf16_f32 v5, v86, v87
    v_lshlrev_b32 v86, 16, v5
    v_and_b32 v87, 0xffff0000, v5
    v_cvt_pk_bf16_f32 v5, v116, v117
    v_lshlrev_b32 v116, 16, v5
    v_and_b32 v117, 0xffff0000, v5
    v_cvt_pk_bf16_f32 v5, v118, v119
    v_lshlrev_b32 v118, 16, v5
    v_and_b32 v119, 0xffff0000, v5
    v_max_f32 v84, 0, v84
    v_mul_f32 v84, v84, v116
    v_max_f32 v85, 0, v85
    v_mul_f32 v85, v85, v117
    v_max_f32 v86, 0, v86
    v_mul_f32 v86, v86, v118
    v_max_f32 v87, 0, v87
    v_mul_f32 v87, v87, v119
    v_cvt_pk_bf16_f32 v6, v84, v85
    v_cvt_pk_bf16_f32 v7, v86, v87
    buffer_store_dwordx2 v[6:7], v3, s[16:19], s32 offen offset:32
    v_add_u32 v3, 57344, v3
    v_cvt_pk_bf16_f32 v5, v72, v73
    v_lshlrev_b32 v72, 16, v5
    v_and_b32 v73, 0xffff0000, v5
    v_cvt_pk_bf16_f32 v5, v74, v75
    v_lshlrev_b32 v74, 16, v5
    v_and_b32 v75, 0xffff0000, v5
    v_cvt_pk_bf16_f32 v5, v104, v105
    v_lshlrev_b32 v104, 16, v5
    v_and_b32 v105, 0xffff0000, v5
    v_cvt_pk_bf16_f32 v5, v106, v107
    v_lshlrev_b32 v106, 16, v5
    v_and_b32 v107, 0xffff0000, v5
    v_max_f32 v72, 0, v72
    v_mul_f32 v72, v72, v104
    v_max_f32 v73, 0, v73
    v_mul_f32 v73, v73, v105
    v_max_f32 v74, 0, v74
    v_mul_f32 v74, v74, v106
    v_max_f32 v75, 0, v75
    v_mul_f32 v75, v75, v107
    v_cvt_pk_bf16_f32 v6, v72, v73
    v_cvt_pk_bf16_f32 v7, v74, v75
    buffer_store_dwordx2 v[6:7], v3, s[16:19], s32 offen offset:0
    v_cvt_pk_bf16_f32 v5, v88, v89
    v_lshlrev_b32 v88, 16, v5
    v_and_b32 v89, 0xffff0000, v5
    v_cvt_pk_bf16_f32 v5, v90, v91
    v_lshlrev_b32 v90, 16, v5
    v_and_b32 v91, 0xffff0000, v5
    v_cvt_pk_bf16_f32 v5, v120, v121
    v_lshlrev_b32 v120, 16, v5
    v_and_b32 v121, 0xffff0000, v5
    v_cvt_pk_bf16_f32 v5, v122, v123
    v_lshlrev_b32 v122, 16, v5
    v_and_b32 v123, 0xffff0000, v5
    v_max_f32 v88, 0, v88
    v_mul_f32 v88, v88, v120
    v_max_f32 v89, 0, v89
    v_mul_f32 v89, v89, v121
    v_max_f32 v90, 0, v90
    v_mul_f32 v90, v90, v122
    v_max_f32 v91, 0, v91
    v_mul_f32 v91, v91, v123
    v_cvt_pk_bf16_f32 v6, v88, v89
    v_cvt_pk_bf16_f32 v7, v90, v91
    buffer_store_dwordx2 v[6:7], v3, s[16:19], s32 offen offset:32
    v_add_u32 v3, 57344, v3
    v_cvt_pk_bf16_f32 v5, v76, v77
    v_lshlrev_b32 v76, 16, v5
    v_and_b32 v77, 0xffff0000, v5
    v_cvt_pk_bf16_f32 v5, v78, v79
    v_lshlrev_b32 v78, 16, v5
    v_and_b32 v79, 0xffff0000, v5
    v_cvt_pk_bf16_f32 v5, v108, v109
    v_lshlrev_b32 v108, 16, v5
    v_and_b32 v109, 0xffff0000, v5
    v_cvt_pk_bf16_f32 v5, v110, v111
    v_lshlrev_b32 v110, 16, v5
    v_and_b32 v111, 0xffff0000, v5
    v_max_f32 v76, 0, v76
    v_mul_f32 v76, v76, v108
    v_max_f32 v77, 0, v77
    v_mul_f32 v77, v77, v109
    v_max_f32 v78, 0, v78
    v_mul_f32 v78, v78, v110
    v_max_f32 v79, 0, v79
    v_mul_f32 v79, v79, v111
    v_cvt_pk_bf16_f32 v6, v76, v77
    v_cvt_pk_bf16_f32 v7, v78, v79
    buffer_store_dwordx2 v[6:7], v3, s[16:19], s32 offen offset:0
    v_cvt_pk_bf16_f32 v5, v92, v93
    v_lshlrev_b32 v92, 16, v5
    v_and_b32 v93, 0xffff0000, v5
    v_cvt_pk_bf16_f32 v5, v94, v95
    v_lshlrev_b32 v94, 16, v5
    v_and_b32 v95, 0xffff0000, v5
    v_cvt_pk_bf16_f32 v5, v124, v125
    v_lshlrev_b32 v124, 16, v5
    v_and_b32 v125, 0xffff0000, v5
    v_cvt_pk_bf16_f32 v5, v126, v127
    v_lshlrev_b32 v126, 16, v5
    v_and_b32 v127, 0xffff0000, v5
    v_max_f32 v92, 0, v92
    v_mul_f32 v92, v92, v124
    v_max_f32 v93, 0, v93
    v_mul_f32 v93, v93, v125
    v_max_f32 v94, 0, v94
    v_mul_f32 v94, v94, v126
    v_max_f32 v95, 0, v95
    v_mul_f32 v95, v95, v127
    v_cvt_pk_bf16_f32 v6, v92, v93
    v_cvt_pk_bf16_f32 v7, v94, v95
    buffer_store_dwordx2 v[6:7], v3, s[16:19], s32 offen offset:32
    s_branch K1_END
K1_EPI_Q:
    v_lshrrev_b32 v3, 1, v2
    v_lshlrev_b32 v3, 6, v3
    v_and_b32 v4, 15, v1
    v_add_u32 v3, v3, v4
    s_lshl_b32 s32, s28, 7
    v_add_u32 v3, s32, v3
    v_lshlrev_b32 v3, 11, v3
    v_and_b32 v4, 1, v2
    v_lshlrev_b32 v4, 8, v4
    v_lshrrev_b32 v5, 4, v1
    v_lshlrev_b32 v5, 4, v5
    v_add3_u32 v23, v3, v4, v5
    s_lshl_b32 s32, s33, 9
    s_add_u32 s32, s32, 2097152
    v_readfirstlane_b32 s37, v2
    s_and_b32 s37, s37, 1
    s_lshl_b32 s37, s37, 2
    s_lshl_b32 s38, s33, 3
    s_add_u32 s37, s37, s38
    s_add_u32 s38, s37, 0
    s_lshl_b32 s38, s38, 9
    buffer_load_ushort v3, v22, s[20:23], s38 offen offset:0
    buffer_load_ushort v4, v22, s[20:23], s38 offen offset:32
    buffer_load_ushort v5, v22, s[20:23], s38 offen offset:64
    buffer_load_ushort v6, v22, s[20:23], s38 offen offset:96
    s_waitcnt vmcnt(0)
    v_lshl_or_b32 v24, v4, 16, v3
    v_lshl_or_b32 v25, v6, 16, v5
    v_cvt_pk_bf16_f32 v26, v64, v65
    v_cvt_pk_bf16_f32 v27, v66, v67
    s_nop 1
    v_mfma_f32_16x16x16_bf16 v[64:67], v[24:25], v[26:27], 0
    v_cvt_pk_bf16_f32 v26, v68, v69
    v_cvt_pk_bf16_f32 v27, v70, v71
    s_nop 1
    v_mfma_f32_16x16x16_bf16 v[68:71], v[24:25], v[26:27], 0
    v_cvt_pk_bf16_f32 v26, v72, v73
    v_cvt_pk_bf16_f32 v27, v74, v75
    s_nop 1
    v_mfma_f32_16x16x16_bf16 v[72:75], v[24:25], v[26:27], 0
    v_cvt_pk_bf16_f32 v26, v76, v77
    v_cvt_pk_bf16_f32 v27, v78, v79
    s_nop 1
    v_mfma_f32_16x16x16_bf16 v[76:79], v[24:25], v[26:27], 0
    s_nop 7
    s_nop 7
    v_cvt_pk_bf16_f32 v5, v64, v65
    v_lshlrev_b32 v64, 16, v5
    v_and_b32 v65, 0xffff0000, v5
    v_cvt_pk_bf16_f32 v5, v66, v67
    v_lshlrev_b32 v66, 16, v5
    v_and_b32 v67, 0xffff0000, v5
    v_cvt_pk_bf16_f32 v5, v68, v69
    v_lshlrev_b32 v68, 16, v5
    v_and_b32 v69, 0xffff0000, v5
    v_cvt_pk_bf16_f32 v5, v70, v71
    v_lshlrev_b32 v70, 16, v5
    v_and_b32 v71, 0xffff0000, v5
    v_cvt_pk_bf16_f32 v5, v72, v73
    v_lshlrev_b32 v72, 16, v5
    v_and_b32 v73, 0xffff0000, v5
    v_cvt_pk_bf16_f32 v5, v74, v75
    v_lshlrev_b32 v74, 16, v5
    v_and_b32 v75, 0xffff0000, v5
    v_cvt_pk_bf16_f32 v5, v76, v77
    v_lshlrev_b32 v76, 16, v5
    v_and_b32 v77, 0xffff0000, v5
    v_cvt_pk_bf16_f32 v5, v78, v79
    v_lshlrev_b32 v78, 16, v5
    v_and_b32 v79, 0xffff0000, v5
    v_max_f32 v32, v64, v65
    v_max3_f32 v32, v32, v66, v67
    v_min_f32 v36, v64, v65
    v_min3_f32 v36, v36, v66, v67
    v_max_f32 v33, v68, v69
    v_max3_f32 v33, v33, v70, v71
    v_min_f32 v37, v68, v69
    v_min3_f32 v37, v37, v70, v71
    v_max_f32 v34, v72, v73
    v_max3_f32 v34, v34, v74, v75
    v_min_f32 v38, v72, v73
    v_min3_f32 v38, v38, v74, v75
    v_max_f32 v35, v76, v77
    v_max3_f32 v35, v35, v78, v79
    v_min_f32 v39, v76, v77
    v_min3_f32 v39, v39, v78, v79
    ds_bpermute_b32 v40, v20, v32
    ds_bpermute_b32 v44, v20, v36
    ds_bpermute_b32 v41, v20, v33
    ds_bpermute_b32 v45, v20, v37
    ds_bpermute_b32 v42, v20, v34
    ds_bpermute_b32 v46, v20, v38
    ds_bpermute_b32 v43, v20, v35
    ds_bpermute_b32 v47, v20, v39
    s_waitcnt lgkmcnt(0)
    v_max_f32 v32, v32, v40
    v_min_f32 v36, v36, v44
    v_max_f32 v33, v33, v41
    v_min_f32 v37, v37, v45
    v_max_f32 v34, v34, v42
    v_min_f32 v38, v38, v46
    v_max_f32 v35, v35, v43
    v_min_f32 v39, v39, v47
    ds_bpermute_b32 v40, v21, v32
    ds_bpermute_b32 v44, v21, v36
    ds_bpermute_b32 v41, v21, v33
    ds_bpermute_b32 v45, v21, v37
    ds_bpermute_b32 v42, v21, v34
    ds_bpermute_b32 v46, v21, v38
    ds_bpermute_b32 v43, v21, v35
    ds_bpermute_b32 v47, v21, v39
    s_waitcnt lgkmcnt(0)
    v_max_f32 v32, v32, v40
    v_min_f32 v36, v36, v44
    v_max_f32 v33, v33, v41
    v_min_f32 v37, v37, v45
    v_max_f32 v34, v34, v42
    v_min_f32 v38, v38, v46
    v_max_f32 v35, v35, v43
    v_min_f32 v39, v39, v47
    s_mov_b32 s40, 1069066811
    v_sub_f32 v48, v36, v64
    v_mul_f32 v48, s40, v48
    v_exp_f32 v48, v48
    v_sub_f32 v64, v64, v32
    v_mul_f32 v64, s40, v64
    v_exp_f32 v64, v64
    v_sub_f32 v49, v36, v65
    v_mul_f32 v49, s40, v49
    v_exp_f32 v49, v49
    v_sub_f32 v65, v65, v32
    v_mul_f32 v65, s40, v65
    v_exp_f32 v65, v65
    v_sub_f32 v50, v36, v66
    v_mul_f32 v50, s40, v50
    v_exp_f32 v50, v50
    v_sub_f32 v66, v66, v32
    v_mul_f32 v66, s40, v66
    v_exp_f32 v66, v66
    v_sub_f32 v51, v36, v67
    v_mul_f32 v51, s40, v51
    v_exp_f32 v51, v51
    v_sub_f32 v67, v67, v32
    v_mul_f32 v67, s40, v67
    v_exp_f32 v67, v67
    v_sub_f32 v52, v37, v68
    v_mul_f32 v52, s40, v52
    v_exp_f32 v52, v52
    v_sub_f32 v68, v68, v33
    v_mul_f32 v68, s40, v68
    v_exp_f32 v68, v68
    v_sub_f32 v53, v37, v69
    v_mul_f32 v53, s40, v53
    v_exp_f32 v53, v53
    v_sub_f32 v69, v69, v33
    v_mul_f32 v69, s40, v69
    v_exp_f32 v69, v69
    v_sub_f32 v54, v37, v70
    v_mul_f32 v54, s40, v54
    v_exp_f32 v54, v54
    v_sub_f32 v70, v70, v33
    v_mul_f32 v70, s40, v70
    v_exp_f32 v70, v70
    v_sub_f32 v55, v37, v71
    v_mul_f32 v55, s40, v55
    v_exp_f32 v55, v55
    v_sub_f32 v71, v71, v33
    v_mul_f32 v71, s40, v71
    v_exp_f32 v71, v71
    v_sub_f32 v56, v38, v72
    v_mul_f32 v56, s40, v56
    v_exp_f32 v56, v56
    v_sub_f32 v72, v72, v34
    v_mul_f32 v72, s40, v72
    v_exp_f32 v72, v72
    v_sub_f32 v57, v38, v73
    v_mul_f32 v57, s40, v57
    v_exp_f32 v57, v57
    v_sub_f32 v73, v73, v34
    v_mul_f32 v73, s40, v73
    v_exp_f32 v73, v73
    v_sub_f32 v58, v38, v74
    v_mul_f32 v58, s40, v58
    v_exp_f32 v58, v58
    v_sub_f32 v74, v74, v34
    v_mul_f32 v74, s40, v74
    v_exp_f32 v74, v74
    v_sub_f32 v59, v38, v75
    v_mul_f32 v59, s40, v59
    v_exp_f32 v59, v59
    v_sub_f32 v75, v75, v34
    v_mul_f32 v75, s40, v75
    v_exp_f32 v75, v75
    v_sub_f32 v60, v39, v76
    v_mul_f32 v60, s40, v60
    v_exp_f32 v60, v60
    v_sub_f32 v76, v76, v35
    v_mul_f32 v76, s40, v76
    v_exp_f32 v76, v76
    v_sub_f32 v61, v39, v77
    v_mul_f32 v61, s40, v61
    v_exp_f32 v61, v61
    v_sub_f32 v77, v77, v35
    v_mul_f32 v77, s40, v77
    v_exp_f32 v77, v77
    v_sub_f32 v62, v39, v78
    v_mul_f32 v62, s40, v62
    v_exp_f32 v62, v62
    v_sub_f32 v78, v78, v35
    v_mul_f32 v78, s40, v78
    v_exp_f32 v78, v78
    v_sub_f32 v63, v39, v79
    v_mul_f32 v63, s40, v63
    v_exp_f32 v63, v63
    v_sub_f32 v79, v79, v35
    v_mul_f32 v79, s40, v79
    v_exp_f32 v79, v79
    s_nop 0
    v_add_f32 v32, v64, v65
    v_add_f32 v32, v32, v66
    v_add_f32 v32, v32, v67
    v_add_f32 v36, v48, v49
    v_add_f32 v36, v36, v50
    v_add_f32 v36, v36, v51
    v_add_f32 v33, v68, v69
    v_add_f32 v33, v33, v70
    v_add_f32 v33, v33, v71
    v_add_f32 v37, v52, v53
    v_add_f32 v37, v37, v54
    v_add_f32 v37, v37, v55
    v_add_f32 v34, v72, v73
    v_add_f32 v34, v34, v74
    v_add_f32 v34, v34, v75
    v_add_f32 v38, v56, v57
    v_add_f32 v38, v38, v58
    v_add_f32 v38, v38, v59
    v_add_f32 v35, v76, v77
    v_add_f32 v35, v35, v78
    v_add_f32 v35, v35, v79
    v_add_f32 v39, v60, v61
    v_add_f32 v39, v39, v62
    v_add_f32 v39, v39, v63
    ds_bpermute_b32 v40, v20, v32
    ds_bpermute_b32 v44, v20, v36
    ds_bpermute_b32 v41, v20, v33
    ds_bpermute_b32 v45, v20, v37
    ds_bpermute_b32 v42, v20, v34
    ds_bpermute_b32 v46, v20, v38
    ds_bpermute_b32 v43, v20, v35
    ds_bpermute_b32 v47, v20, v39
    s_waitcnt lgkmcnt(0)
    v_add_f32 v32, v32, v40
    v_add_f32 v36, v36, v44
    v_add_f32 v33, v33, v41
    v_add_f32 v37, v37, v45
    v_add_f32 v34, v34, v42
    v_add_f32 v38, v38, v46
    v_add_f32 v35, v35, v43
    v_add_f32 v39, v39, v47
    ds_bpermute_b32 v40, v21, v32
    ds_bpermute_b32 v44, v21, v36
    ds_bpermute_b32 v41, v21, v33
    ds_bpermute_b32 v45, v21, v37
    ds_bpermute_b32 v42, v21, v34
    ds_bpermute_b32 v46, v21, v38
    ds_bpermute_b32 v43, v21, v35
    ds_bpermute_b32 v47, v21, v39
    s_waitcnt lgkmcnt(0)
    v_add_f32 v32, v32, v40
    v_add_f32 v36, v36, v44
    v_add_f32 v33, v33, v41
    v_add_f32 v37, v37, v45
    v_add_f32 v34, v34, v42
    v_add_f32 v38, v38, v46
    v_add_f32 v35, v35, v43
    v_add_f32 v39, v39, v47
    v_rcp_f32 v32, v32
    v_rcp_f32 v36, v36
    v_rcp_f32 v33, v33
    v_rcp_f32 v37, v37
    v_rcp_f32 v34, v34
    v_rcp_f32 v38, v38
    v_rcp_f32 v35, v35
    v_rcp_f32 v39, v39
    s_nop 0
    v_mul_f32 v64, v64, v32
    v_mul_f32 v48, v48, v36
    v_mul_f32 v65, v65, v32
    v_mul_f32 v49, v49, v36
    v_mul_f32 v66, v66, v32
    v_mul_f32 v50, v50, v36
    v_mul_f32 v67, v67, v32
    v_mul_f32 v51, v51, v36
    v_cvt_pk_bf16_f32 v50, v50, v51
    v_cvt_pk_bf16_f32 v51, v48, v49
    v_cvt_pk_bf16_f32 v48, v64, v65
    v_cvt_pk_bf16_f32 v49, v66, v67
    v_mov_b32 v3, v50
    v_mov_b32 v50, v51
    v_mov_b32 v51, v3
    v_mul_f32 v68, v68, v33
    v_mul_f32 v52, v52, v37
    v_mul_f32 v69, v69, v33
    v_mul_f32 v53, v53, v37
    v_mul_f32 v70, v70, v33
    v_mul_f32 v54, v54, v37
    v_mul_f32 v71, v71, v33
    v_mul_f32 v55, v55, v37
    v_cvt_pk_bf16_f32 v54, v54, v55
    v_cvt_pk_bf16_f32 v55, v52, v53
    v_cvt_pk_bf16_f32 v52, v68, v69
    v_cvt_pk_bf16_f32 v53, v70, v71
    v_mov_b32 v3, v54
    v_mov_b32 v54, v55
    v_mov_b32 v55, v3
    v_mul_f32 v72, v72, v34
    v_mul_f32 v56, v56, v38
    v_mul_f32 v73, v73, v34
    v_mul_f32 v57, v57, v38
    v_mul_f32 v74, v74, v34
    v_mul_f32 v58, v58, v38
    v_mul_f32 v75, v75, v34
    v_mul_f32 v59, v59, v38
    v_cvt_pk_bf16_f32 v58, v58, v59
    v_cvt_pk_bf16_f32 v59, v56, v57
    v_cvt_pk_bf16_f32 v56, v72, v73
    v_cvt_pk_bf16_f32 v57, v74, v75
    v_mov_b32 v3, v58
    v_mov_b32 v58, v59
    v_mov_b32 v59, v3
    v_mul_f32 v76, v76, v35
    v_mul_f32 v60, v60, v39
    v_mul_f32 v77, v77, v35
    v_mul_f32 v61, v61, v39
    v_mul_f32 v78, v78, v35
    v_mul_f32 v62, v62, v39
    v_mul_f32 v79, v79, v35
    v_mul_f32 v63, v63, v39
    v_cvt_pk_bf16_f32 v62, v62, v63
    v_cvt_pk_bf16_f32 v63, v60, v61
    v_cvt_pk_bf16_f32 v60, v76, v77
    v_cvt_pk_bf16_f32 v61, v78, v79
    v_mov_b32 v3, v62
    v_mov_b32 v62, v63
    v_mov_b32 v63, v3
    buffer_store_dwordx4 v[48:51], v23, s[16:19], s32 offen offset:0
    v_add_u32 v23, 32768, v23
    buffer_store_dwordx4 v[52:55], v23, s[16:19], s32 offen offset:0
    v_add_u32 v23, 32768, v23
    buffer_store_dwordx4 v[56:59], v23, s[16:19], s32 offen offset:0
    v_add_u32 v23, 32768, v23
    buffer_store_dwordx4 v[60:63], v23, s[16:19], s32 offen offset:0
    v_subrev_u32 v23, 98304, v23
    s_nop 1
    s_add_u32 s38, s37, 1
    s_lshl_b32 s38, s38, 9
    buffer_load_ushort v3, v22, s[20:23], s38 offen offset:0
    buffer_load_ushort v4, v22, s[20:23], s38 offen offset:32
    buffer_load_ushort v5, v22, s[20:23], s38 offen offset:64
    buffer_load_ushort v6, v22, s[20:23], s38 offen offset:96
    s_waitcnt vmcnt(0)
    v_lshl_or_b32 v24, v4, 16, v3
    v_lshl_or_b32 v25, v6, 16, v5
    v_cvt_pk_bf16_f32 v26, v80, v81
    v_cvt_pk_bf16_f32 v27, v82, v83
    s_nop 1
    v_mfma_f32_16x16x16_bf16 v[80:83], v[24:25], v[26:27], 0
    v_cvt_pk_bf16_f32 v26, v84, v85
    v_cvt_pk_bf16_f32 v27, v86, v87
    s_nop 1
    v_mfma_f32_16x16x16_bf16 v[84:87], v[24:25], v[26:27], 0
    v_cvt_pk_bf16_f32 v26, v88, v89
    v_cvt_pk_bf16_f32 v27, v90, v91
    s_nop 1
    v_mfma_f32_16x16x16_bf16 v[88:91], v[24:25], v[26:27], 0
    v_cvt_pk_bf16_f32 v26, v92, v93
    v_cvt_pk_bf16_f32 v27, v94, v95
    s_nop 1
    v_mfma_f32_16x16x16_bf16 v[92:95], v[24:25], v[26:27], 0
    s_nop 7
    s_nop 7
    v_cvt_pk_bf16_f32 v5, v80, v81
    v_lshlrev_b32 v80, 16, v5
    v_and_b32 v81, 0xffff0000, v5
    v_cvt_pk_bf16_f32 v5, v82, v83
    v_lshlrev_b32 v82, 16, v5
    v_and_b32 v83, 0xffff0000, v5
    v_cvt_pk_bf16_f32 v5, v84, v85
    v_lshlrev_b32 v84, 16, v5
    v_and_b32 v85, 0xffff0000, v5
    v_cvt_pk_bf16_f32 v5, v86, v87
    v_lshlrev_b32 v86, 16, v5
    v_and_b32 v87, 0xffff0000, v5
    v_cvt_pk_bf16_f32 v5, v88, v89
    v_lshlrev_b32 v88, 16, v5
    v_and_b32 v89, 0xffff0000, v5
    v_cvt_pk_bf16_f32 v5, v90, v91
    v_lshlrev_b32 v90, 16, v5
    v_and_b32 v91, 0xffff0000, v5
    v_cvt_pk_bf16_f32 v5, v92, v93
    v_lshlrev_b32 v92, 16, v5
    v_and_b32 v93, 0xffff0000, v5
    v_cvt_pk_bf16_f32 v5, v94, v95
    v_lshlrev_b32 v94, 16, v5
    v_and_b32 v95, 0xffff0000, v5
    v_max_f32 v32, v80, v81
    v_max3_f32 v32, v32, v82, v83
    v_min_f32 v36, v80, v81
    v_min3_f32 v36, v36, v82, v83
    v_max_f32 v33, v84, v85
    v_max3_f32 v33, v33, v86, v87
    v_min_f32 v37, v84, v85
    v_min3_f32 v37, v37, v86, v87
    v_max_f32 v34, v88, v89
    v_max3_f32 v34, v34, v90, v91
    v_min_f32 v38, v88, v89
    v_min3_f32 v38, v38, v90, v91
    v_max_f32 v35, v92, v93
    v_max3_f32 v35, v35, v94, v95
    v_min_f32 v39, v92, v93
    v_min3_f32 v39, v39, v94, v95
    ds_bpermute_b32 v40, v20, v32
    ds_bpermute_b32 v44, v20, v36
    ds_bpermute_b32 v41, v20, v33
    ds_bpermute_b32 v45, v20, v37
    ds_bpermute_b32 v42, v20, v34
    ds_bpermute_b32 v46, v20, v38
    ds_bpermute_b32 v43, v20, v35
    ds_bpermute_b32 v47, v20, v39
    s_waitcnt lgkmcnt(0)
    v_max_f32 v32, v32, v40
    v_min_f32 v36, v36, v44
    v_max_f32 v33, v33, v41
    v_min_f32 v37, v37, v45
    v_max_f32 v34, v34, v42
    v_min_f32 v38, v38, v46
    v_max_f32 v35, v35, v43
    v_min_f32 v39, v39, v47
    ds_bpermute_b32 v40, v21, v32
    ds_bpermute_b32 v44, v21, v36
    ds_bpermute_b32 v41, v21, v33
    ds_bpermute_b32 v45, v21, v37
    ds_bpermute_b32 v42, v21, v34
    ds_bpermute_b32 v46, v21, v38
    ds_bpermute_b32 v43, v21, v35
    ds_bpermute_b32 v47, v21, v39
    s_waitcnt lgkmcnt(0)
    v_max_f32 v32, v32, v40
    v_min_f32 v36, v36, v44
    v_max_f32 v33, v33, v41
    v_min_f32 v37, v37, v45
    v_max_f32 v34, v34, v42
    v_min_f32 v38, v38, v46
    v_max_f32 v35, v35, v43
    v_min_f32 v39, v39, v47
    s_mov_b32 s40, 1069066811
    v_sub_f32 v48, v36, v80
    v_mul_f32 v48, s40, v48
    v_exp_f32 v48, v48
    v_sub_f32 v80, v80, v32
    v_mul_f32 v80, s40, v80
    v_exp_f32 v80, v80
    v_sub_f32 v49, v36, v81
    v_mul_f32 v49, s40, v49
    v_exp_f32 v49, v49
    v_sub_f32 v81, v81, v32
    v_mul_f32 v81, s40, v81
    v_exp_f32 v81, v81
    v_sub_f32 v50, v36, v82
    v_mul_f32 v50, s40, v50
    v_exp_f32 v50, v50
    v_sub_f32 v82, v82, v32
    v_mul_f32 v82, s40, v82
    v_exp_f32 v82, v82
    v_sub_f32 v51, v36, v83
    v_mul_f32 v51, s40, v51
    v_exp_f32 v51, v51
    v_sub_f32 v83, v83, v32
    v_mul_f32 v83, s40, v83
    v_exp_f32 v83, v83
    v_sub_f32 v52, v37, v84
    v_mul_f32 v52, s40, v52
    v_exp_f32 v52, v52
    v_sub_f32 v84, v84, v33
    v_mul_f32 v84, s40, v84
    v_exp_f32 v84, v84
    v_sub_f32 v53, v37, v85
    v_mul_f32 v53, s40, v53
    v_exp_f32 v53, v53
    v_sub_f32 v85, v85, v33
    v_mul_f32 v85, s40, v85
    v_exp_f32 v85, v85
    v_sub_f32 v54, v37, v86
    v_mul_f32 v54, s40, v54
    v_exp_f32 v54, v54
    v_sub_f32 v86, v86, v33
    v_mul_f32 v86, s40, v86
    v_exp_f32 v86, v86
    v_sub_f32 v55, v37, v87
    v_mul_f32 v55, s40, v55
    v_exp_f32 v55, v55
    v_sub_f32 v87, v87, v33
    v_mul_f32 v87, s40, v87
    v_exp_f32 v87, v87
    v_sub_f32 v56, v38, v88
    v_mul_f32 v56, s40, v56
    v_exp_f32 v56, v56
    v_sub_f32 v88, v88, v34
    v_mul_f32 v88, s40, v88
    v_exp_f32 v88, v88
    v_sub_f32 v57, v38, v89
    v_mul_f32 v57, s40, v57
    v_exp_f32 v57, v57
    v_sub_f32 v89, v89, v34
    v_mul_f32 v89, s40, v89
    v_exp_f32 v89, v89
    v_sub_f32 v58, v38, v90
    v_mul_f32 v58, s40, v58
    v_exp_f32 v58, v58
    v_sub_f32 v90, v90, v34
    v_mul_f32 v90, s40, v90
    v_exp_f32 v90, v90
    v_sub_f32 v59, v38, v91
    v_mul_f32 v59, s40, v59
    v_exp_f32 v59, v59
    v_sub_f32 v91, v91, v34
    v_mul_f32 v91, s40, v91
    v_exp_f32 v91, v91
    v_sub_f32 v60, v39, v92
    v_mul_f32 v60, s40, v60
    v_exp_f32 v60, v60
    v_sub_f32 v92, v92, v35
    v_mul_f32 v92, s40, v92
    v_exp_f32 v92, v92
    v_sub_f32 v61, v39, v93
    v_mul_f32 v61, s40, v61
    v_exp_f32 v61, v61
    v_sub_f32 v93, v93, v35
    v_mul_f32 v93, s40, v93
    v_exp_f32 v93, v93
    v_sub_f32 v62, v39, v94
    v_mul_f32 v62, s40, v62
    v_exp_f32 v62, v62
    v_sub_f32 v94, v94, v35
    v_mul_f32 v94, s40, v94
    v_exp_f32 v94, v94
    v_sub_f32 v63, v39, v95
    v_mul_f32 v63, s40, v63
    v_exp_f32 v63, v63
    v_sub_f32 v95, v95, v35
    v_mul_f32 v95, s40, v95
    v_exp_f32 v95, v95
    s_nop 0
    v_add_f32 v32, v80, v81
    v_add_f32 v32, v32, v82
    v_add_f32 v32, v32, v83
    v_add_f32 v36, v48, v49
    v_add_f32 v36, v36, v50
    v_add_f32 v36, v36, v51
    v_add_f32 v33, v84, v85
    v_add_f32 v33, v33, v86
    v_add_f32 v33, v33, v87
    v_add_f32 v37, v52, v53
    v_add_f32 v37, v37, v54
    v_add_f32 v37, v37, v55
    v_add_f32 v34, v88, v89
    v_add_f32 v34, v34, v90
    v_add_f32 v34, v34, v91
    v_add_f32 v38, v56, v57
    v_add_f32 v38, v38, v58
    v_add_f32 v38, v38, v59
    v_add_f32 v35, v92, v93
    v_add_f32 v35, v35, v94
    v_add_f32 v35, v35, v95
    v_add_f32 v39, v60, v61
    v_add_f32 v39, v39, v62
    v_add_f32 v39, v39, v63
    ds_bpermute_b32 v40, v20, v32
    ds_bpermute_b32 v44, v20, v36
    ds_bpermute_b32 v41, v20, v33
    ds_bpermute_b32 v45, v20, v37
    ds_bpermute_b32 v42, v20, v34
    ds_bpermute_b32 v46, v20, v38
    ds_bpermute_b32 v43, v20, v35
    ds_bpermute_b32 v47, v20, v39
    s_waitcnt lgkmcnt(0)
    v_add_f32 v32, v32, v40
    v_add_f32 v36, v36, v44
    v_add_f32 v33, v33, v41
    v_add_f32 v37, v37, v45
    v_add_f32 v34, v34, v42
    v_add_f32 v38, v38, v46
    v_add_f32 v35, v35, v43
    v_add_f32 v39, v39, v47
    ds_bpermute_b32 v40, v21, v32
    ds_bpermute_b32 v44, v21, v36
    ds_bpermute_b32 v41, v21, v33
    ds_bpermute_b32 v45, v21, v37
    ds_bpermute_b32 v42, v21, v34
    ds_bpermute_b32 v46, v21, v38
    ds_bpermute_b32 v43, v21, v35
    ds_bpermute_b32 v47, v21, v39
    s_waitcnt lgkmcnt(0)
    v_add_f32 v32, v32, v40
    v_add_f32 v36, v36, v44
    v_add_f32 v33, v33, v41
    v_add_f32 v37, v37, v45
    v_add_f32 v34, v34, v42
    v_add_f32 v38, v38, v46
    v_add_f32 v35, v35, v43
    v_add_f32 v39, v39, v47
    v_rcp_f32 v32, v32
    v_rcp_f32 v36, v36
    v_rcp_f32 v33, v33
    v_rcp_f32 v37, v37
    v_rcp_f32 v34, v34
    v_rcp_f32 v38, v38
    v_rcp_f32 v35, v35
    v_rcp_f32 v39, v39
    s_nop 0
    v_mul_f32 v80, v80, v32
    v_mul_f32 v48, v48, v36
    v_mul_f32 v81, v81, v32
    v_mul_f32 v49, v49, v36
    v_mul_f32 v82, v82, v32
    v_mul_f32 v50, v50, v36
    v_mul_f32 v83, v83, v32
    v_mul_f32 v51, v51, v36
    v_cvt_pk_bf16_f32 v50, v50, v51
    v_cvt_pk_bf16_f32 v51, v48, v49
    v_cvt_pk_bf16_f32 v48, v80, v81
    v_cvt_pk_bf16_f32 v49, v82, v83
    v_mov_b32 v3, v50
    v_mov_b32 v50, v51
    v_mov_b32 v51, v3
    v_mul_f32 v84, v84, v33
    v_mul_f32 v52, v52, v37
    v_mul_f32 v85, v85, v33
    v_mul_f32 v53, v53, v37
    v_mul_f32 v86, v86, v33
    v_mul_f32 v54, v54, v37
    v_mul_f32 v87, v87, v33
    v_mul_f32 v55, v55, v37
    v_cvt_pk_bf16_f32 v54, v54, v55
    v_cvt_pk_bf16_f32 v55, v52, v53
    v_cvt_pk_bf16_f32 v52, v84, v85
    v_cvt_pk_bf16_f32 v53, v86, v87
    v_mov_b32 v3, v54
    v_mov_b32 v54, v55
    v_mov_b32 v55, v3
    v_mul_f32 v88, v88, v34
    v_mul_f32 v56, v56, v38
    v_mul_f32 v89, v89, v34
    v_mul_f32 v57, v57, v38
    v_mul_f32 v90, v90, v34
    v_mul_f32 v58, v58, v38
    v_mul_f32 v91, v91, v34
    v_mul_f32 v59, v59, v38
    v_cvt_pk_bf16_f32 v58, v58, v59
    v_cvt_pk_bf16_f32 v59, v56, v57
    v_cvt_pk_bf16_f32 v56, v88, v89
    v_cvt_pk_bf16_f32 v57, v90, v91
    v_mov_b32 v3, v58
    v_mov_b32 v58, v59
    v_mov_b32 v59, v3
    v_mul_f32 v92, v92, v35
    v_mul_f32 v60, v60, v39
    v_mul_f32 v93, v93, v35
    v_mul_f32 v61, v61, v39
    v_mul_f32 v94, v94, v35
    v_mul_f32 v62, v62, v39
    v_mul_f32 v95, v95, v35
    v_mul_f32 v63, v63, v39
    v_cvt_pk_bf16_f32 v62, v62, v63
    v_cvt_pk_bf16_f32 v63, v60, v61
    v_cvt_pk_bf16_f32 v60, v92, v93
    v_cvt_pk_bf16_f32 v61, v94, v95
    v_mov_b32 v3, v62
    v_mov_b32 v62, v63
    v_mov_b32 v63, v3
    buffer_store_dwordx4 v[48:51], v23, s[16:19], s32 offen offset:64
    v_add_u32 v23, 32768, v23
    buffer_store_dwordx4 v[52:55], v23, s[16:19], s32 offen offset:64
    v_add_u32 v23, 32768, v23
    buffer_store_dwordx4 v[56:59], v23, s[16:19], s32 offen offset:64
    v_add_u32 v23, 32768, v23
    buffer_store_dwordx4 v[60:63], v23, s[16:19], s32 offen offset:64
    v_subrev_u32 v23, 98304, v23
    s_nop 1
    s_add_u32 s38, s37, 2
    s_lshl_b32 s38, s38, 9
    buffer_load_ushort v3, v22, s[20:23], s38 offen offset:0
    buffer_load_ushort v4, v22, s[20:23], s38 offen offset:32
    buffer_load_ushort v5, v22, s[20:23], s38 offen offset:64
    buffer_load_ushort v6, v22, s[20:23], s38 offen offset:96
    s_waitcnt vmcnt(0)
    v_lshl_or_b32 v24, v4, 16, v3
    v_lshl_or_b32 v25, v6, 16, v5
    v_cvt_pk_bf16_f32 v26, v96, v97
    v_cvt_pk_bf16_f32 v27, v98, v99
    s_nop 1
    v_mfma_f32_16x16x16_bf16 v[96:99], v[24:25], v[26:27], 0
    v_cvt_pk_bf16_f32 v26, v100, v101
    v_cvt_pk_bf16_f32 v27, v102, v103
    s_nop 1
    v_mfma_f32_16x16x16_bf16 v[100:103], v[24:25], v[26:27], 0
    v_cvt_pk_bf16_f32 v26, v104, v105
    v_cvt_pk_bf16_f32 v27, v106, v107
    s_nop 1
    v_mfma_f32_16x16x16_bf16 v[104:107], v[24:25], v[26:27], 0
    v_cvt_pk_bf16_f32 v26, v108, v109
    v_cvt_pk_bf16_f32 v27, v110, v111
    s_nop 1
    v_mfma_f32_16x16x16_bf16 v[108:111], v[24:25], v[26:27], 0
    s_nop 7
    s_nop 7
    v_cvt_pk_bf16_f32 v5, v96, v97
    v_lshlrev_b32 v96, 16, v5
    v_and_b32 v97, 0xffff0000, v5
    v_cvt_pk_bf16_f32 v5, v98, v99
    v_lshlrev_b32 v98, 16, v5
    v_and_b32 v99, 0xffff0000, v5
    v_cvt_pk_bf16_f32 v5, v100, v101
    v_lshlrev_b32 v100, 16, v5
    v_and_b32 v101, 0xffff0000, v5
    v_cvt_pk_bf16_f32 v5, v102, v103
    v_lshlrev_b32 v102, 16, v5
    v_and_b32 v103, 0xffff0000, v5
    v_cvt_pk_bf16_f32 v5, v104, v105
    v_lshlrev_b32 v104, 16, v5
    v_and_b32 v105, 0xffff0000, v5
    v_cvt_pk_bf16_f32 v5, v106, v107
    v_lshlrev_b32 v106, 16, v5
    v_and_b32 v107, 0xffff0000, v5
    v_cvt_pk_bf16_f32 v5, v108, v109
    v_lshlrev_b32 v108, 16, v5
    v_and_b32 v109, 0xffff0000, v5
    v_cvt_pk_bf16_f32 v5, v110, v111
    v_lshlrev_b32 v110, 16, v5
    v_and_b32 v111, 0xffff0000, v5
    v_max_f32 v32, v96, v97
    v_max3_f32 v32, v32, v98, v99
    v_min_f32 v36, v96, v97
    v_min3_f32 v36, v36, v98, v99
    v_max_f32 v33, v100, v101
    v_max3_f32 v33, v33, v102, v103
    v_min_f32 v37, v100, v101
    v_min3_f32 v37, v37, v102, v103
    v_max_f32 v34, v104, v105
    v_max3_f32 v34, v34, v106, v107
    v_min_f32 v38, v104, v105
    v_min3_f32 v38, v38, v106, v107
    v_max_f32 v35, v108, v109
    v_max3_f32 v35, v35, v110, v111
    v_min_f32 v39, v108, v109
    v_min3_f32 v39, v39, v110, v111
    ds_bpermute_b32 v40, v20, v32
    ds_bpermute_b32 v44, v20, v36
    ds_bpermute_b32 v41, v20, v33
    ds_bpermute_b32 v45, v20, v37
    ds_bpermute_b32 v42, v20, v34
    ds_bpermute_b32 v46, v20, v38
    ds_bpermute_b32 v43, v20, v35
    ds_bpermute_b32 v47, v20, v39
    s_waitcnt lgkmcnt(0)
    v_max_f32 v32, v32, v40
    v_min_f32 v36, v36, v44
    v_max_f32 v33, v33, v41
    v_min_f32 v37, v37, v45
    v_max_f32 v34, v34, v42
    v_min_f32 v38, v38, v46
    v_max_f32 v35, v35, v43
    v_min_f32 v39, v39, v47
    ds_bpermute_b32 v40, v21, v32
    ds_bpermute_b32 v44, v21, v36
    ds_bpermute_b32 v41, v21, v33
    ds_bpermute_b32 v45, v21, v37
    ds_bpermute_b32 v42, v21, v34
    ds_bpermute_b32 v46, v21, v38
    ds_bpermute_b32 v43, v21, v35
    ds_bpermute_b32 v47, v21, v39
    s_waitcnt lgkmcnt(0)
    v_max_f32 v32, v32, v40
    v_min_f32 v36, v36, v44
    v_max_f32 v33, v33, v41
    v_min_f32 v37, v37, v45
    v_max_f32 v34, v34, v42
    v_min_f32 v38, v38, v46
    v_max_f32 v35, v35, v43
    v_min_f32 v39, v39, v47
    s_mov_b32 s40, 1069066811
    v_sub_f32 v48, v36, v96
    v_mul_f32 v48, s40, v48
    v_exp_f32 v48, v48
    v_sub_f32 v96, v96, v32
    v_mul_f32 v96, s40, v96
    v_exp_f32 v96, v96
    v_sub_f32 v49, v36, v97
    v_mul_f32 v49, s40, v49
    v_exp_f32 v49, v49
    v_sub_f32 v97, v97, v32
    v_mul_f32 v97, s40, v97
    v_exp_f32 v97, v97
    v_sub_f32 v50, v36, v98
    v_mul_f32 v50, s40, v50
    v_exp_f32 v50, v50
    v_sub_f32 v98, v98, v32
    v_mul_f32 v98, s40, v98
    v_exp_f32 v98, v98
    v_sub_f32 v51, v36, v99
    v_mul_f32 v51, s40, v51
    v_exp_f32 v51, v51
    v_sub_f32 v99, v99, v32
    v_mul_f32 v99, s40, v99
    v_exp_f32 v99, v99
    v_sub_f32 v52, v37, v100
    v_mul_f32 v52, s40, v52
    v_exp_f32 v52, v52
    v_sub_f32 v100, v100, v33
    v_mul_f32 v100, s40, v100
    v_exp_f32 v100, v100
    v_sub_f32 v53, v37, v101
    v_mul_f32 v53, s40, v53
    v_exp_f32 v53, v53
    v_sub_f32 v101, v101, v33
    v_mul_f32 v101, s40, v101
    v_exp_f32 v101, v101
    v_sub_f32 v54, v37, v102
    v_mul_f32 v54, s40, v54
    v_exp_f32 v54, v54
    v_sub_f32 v102, v102, v33
    v_mul_f32 v102, s40, v102
    v_exp_f32 v102, v102
    v_sub_f32 v55, v37, v103
    v_mul_f32 v55, s40, v55
    v_exp_f32 v55, v55
    v_sub_f32 v103, v103, v33
    v_mul_f32 v103, s40, v103
    v_exp_f32 v103, v103
    v_sub_f32 v56, v38, v104
    v_mul_f32 v56, s40, v56
    v_exp_f32 v56, v56
    v_sub_f32 v104, v104, v34
    v_mul_f32 v104, s40, v104
    v_exp_f32 v104, v104
    v_sub_f32 v57, v38, v105
    v_mul_f32 v57, s40, v57
    v_exp_f32 v57, v57
    v_sub_f32 v105, v105, v34
    v_mul_f32 v105, s40, v105
    v_exp_f32 v105, v105
    v_sub_f32 v58, v38, v106
    v_mul_f32 v58, s40, v58
    v_exp_f32 v58, v58
    v_sub_f32 v106, v106, v34
    v_mul_f32 v106, s40, v106
    v_exp_f32 v106, v106
    v_sub_f32 v59, v38, v107
    v_mul_f32 v59, s40, v59
    v_exp_f32 v59, v59
    v_sub_f32 v107, v107, v34
    v_mul_f32 v107, s40, v107
    v_exp_f32 v107, v107
    v_sub_f32 v60, v39, v108
    v_mul_f32 v60, s40, v60
    v_exp_f32 v60, v60
    v_sub_f32 v108, v108, v35
    v_mul_f32 v108, s40, v108
    v_exp_f32 v108, v108
    v_sub_f32 v61, v39, v109
    v_mul_f32 v61, s40, v61
    v_exp_f32 v61, v61
    v_sub_f32 v109, v109, v35
    v_mul_f32 v109, s40, v109
    v_exp_f32 v109, v109
    v_sub_f32 v62, v39, v110
    v_mul_f32 v62, s40, v62
    v_exp_f32 v62, v62
    v_sub_f32 v110, v110, v35
    v_mul_f32 v110, s40, v110
    v_exp_f32 v110, v110
    v_sub_f32 v63, v39, v111
    v_mul_f32 v63, s40, v63
    v_exp_f32 v63, v63
    v_sub_f32 v111, v111, v35
    v_mul_f32 v111, s40, v111
    v_exp_f32 v111, v111
    s_nop 0
    v_add_f32 v32, v96, v97
    v_add_f32 v32, v32, v98
    v_add_f32 v32, v32, v99
    v_add_f32 v36, v48, v49
    v_add_f32 v36, v36, v50
    v_add_f32 v36, v36, v51
    v_add_f32 v33, v100, v101
    v_add_f32 v33, v33, v102
    v_add_f32 v33, v33, v103
    v_add_f32 v37, v52, v53
    v_add_f32 v37, v37, v54
    v_add_f32 v37, v37, v55
    v_add_f32 v34, v104, v105
    v_add_f32 v34, v34, v106
    v_add_f32 v34, v34, v107
    v_add_f32 v38, v56, v57
    v_add_f32 v38, v38, v58
    v_add_f32 v38, v38, v59
    v_add_f32 v35, v108, v109
    v_add_f32 v35, v35, v110
    v_add_f32 v35, v35, v111
    v_add_f32 v39, v60, v61
    v_add_f32 v39, v39, v62
    v_add_f32 v39, v39, v63
    ds_bpermute_b32 v40, v20, v32
    ds_bpermute_b32 v44, v20, v36
    ds_bpermute_b32 v41, v20, v33
    ds_bpermute_b32 v45, v20, v37
    ds_bpermute_b32 v42, v20, v34
    ds_bpermute_b32 v46, v20, v38
    ds_bpermute_b32 v43, v20, v35
    ds_bpermute_b32 v47, v20, v39
    s_waitcnt lgkmcnt(0)
    v_add_f32 v32, v32, v40
    v_add_f32 v36, v36, v44
    v_add_f32 v33, v33, v41
    v_add_f32 v37, v37, v45
    v_add_f32 v34, v34, v42
    v_add_f32 v38, v38, v46
    v_add_f32 v35, v35, v43
    v_add_f32 v39, v39, v47
    ds_bpermute_b32 v40, v21, v32
    ds_bpermute_b32 v44, v21, v36
    ds_bpermute_b32 v41, v21, v33
    ds_bpermute_b32 v45, v21, v37
    ds_bpermute_b32 v42, v21, v34
    ds_bpermute_b32 v46, v21, v38
    ds_bpermute_b32 v43, v21, v35
    ds_bpermute_b32 v47, v21, v39
    s_waitcnt lgkmcnt(0)
    v_add_f32 v32, v32, v40
    v_add_f32 v36, v36, v44
    v_add_f32 v33, v33, v41
    v_add_f32 v37, v37, v45
    v_add_f32 v34, v34, v42
    v_add_f32 v38, v38, v46
    v_add_f32 v35, v35, v43
    v_add_f32 v39, v39, v47
    v_rcp_f32 v32, v32
    v_rcp_f32 v36, v36
    v_rcp_f32 v33, v33
    v_rcp_f32 v37, v37
    v_rcp_f32 v34, v34
    v_rcp_f32 v38, v38
    v_rcp_f32 v35, v35
    v_rcp_f32 v39, v39
    s_nop 0
    v_mul_f32 v96, v96, v32
    v_mul_f32 v48, v48, v36
    v_mul_f32 v97, v97, v32
    v_mul_f32 v49, v49, v36
    v_mul_f32 v98, v98, v32
    v_mul_f32 v50, v50, v36
    v_mul_f32 v99, v99, v32
    v_mul_f32 v51, v51, v36
    v_cvt_pk_bf16_f32 v50, v50, v51
    v_cvt_pk_bf16_f32 v51, v48, v49
    v_cvt_pk_bf16_f32 v48, v96, v97
    v_cvt_pk_bf16_f32 v49, v98, v99
    v_mov_b32 v3, v50
    v_mov_b32 v50, v51
    v_mov_b32 v51, v3
    v_mul_f32 v100, v100, v33
    v_mul_f32 v52, v52, v37
    v_mul_f32 v101, v101, v33
    v_mul_f32 v53, v53, v37
    v_mul_f32 v102, v102, v33
    v_mul_f32 v54, v54, v37
    v_mul_f32 v103, v103, v33
    v_mul_f32 v55, v55, v37
    v_cvt_pk_bf16_f32 v54, v54, v55
    v_cvt_pk_bf16_f32 v55, v52, v53
    v_cvt_pk_bf16_f32 v52, v100, v101
    v_cvt_pk_bf16_f32 v53, v102, v103
    v_mov_b32 v3, v54
    v_mov_b32 v54, v55
    v_mov_b32 v55, v3
    v_mul_f32 v104, v104, v34
    v_mul_f32 v56, v56, v38
    v_mul_f32 v105, v105, v34
    v_mul_f32 v57, v57, v38
    v_mul_f32 v106, v106, v34
    v_mul_f32 v58, v58, v38
    v_mul_f32 v107, v107, v34
    v_mul_f32 v59, v59, v38
    v_cvt_pk_bf16_f32 v58, v58, v59
    v_cvt_pk_bf16_f32 v59, v56, v57
    v_cvt_pk_bf16_f32 v56, v104, v105
    v_cvt_pk_bf16_f32 v57, v106, v107
    v_mov_b32 v3, v58
    v_mov_b32 v58, v59
    v_mov_b32 v59, v3
    v_mul_f32 v108, v108, v35
    v_mul_f32 v60, v60, v39
    v_mul_f32 v109, v109, v35
    v_mul_f32 v61, v61, v39
    v_mul_f32 v110, v110, v35
    v_mul_f32 v62, v62, v39
    v_mul_f32 v111, v111, v35
    v_mul_f32 v63, v63, v39
    v_cvt_pk_bf16_f32 v62, v62, v63
    v_cvt_pk_bf16_f32 v63, v60, v61
    v_cvt_pk_bf16_f32 v60, v108, v109
    v_cvt_pk_bf16_f32 v61, v110, v111
    v_mov_b32 v3, v62
    v_mov_b32 v62, v63
    v_mov_b32 v63, v3
    buffer_store_dwordx4 v[48:51], v23, s[16:19], s32 offen offset:128
    v_add_u32 v23, 32768, v23
    buffer_store_dwordx4 v[52:55], v23, s[16:19], s32 offen offset:128
    v_add_u32 v23, 32768, v23
    buffer_store_dwordx4 v[56:59], v23, s[16:19], s32 offen offset:128
    v_add_u32 v23, 32768, v23
    buffer_store_dwordx4 v[60:63], v23, s[16:19], s32 offen offset:128
    v_subrev_u32 v23, 98304, v23
    s_nop 1
    s_add_u32 s38, s37, 3
    s_lshl_b32 s38, s38, 9
    buffer_load_ushort v3, v22, s[20:23], s38 offen offset:0
    buffer_load_ushort v4, v22, s[20:23], s38 offen offset:32
    buffer_load_ushort v5, v22, s[20:23], s38 offen offset:64
    buffer_load_ushort v6, v22, s[20:23], s38 offen offset:96
    s_waitcnt vmcnt(0)
    v_lshl_or_b32 v24, v4, 16, v3
    v_lshl_or_b32 v25, v6, 16, v5
    v_cvt_pk_bf16_f32 v26, v112, v113
    v_cvt_pk_bf16_f32 v27, v114, v115
    s_nop 1
    v_mfma_f32_16x16x16_bf16 v[112:115], v[24:25], v[26:27], 0
    v_cvt_pk_bf16_f32 v26, v116, v117
    v_cvt_pk_bf16_f32 v27, v118, v119
    s_nop 1
    v_mfma_f32_16x16x16_bf16 v[116:119], v[24:25], v[26:27], 0
    v_cvt_pk_bf16_f32 v26, v120, v121
    v_cvt_pk_bf16_f32 v27, v122, v123
    s_nop 1
    v_mfma_f32_16x16x16_bf16 v[120:123], v[24:25], v[26:27], 0
    v_cvt_pk_bf16_f32 v26, v124, v125
    v_cvt_pk_bf16_f32 v27, v126, v127
    s_nop 1
    v_mfma_f32_16x16x16_bf16 v[124:127], v[24:25], v[26:27], 0
    s_nop 7
    s_nop 7
    v_cvt_pk_bf16_f32 v5, v112, v113
    v_lshlrev_b32 v112, 16, v5
    v_and_b32 v113, 0xffff0000, v5
    v_cvt_pk_bf16_f32 v5, v114, v115
    v_lshlrev_b32 v114, 16, v5
    v_and_b32 v115, 0xffff0000, v5
    v_cvt_pk_bf16_f32 v5, v116, v117
    v_lshlrev_b32 v116, 16, v5
    v_and_b32 v117, 0xffff0000, v5
    v_cvt_pk_bf16_f32 v5, v118, v119
    v_lshlrev_b32 v118, 16, v5
    v_and_b32 v119, 0xffff0000, v5
    v_cvt_pk_bf16_f32 v5, v120, v121
    v_lshlrev_b32 v120, 16, v5
    v_and_b32 v121, 0xffff0000, v5
    v_cvt_pk_bf16_f32 v5, v122, v123
    v_lshlrev_b32 v122, 16, v5
    v_and_b32 v123, 0xffff0000, v5
    v_cvt_pk_bf16_f32 v5, v124, v125
    v_lshlrev_b32 v124, 16, v5
    v_and_b32 v125, 0xffff0000, v5
    v_cvt_pk_bf16_f32 v5, v126, v127
    v_lshlrev_b32 v126, 16, v5
    v_and_b32 v127, 0xffff0000, v5
    v_max_f32 v32, v112, v113
    v_max3_f32 v32, v32, v114, v115
    v_min_f32 v36, v112, v113
    v_min3_f32 v36, v36, v114, v115
    v_max_f32 v33, v116, v117
    v_max3_f32 v33, v33, v118, v119
    v_min_f32 v37, v116, v117
    v_min3_f32 v37, v37, v118, v119
    v_max_f32 v34, v120, v121
    v_max3_f32 v34, v34, v122, v123
    v_min_f32 v38, v120, v121
    v_min3_f32 v38, v38, v122, v123
    v_max_f32 v35, v124, v125
    v_max3_f32 v35, v35, v126, v127
    v_min_f32 v39, v124, v125
    v_min3_f32 v39, v39, v126, v127
    ds_bpermute_b32 v40, v20, v32
    ds_bpermute_b32 v44, v20, v36
    ds_bpermute_b32 v41, v20, v33
    ds_bpermute_b32 v45, v20, v37
    ds_bpermute_b32 v42, v20, v34
    ds_bpermute_b32 v46, v20, v38
    ds_bpermute_b32 v43, v20, v35
    ds_bpermute_b32 v47, v20, v39
    s_waitcnt lgkmcnt(0)
    v_max_f32 v32, v32, v40
    v_min_f32 v36, v36, v44
    v_max_f32 v33, v33, v41
    v_min_f32 v37, v37, v45
    v_max_f32 v34, v34, v42
    v_min_f32 v38, v38, v46
    v_max_f32 v35, v35, v43
    v_min_f32 v39, v39, v47
    ds_bpermute_b32 v40, v21, v32
    ds_bpermute_b32 v44, v21, v36
    ds_bpermute_b32 v41, v21, v33
    ds_bpermute_b32 v45, v21, v37
    ds_bpermute_b32 v42, v21, v34
    ds_bpermute_b32 v46, v21, v38
    ds_bpermute_b32 v43, v21, v35
    ds_bpermute_b32 v47, v21, v39
    s_waitcnt lgkmcnt(0)
    v_max_f32 v32, v32, v40
    v_min_f32 v36, v36, v44
    v_max_f32 v33, v33, v41
    v_min_f32 v37, v37, v45
    v_max_f32 v34, v34, v42
    v_min_f32 v38, v38, v46
    v_max_f32 v35, v35, v43
    v_min_f32 v39, v39, v47
    s_mov_b32 s40, 1069066811
    v_sub_f32 v48, v36, v112
    v_mul_f32 v48, s40, v48
    v_exp_f32 v48, v48
    v_sub_f32 v112, v112, v32
    v_mul_f32 v112, s40, v112
    v_exp_f32 v112, v112
    v_sub_f32 v49, v36, v113
    v_mul_f32 v49, s40, v49
    v_exp_f32 v49, v49
    v_sub_f32 v113, v113, v32
    v_mul_f32 v113, s40, v113
    v_exp_f32 v113, v113
    v_sub_f32 v50, v36, v114
    v_mul_f32 v50, s40, v50
    v_exp_f32 v50, v50
    v_sub_f32 v114, v114, v32
    v_mul_f32 v114, s40, v114
    v_exp_f32 v114, v114
    v_sub_f32 v51, v36, v115
    v_mul_f32 v51, s40, v51
    v_exp_f32 v51, v51
    v_sub_f32 v115, v115, v32
    v_mul_f32 v115, s40, v115
    v_exp_f32 v115, v115
    v_sub_f32 v52, v37, v116
    v_mul_f32 v52, s40, v52
    v_exp_f32 v52, v52
    v_sub_f32 v116, v116, v33
    v_mul_f32 v116, s40, v116
    v_exp_f32 v116, v116
    v_sub_f32 v53, v37, v117
    v_mul_f32 v53, s40, v53
    v_exp_f32 v53, v53
    v_sub_f32 v117, v117, v33
    v_mul_f32 v117, s40, v117
    v_exp_f32 v117, v117
    v_sub_f32 v54, v37, v118
    v_mul_f32 v54, s40, v54
    v_exp_f32 v54, v54
    v_sub_f32 v118, v118, v33
    v_mul_f32 v118, s40, v118
    v_exp_f32 v118, v118
    v_sub_f32 v55, v37, v119
    v_mul_f32 v55, s40, v55
    v_exp_f32 v55, v55
    v_sub_f32 v119, v119, v33
    v_mul_f32 v119, s40, v119
    v_exp_f32 v119, v119
    v_sub_f32 v56, v38, v120
    v_mul_f32 v56, s40, v56
    v_exp_f32 v56, v56
    v_sub_f32 v120, v120, v34
    v_mul_f32 v120, s40, v120
    v_exp_f32 v120, v120
    v_sub_f32 v57, v38, v121
    v_mul_f32 v57, s40, v57
    v_exp_f32 v57, v57
    v_sub_f32 v121, v121, v34
    v_mul_f32 v121, s40, v121
    v_exp_f32 v121, v121
    v_sub_f32 v58, v38, v122
    v_mul_f32 v58, s40, v58
    v_exp_f32 v58, v58
    v_sub_f32 v122, v122, v34
    v_mul_f32 v122, s40, v122
    v_exp_f32 v122, v122
    v_sub_f32 v59, v38, v123
    v_mul_f32 v59, s40, v59
    v_exp_f32 v59, v59
    v_sub_f32 v123, v123, v34
    v_mul_f32 v123, s40, v123
    v_exp_f32 v123, v123
    v_sub_f32 v60, v39, v124
    v_mul_f32 v60, s40, v60
    v_exp_f32 v60, v60
    v_sub_f32 v124, v124, v35
    v_mul_f32 v124, s40, v124
    v_exp_f32 v124, v124
    v_sub_f32 v61, v39, v125
    v_mul_f32 v61, s40, v61
    v_exp_f32 v61, v61
    v_sub_f32 v125, v125, v35
    v_mul_f32 v125, s40, v125
    v_exp_f32 v125, v125
    v_sub_f32 v62, v39, v126
    v_mul_f32 v62, s40, v62
    v_exp_f32 v62, v62
    v_sub_f32 v126, v126, v35
    v_mul_f32 v126, s40, v126
    v_exp_f32 v126, v126
    v_sub_f32 v63, v39, v127
    v_mul_f32 v63, s40, v63
    v_exp_f32 v63, v63
    v_sub_f32 v127, v127, v35
    v_mul_f32 v127, s40, v127
    v_exp_f32 v127, v127
    s_nop 0
    v_add_f32 v32, v112, v113
    v_add_f32 v32, v32, v114
    v_add_f32 v32, v32, v115
    v_add_f32 v36, v48, v49
    v_add_f32 v36, v36, v50
    v_add_f32 v36, v36, v51
    v_add_f32 v33, v116, v117
    v_add_f32 v33, v33, v118
    v_add_f32 v33, v33, v119
    v_add_f32 v37, v52, v53
    v_add_f32 v37, v37, v54
    v_add_f32 v37, v37, v55
    v_add_f32 v34, v120, v121
    v_add_f32 v34, v34, v122
    v_add_f32 v34, v34, v123
    v_add_f32 v38, v56, v57
    v_add_f32 v38, v38, v58
    v_add_f32 v38, v38, v59
    v_add_f32 v35, v124, v125
    v_add_f32 v35, v35, v126
    v_add_f32 v35, v35, v127
    v_add_f32 v39, v60, v61
    v_add_f32 v39, v39, v62
    v_add_f32 v39, v39, v63
    ds_bpermute_b32 v40, v20, v32
    ds_bpermute_b32 v44, v20, v36
    ds_bpermute_b32 v41, v20, v33
    ds_bpermute_b32 v45, v20, v37
    ds_bpermute_b32 v42, v20, v34
    ds_bpermute_b32 v46, v20, v38
    ds_bpermute_b32 v43, v20, v35
    ds_bpermute_b32 v47, v20, v39
    s_waitcnt lgkmcnt(0)
    v_add_f32 v32, v32, v40
    v_add_f32 v36, v36, v44
    v_add_f32 v33, v33, v41
    v_add_f32 v37, v37, v45
    v_add_f32 v34, v34, v42
    v_add_f32 v38, v38, v46
    v_add_f32 v35, v35, v43
    v_add_f32 v39, v39, v47
    ds_bpermute_b32 v40, v21, v32
    ds_bpermute_b32 v44, v21, v36
    ds_bpermute_b32 v41, v21, v33
    ds_bpermute_b32 v45, v21, v37
    ds_bpermute_b32 v42, v21, v34
    ds_bpermute_b32 v46, v21, v38
    ds_bpermute_b32 v43, v21, v35
    ds_bpermute_b32 v47, v21, v39
    s_waitcnt lgkmcnt(0)
    v_add_f32 v32, v32, v40
    v_add_f32 v36, v36, v44
    v_add_f32 v33, v33, v41
    v_add_f32 v37, v37, v45
    v_add_f32 v34, v34, v42
    v_add_f32 v38, v38, v46
    v_add_f32 v35, v35, v43
    v_add_f32 v39, v39, v47
    v_rcp_f32 v32, v32
    v_rcp_f32 v36, v36
    v_rcp_f32 v33, v33
    v_rcp_f32 v37, v37
    v_rcp_f32 v34, v34
    v_rcp_f32 v38, v38
    v_rcp_f32 v35, v35
    v_rcp_f32 v39, v39
    s_nop 0
    v_mul_f32 v112, v112, v32
    v_mul_f32 v48, v48, v36
    v_mul_f32 v113, v113, v32
    v_mul_f32 v49, v49, v36
    v_mul_f32 v114, v114, v32
    v_mul_f32 v50, v50, v36
    v_mul_f32 v115, v115, v32
    v_mul_f32 v51, v51, v36
    v_cvt_pk_bf16_f32 v50, v50, v51
    v_cvt_pk_bf16_f32 v51, v48, v49
    v_cvt_pk_bf16_f32 v48, v112, v113
    v_cvt_pk_bf16_f32 v49, v114, v115
    v_mov_b32 v3, v50
    v_mov_b32 v50, v51
    v_mov_b32 v51, v3
    v_mul_f32 v116, v116, v33
    v_mul_f32 v52, v52, v37
    v_mul_f32 v117, v117, v33
    v_mul_f32 v53, v53, v37
    v_mul_f32 v118, v118, v33
    v_mul_f32 v54, v54, v37
    v_mul_f32 v119, v119, v33
    v_mul_f32 v55, v55, v37
    v_cvt_pk_bf16_f32 v54, v54, v55
    v_cvt_pk_bf16_f32 v55, v52, v53
    v_cvt_pk_bf16_f32 v52, v116, v117
    v_cvt_pk_bf16_f32 v53, v118, v119
    v_mov_b32 v3, v54
    v_mov_b32 v54, v55
    v_mov_b32 v55, v3
    v_mul_f32 v120, v120, v34
    v_mul_f32 v56, v56, v38
    v_mul_f32 v121, v121, v34
    v_mul_f32 v57, v57, v38
    v_mul_f32 v122, v122, v34
    v_mul_f32 v58, v58, v38
    v_mul_f32 v123, v123, v34
    v_mul_f32 v59, v59, v38
    v_cvt_pk_bf16_f32 v58, v58, v59
    v_cvt_pk_bf16_f32 v59, v56, v57
    v_cvt_pk_bf16_f32 v56, v120, v121
    v_cvt_pk_bf16_f32 v57, v122, v123
    v_mov_b32 v3, v58
    v_mov_b32 v58, v59
    v_mov_b32 v59, v3
    v_mul_f32 v124, v124, v35
    v_mul_f32 v60, v60, v39
    v_mul_f32 v125, v125, v35
    v_mul_f32 v61, v61, v39
    v_mul_f32 v126, v126, v35
    v_mul_f32 v62, v62, v39
    v_mul_f32 v127, v127, v35
    v_mul_f32 v63, v63, v39
    v_cvt_pk_bf16_f32 v62, v62, v63
    v_cvt_pk_bf16_f32 v63, v60, v61
    v_cvt_pk_bf16_f32 v60, v124, v125
    v_cvt_pk_bf16_f32 v61, v126, v127
    v_mov_b32 v3, v62
    v_mov_b32 v62, v63
    v_mov_b32 v63, v3
    buffer_store_dwordx4 v[48:51], v23, s[16:19], s32 offen offset:192
    v_add_u32 v23, 32768, v23
    buffer_store_dwordx4 v[52:55], v23, s[16:19], s32 offen offset:192
    v_add_u32 v23, 32768, v23
    buffer_store_dwordx4 v[56:59], v23, s[16:19], s32 offen offset:192
    v_add_u32 v23, 32768, v23
    buffer_store_dwordx4 v[60:63], v23, s[16:19], s32 offen offset:192
    v_subrev_u32 v23, 98304, v23
    s_nop 1
    s_branch K1_END
K1_LOOP_KV:
    ds_read_b128 v[128:131], v235 offset:0
    ds_read_b128 v[132:135], v235 offset:2048
    ds_read_b128 v[136:139], v235 offset:4096
    ds_read_b128 v[140:143], v235 offset:6144
    ds_read_b64_tr_b16 v[160:161], v237 offset:0
    ds_read_b64_tr_b16 v[162:163], v237 offset:1024
    ds_read_b64_tr_b16 v[164:165], v238 offset:0
    ds_read_b64_tr_b16 v[166:167], v238 offset:1024
    ds_read_b64_tr_b16 v[168:169], v239 offset:0
    ds_read_b64_tr_b16 v[170:171], v239 offset:1024
    ds_read_b64_tr_b16 v[172:173], v240 offset:0
    ds_read_b64_tr_b16 v[174:175], v240 offset:1024
    ds_read_b128 v[144:147], v236 offset:0
    ds_read_b128 v[148:151], v236 offset:2048
    ds_read_b128 v[152:155], v236 offset:4096
    ds_read_b128 v[156:159], v236 offset:6144
    ds_read_b64_tr_b16 v[176:177], v237 offset:8192
    ds_read_b64_tr_b16 v[178:179], v237 offset:9216
    ds_read_b64_tr_b16 v[180:181], v238 offset:8192
    ds_read_b64_tr_b16 v[182:183], v238 offset:9216
    ds_read_b64_tr_b16 v[184:185], v239 offset:8192
    ds_read_b64_tr_b16 v[186:187], v239 offset:9216
    ds_read_b64_tr_b16 v[188:189], v240 offset:8192
    ds_read_b64_tr_b16 v[190:191], v240 offset:9216
    s_waitcnt lgkmcnt(12)
    v_mfma_f32_16x16x32_bf16 v[64:67], v[160:163], v[128:131], 0
    v_mfma_f32_16x16x32_bf16 v[68:71], v[160:163], v[132:135], 0
    v_mfma_f32_16x16x32_bf16 v[72:75], v[160:163], v[136:139], 0
    v_mfma_f32_16x16x32_bf16 v[76:79], v[160:163], v[140:143], 0
    v_mfma_f32_16x16x32_bf16 v[80:83], v[128:131], v[164:167], 0
    v_mfma_f32_16x16x32_bf16 v[84:87], v[132:135], v[164:167], 0
    v_mfma_f32_16x16x32_bf16 v[88:91], v[136:139], v[164:167], 0
    v_mfma_f32_16x16x32_bf16 v[92:95], v[140:143], v[164:167], 0
    v_mfma_f32_16x16x32_bf16 v[96:99], v[168:171], v[128:131], 0
    v_mfma_f32_16x16x32_bf16 v[100:103], v[168:171], v[132:135], 0
    v_mfma_f32_16x16x32_bf16 v[104:107], v[168:171], v[136:139], 0
    v_mfma_f32_16x16x32_bf16 v[108:111], v[168:171], v[140:143], 0
    v_mfma_f32_16x16x32_bf16 v[112:115], v[128:131], v[172:175], 0
    v_mfma_f32_16x16x32_bf16 v[116:119], v[132:135], v[172:175], 0
    v_mfma_f32_16x16x32_bf16 v[120:123], v[136:139], v[172:175], 0
    v_mfma_f32_16x16x32_bf16 v[124:127], v[140:143], v[172:175], 0
    s_waitcnt lgkmcnt(0)
    v_mfma_f32_16x16x32_bf16 v[64:67], v[176:179], v[144:147], v[64:67]
    v_mfma_f32_16x16x32_bf16 v[68:71], v[176:179], v[148:151], v[68:71]
    v_mfma_f32_16x16x32_bf16 v[72:75], v[176:179], v[152:155], v[72:75]
    v_mfma_f32_16x16x32_bf16 v[76:79], v[176:179], v[156:159], v[76:79]
    v_mfma_f32_16x16x32_bf16 v[80:83], v[144:147], v[180:183], v[80:83]
    v_mfma_f32_16x16x32_bf16 v[84:87], v[148:151], v[180:183], v[84:87]
    v_mfma_f32_16x16x32_bf16 v[88:91], v[152:155], v[180:183], v[88:91]
    v_mfma_f32_16x16x32_bf16 v[92:95], v[156:159], v[180:183], v[92:95]
    v_mfma_f32_16x16x32_bf16 v[96:99], v[184:187], v[144:147], v[96:99]
    v_mfma_f32_16x16x32_bf16 v[100:103], v[184:187], v[148:151], v[100:103]
    v_mfma_f32_16x16x32_bf16 v[104:107], v[184:187], v[152:155], v[104:107]
    v_mfma_f32_16x16x32_bf16 v[108:111], v[184:187], v[156:159], v[108:111]
    v_mfma_f32_16x16x32_bf16 v[112:115], v[144:147], v[188:191], v[112:115]
    v_mfma_f32_16x16x32_bf16 v[116:119], v[148:151], v[188:191], v[116:119]
    v_mfma_f32_16x16x32_bf16 v[120:123], v[152:155], v[188:191], v[120:123]
    v_mfma_f32_16x16x32_bf16 v[124:127], v[156:159], v[188:191], v[124:127]
    s_waitcnt vmcnt(8)
    ds_write_b128 v233, v[32:35] offset:16384
    ds_write_b128 v233, v[36:39] offset:20480
    ds_write_b128 v233, v[40:43] offset:24576
    ds_write_b128 v233, v[44:47] offset:28672
    ds_write_b128 v234, v[48:51] offset:16384
    ds_write_b128 v234, v[52:55] offset:20480
    ds_write_b128 v234, v[56:59] offset:24576
    ds_write_b128 v234, v[60:63] offset:28672
    s_waitcnt lgkmcnt(0)
    buffer_load_dwordx4 v[32:35], v232, s[16:19], s24 offen offset:384
    buffer_load_dwordx4 v[36:39], v232, s[16:19], s25 offen offset:384
    buffer_load_dwordx4 v[40:43], v232, s[16:19], s26 offen offset:384
    buffer_load_dwordx4 v[44:47], v232, s[16:19], s27 offen offset:384
    global_load_dwordx4 v[48:51], v[224:225], off
    global_load_dwordx4 v[52:55], v[226:227], off
    global_load_dwordx4 v[56:59], v[228:229], off
    global_load_dwordx4 v[60:63], v[230:231], off
    v_add_co_u32 v224, vcc, s31, v224
    v_addc_co_u32 v225, vcc, 0, v225, vcc
    v_add_co_u32 v226, vcc, s31, v226
    v_addc_co_u32 v227, vcc, 0, v227, vcc
    v_add_co_u32 v228, vcc, s31, v228
    v_addc_co_u32 v229, vcc, 0, v229, vcc
    v_add_co_u32 v230, vcc, s31, v230
    v_addc_co_u32 v231, vcc, 0, v231, vcc
    s_barrier
    ds_read_b128 v[128:131], v235 offset:16384
    ds_read_b128 v[132:135], v235 offset:18432
    ds_read_b128 v[136:139], v235 offset:20480
    ds_read_b128 v[140:143], v235 offset:22528
    ds_read_b64_tr_b16 v[160:161], v237 offset:16384
    ds_read_b64_tr_b16 v[162:163], v237 offset:17408
    ds_read_b64_tr_b16 v[164:165], v238 offset:16384
    ds_read_b64_tr_b16 v[166:167], v238 offset:17408
    ds_read_b64_tr_b16 v[168:169], v239 offset:16384
    ds_read_b64_tr_b16 v[170:171], v239 offset:17408
    ds_read_b64_tr_b16 v[172:173], v240 offset:16384
    ds_read_b64_tr_b16 v[174:175], v240 offset:17408
    ds_read_b128 v[144:147], v236 offset:16384
    ds_read_b128 v[148:151], v236 offset:18432
    ds_read_b128 v[152:155], v236 offset:20480
    ds_read_b128 v[156:159], v236 offset:22528
    ds_read_b64_tr_b16 v[176:177], v237 offset:24576
    ds_read_b64_tr_b16 v[178:179], v237 offset:25600
    ds_read_b64_tr_b16 v[180:181], v238 offset:24576
    ds_read_b64_tr_b16 v[182:183], v238 offset:25600
    ds_read_b64_tr_b16 v[184:185], v239 offset:24576
    ds_read_b64_tr_b16 v[186:187], v239 offset:25600
    ds_read_b64_tr_b16 v[188:189], v240 offset:24576
    ds_read_b64_tr_b16 v[190:191], v240 offset:25600
    s_waitcnt lgkmcnt(12)
    v_mfma_f32_16x16x32_bf16 v[64:67], v[160:163], v[128:131], v[64:67]
    v_mfma_f32_16x16x32_bf16 v[68:71], v[160:163], v[132:135], v[68:71]
    v_mfma_f32_16x16x32_bf16 v[72:75], v[160:163], v[136:139], v[72:75]
    v_mfma_f32_16x16x32_bf16 v[76:79], v[160:163], v[140:143], v[76:79]
    v_mfma_f32_16x16x32_bf16 v[80:83], v[128:131], v[164:167], v[80:83]
    v_mfma_f32_16x16x32_bf16 v[84:87], v[132:135], v[164:167], v[84:87]
    v_mfma_f32_16x16x32_bf16 v[88:91], v[136:139], v[164:167], v[88:91]
    v_mfma_f32_16x16x32_bf16 v[92:95], v[140:143], v[164:167], v[92:95]
    v_mfma_f32_16x16x32_bf16 v[96:99], v[168:171], v[128:131], v[96:99]
    v_mfma_f32_16x16x32_bf16 v[100:103], v[168:171], v[132:135], v[100:103]
    v_mfma_f32_16x16x32_bf16 v[104:107], v[168:171], v[136:139], v[104:107]
    v_mfma_f32_16x16x32_bf16 v[108:111], v[168:171], v[140:143], v[108:111]
    v_mfma_f32_16x16x32_bf16 v[112:115], v[128:131], v[172:175], v[112:115]
    v_mfma_f32_16x16x32_bf16 v[116:119], v[132:135], v[172:175], v[116:119]
    v_mfma_f32_16x16x32_bf16 v[120:123], v[136:139], v[172:175], v[120:123]
    v_mfma_f32_16x16x32_bf16 v[124:127], v[140:143], v[172:175], v[124:127]
    s_waitcnt lgkmcnt(0)
    v_mfma_f32_16x16x32_bf16 v[64:67], v[176:179], v[144:147], v[64:67]
    v_mfma_f32_16x16x32_bf16 v[68:71], v[176:179], v[148:151], v[68:71]
    v_mfma_f32_16x16x32_bf16 v[72:75], v[176:179], v[152:155], v[72:75]
    v_mfma_f32_16x16x32_bf16 v[76:79], v[176:179], v[156:159], v[76:79]
    v_mfma_f32_16x16x32_bf16 v[80:83], v[144:147], v[180:183], v[80:83]
    v_mfma_f32_16x16x32_bf16 v[84:87], v[148:151], v[180:183], v[84:87]
    v_mfma_f32_16x16x32_bf16 v[88:91], v[152:155], v[180:183], v[88:91]
    v_mfma_f32_16x16x32_bf16 v[92:95], v[156:159], v[180:183], v[92:95]
    v_mfma_f32_16x16x32_bf16 v[96:99], v[184:187], v[144:147], v[96:99]
    v_mfma_f32_16x16x32_bf16 v[100:103], v[184:187], v[148:151], v[100:103]
    v_mfma_f32_16x16x32_bf16 v[104:107], v[184:187], v[152:155], v[104:107]
    v_mfma_f32_16x16x32_bf16 v[108:111], v[184:187], v[156:159], v[108:111]
    v_mfma_f32_16x16x32_bf16 v[112:115], v[144:147], v[188:191], v[112:115]
    v_mfma_f32_16x16x32_bf16 v[116:119], v[148:151], v[188:191], v[116:119]
    v_mfma_f32_16x16x32_bf16 v[120:123], v[152:155], v[188:191], v[120:123]
    v_mfma_f32_16x16x32_bf16 v[124:127], v[156:159], v[188:191], v[124:127]
    s_waitcnt vmcnt(8)
    ds_write_b128 v233, v[192:195] offset:0
    ds_write_b128 v233, v[196:199] offset:4096
    ds_write_b128 v233, v[200:203] offset:8192
    ds_write_b128 v233, v[204:207] offset:12288
    ds_write_b128 v234, v[208:211] offset:0
    ds_write_b128 v234, v[212:215] offset:4096
    ds_write_b128 v234, v[216:219] offset:8192
    ds_write_b128 v234, v[220:223] offset:12288
    s_waitcnt lgkmcnt(0)
    buffer_load_dwordx4 v[192:195], v232, s[16:19], s24 offen offset:512
    buffer_load_dwordx4 v[196:199], v232, s[16:19], s25 offen offset:512
    buffer_load_dwordx4 v[200:203], v232, s[16:19], s26 offen offset:512
    buffer_load_dwordx4 v[204:207], v232, s[16:19], s27 offen offset:512
    global_load_dwordx4 v[208:211], v[224:225], off
    global_load_dwordx4 v[212:215], v[226:227], off
    global_load_dwordx4 v[216:219], v[228:229], off
    global_load_dwordx4 v[220:223], v[230:231], off
    v_add_co_u32 v224, vcc, s31, v224
    v_addc_co_u32 v225, vcc, 0, v225, vcc
    v_add_co_u32 v226, vcc, s31, v226
    v_addc_co_u32 v227, vcc, 0, v227, vcc
    v_add_co_u32 v228, vcc, s31, v228
    v_addc_co_u32 v229, vcc, 0, v229, vcc
    v_add_co_u32 v230, vcc, s31, v230
    v_addc_co_u32 v231, vcc, 0, v231, vcc
    s_barrier
    ds_read_b128 v[128:131], v235 offset:0
    ds_read_b128 v[132:135], v235 offset:2048
    ds_read_b128 v[136:139], v235 offset:4096
    ds_read_b128 v[140:143], v235 offset:6144
    ds_read_b64_tr_b16 v[160:161], v237 offset:0
    ds_read_b64_tr_b16 v[162:163], v237 offset:1024
    ds_read_b64_tr_b16 v[164:165], v238 offset:0
    ds_read_b64_tr_b16 v[166:167], v238 offset:1024
    ds_read_b64_tr_b16 v[168:169], v239 offset:0
    ds_read_b64_tr_b16 v[170:171], v239 offset:1024
    ds_read_b64_tr_b16 v[172:173], v240 offset:0
    ds_read_b64_tr_b16 v[174:175], v240 offset:1024
    ds_read_b128 v[144:147], v236 offset:0
    ds_read_b128 v[148:151], v236 offset:2048
    ds_read_b128 v[152:155], v236 offset:4096
    ds_read_b128 v[156:159], v236 offset:6144
    ds_read_b64_tr_b16 v[176:177], v237 offset:8192
    ds_read_b64_tr_b16 v[178:179], v237 offset:9216
    ds_read_b64_tr_b16 v[180:181], v238 offset:8192
    ds_read_b64_tr_b16 v[182:183], v238 offset:9216
    ds_read_b64_tr_b16 v[184:185], v239 offset:8192
    ds_read_b64_tr_b16 v[186:187], v239 offset:9216
    ds_read_b64_tr_b16 v[188:189], v240 offset:8192
    ds_read_b64_tr_b16 v[190:191], v240 offset:9216
    s_waitcnt lgkmcnt(12)
    v_mfma_f32_16x16x32_bf16 v[64:67], v[160:163], v[128:131], v[64:67]
    v_mfma_f32_16x16x32_bf16 v[68:71], v[160:163], v[132:135], v[68:71]
    v_mfma_f32_16x16x32_bf16 v[72:75], v[160:163], v[136:139], v[72:75]
    v_mfma_f32_16x16x32_bf16 v[76:79], v[160:163], v[140:143], v[76:79]
    v_mfma_f32_16x16x32_bf16 v[80:83], v[128:131], v[164:167], v[80:83]
    v_mfma_f32_16x16x32_bf16 v[84:87], v[132:135], v[164:167], v[84:87]
    v_mfma_f32_16x16x32_bf16 v[88:91], v[136:139], v[164:167], v[88:91]
    v_mfma_f32_16x16x32_bf16 v[92:95], v[140:143], v[164:167], v[92:95]
    v_mfma_f32_16x16x32_bf16 v[96:99], v[168:171], v[128:131], v[96:99]
    v_mfma_f32_16x16x32_bf16 v[100:103], v[168:171], v[132:135], v[100:103]
    v_mfma_f32_16x16x32_bf16 v[104:107], v[168:171], v[136:139], v[104:107]
    v_mfma_f32_16x16x32_bf16 v[108:111], v[168:171], v[140:143], v[108:111]
    v_mfma_f32_16x16x32_bf16 v[112:115], v[128:131], v[172:175], v[112:115]
    v_mfma_f32_16x16x32_bf16 v[116:119], v[132:135], v[172:175], v[116:119]
    v_mfma_f32_16x16x32_bf16 v[120:123], v[136:139], v[172:175], v[120:123]
    v_mfma_f32_16x16x32_bf16 v[124:127], v[140:143], v[172:175], v[124:127]
    s_waitcnt lgkmcnt(0)
    v_mfma_f32_16x16x32_bf16 v[64:67], v[176:179], v[144:147], v[64:67]
    v_mfma_f32_16x16x32_bf16 v[68:71], v[176:179], v[148:151], v[68:71]
    v_mfma_f32_16x16x32_bf16 v[72:75], v[176:179], v[152:155], v[72:75]
    v_mfma_f32_16x16x32_bf16 v[76:79], v[176:179], v[156:159], v[76:79]
    v_mfma_f32_16x16x32_bf16 v[80:83], v[144:147], v[180:183], v[80:83]
    v_mfma_f32_16x16x32_bf16 v[84:87], v[148:151], v[180:183], v[84:87]
    v_mfma_f32_16x16x32_bf16 v[88:91], v[152:155], v[180:183], v[88:91]
    v_mfma_f32_16x16x32_bf16 v[92:95], v[156:159], v[180:183], v[92:95]
    v_mfma_f32_16x16x32_bf16 v[96:99], v[184:187], v[144:147], v[96:99]
    v_mfma_f32_16x16x32_bf16 v[100:103], v[184:187], v[148:151], v[100:103]
    v_mfma_f32_16x16x32_bf16 v[104:107], v[184:187], v[152:155], v[104:107]
    v_mfma_f32_16x16x32_bf16 v[108:111], v[184:187], v[156:159], v[108:111]
    v_mfma_f32_16x16x32_bf16 v[112:115], v[144:147], v[188:191], v[112:115]
    v_mfma_f32_16x16x32_bf16 v[116:119], v[148:151], v[188:191], v[116:119]
    v_mfma_f32_16x16x32_bf16 v[120:123], v[152:155], v[188:191], v[120:123]
    v_mfma_f32_16x16x32_bf16 v[124:127], v[156:159], v[188:191], v[124:127]
    s_waitcnt vmcnt(8)
    ds_write_b128 v233, v[32:35] offset:16384
    ds_write_b128 v233, v[36:39] offset:20480
    ds_write_b128 v233, v[40:43] offset:24576
    ds_write_b128 v233, v[44:47] offset:28672
    ds_write_b128 v234, v[48:51] offset:16384
    ds_write_b128 v234, v[52:55] offset:20480
    ds_write_b128 v234, v[56:59] offset:24576
    ds_write_b128 v234, v[60:63] offset:28672
    s_waitcnt lgkmcnt(0)
    buffer_load_dwordx4 v[32:35], v232, s[16:19], s24 offen offset:640
    buffer_load_dwordx4 v[36:39], v232, s[16:19], s25 offen offset:640
    buffer_load_dwordx4 v[40:43], v232, s[16:19], s26 offen offset:640
    buffer_load_dwordx4 v[44:47], v232, s[16:19], s27 offen offset:640
    global_load_dwordx4 v[48:51], v[224:225], off
    global_load_dwordx4 v[52:55], v[226:227], off
    global_load_dwordx4 v[56:59], v[228:229], off
    global_load_dwordx4 v[60:63], v[230:231], off
    v_add_co_u32 v224, vcc, s31, v224
    v_addc_co_u32 v225, vcc, 0, v225, vcc
    v_add_co_u32 v226, vcc, s31, v226
    v_addc_co_u32 v227, vcc, 0, v227, vcc
    v_add_co_u32 v228, vcc, s31, v228
    v_addc_co_u32 v229, vcc, 0, v229, vcc
    v_add_co_u32 v230, vcc, s31, v230
    v_addc_co_u32 v231, vcc, 0, v231, vcc
    s_barrier
    ds_read_b128 v[128:131], v235 offset:16384
    ds_read_b128 v[132:135], v235 offset:18432
    ds_read_b128 v[136:139], v235 offset:20480
    ds_read_b128 v[140:143], v235 offset:22528
    ds_read_b64_tr_b16 v[160:161], v237 offset:16384
    ds_read_b64_tr_b16 v[162:163], v237 offset:17408
    ds_read_b64_tr_b16 v[164:165], v238 offset:16384
    ds_read_b64_tr_b16 v[166:167], v238 offset:17408
    ds_read_b64_tr_b16 v[168:169], v239 offset:16384
    ds_read_b64_tr_b16 v[170:171], v239 offset:17408
    ds_read_b64_tr_b16 v[172:173], v240 offset:16384
    ds_read_b64_tr_b16 v[174:175], v240 offset:17408
    ds_read_b128 v[144:147], v236 offset:16384
    ds_read_b128 v[148:151], v236 offset:18432
    ds_read_b128 v[152:155], v236 offset:20480
    ds_read_b128 v[156:159], v236 offset:22528
    ds_read_b64_tr_b16 v[176:177], v237 offset:24576
    ds_read_b64_tr_b16 v[178:179], v237 offset:25600
    ds_read_b64_tr_b16 v[180:181], v238 offset:24576
    ds_read_b64_tr_b16 v[182:183], v238 offset:25600
    ds_read_b64_tr_b16 v[184:185], v239 offset:24576
    ds_read_b64_tr_b16 v[186:187], v239 offset:25600
    ds_read_b64_tr_b16 v[188:189], v240 offset:24576
    ds_read_b64_tr_b16 v[190:191], v240 offset:25600
    s_waitcnt lgkmcnt(12)
    v_mfma_f32_16x16x32_bf16 v[64:67], v[160:163], v[128:131], v[64:67]
    v_mfma_f32_16x16x32_bf16 v[68:71], v[160:163], v[132:135], v[68:71]
    v_mfma_f32_16x16x32_bf16 v[72:75], v[160:163], v[136:139], v[72:75]
    v_mfma_f32_16x16x32_bf16 v[76:79], v[160:163], v[140:143], v[76:79]
    v_mfma_f32_16x16x32_bf16 v[80:83], v[128:131], v[164:167], v[80:83]
    v_mfma_f32_16x16x32_bf16 v[84:87], v[132:135], v[164:167], v[84:87]
    v_mfma_f32_16x16x32_bf16 v[88:91], v[136:139], v[164:167], v[88:91]
    v_mfma_f32_16x16x32_bf16 v[92:95], v[140:143], v[164:167], v[92:95]
    v_mfma_f32_16x16x32_bf16 v[96:99], v[168:171], v[128:131], v[96:99]
    v_mfma_f32_16x16x32_bf16 v[100:103], v[168:171], v[132:135], v[100:103]
    v_mfma_f32_16x16x32_bf16 v[104:107], v[168:171], v[136:139], v[104:107]
    v_mfma_f32_16x16x32_bf16 v[108:111], v[168:171], v[140:143], v[108:111]
    v_mfma_f32_16x16x32_bf16 v[112:115], v[128:131], v[172:175], v[112:115]
    v_mfma_f32_16x16x32_bf16 v[116:119], v[132:135], v[172:175], v[116:119]
    v_mfma_f32_16x16x32_bf16 v[120:123], v[136:139], v[172:175], v[120:123]
    v_mfma_f32_16x16x32_bf16 v[124:127], v[140:143], v[172:175], v[124:127]
    s_waitcnt lgkmcnt(0)
    v_mfma_f32_16x16x32_bf16 v[64:67], v[176:179], v[144:147], v[64:67]
    v_mfma_f32_16x16x32_bf16 v[68:71], v[176:179], v[148:151], v[68:71]
    v_mfma_f32_16x16x32_bf16 v[72:75], v[176:179], v[152:155], v[72:75]
    v_mfma_f32_16x16x32_bf16 v[76:79], v[176:179], v[156:159], v[76:79]
    v_mfma_f32_16x16x32_bf16 v[80:83], v[144:147], v[180:183], v[80:83]
    v_mfma_f32_16x16x32_bf16 v[84:87], v[148:151], v[180:183], v[84:87]
    v_mfma_f32_16x16x32_bf16 v[88:91], v[152:155], v[180:183], v[88:91]
    v_mfma_f32_16x16x32_bf16 v[92:95], v[156:159], v[180:183], v[92:95]
    v_mfma_f32_16x16x32_bf16 v[96:99], v[184:187], v[144:147], v[96:99]
    v_mfma_f32_16x16x32_bf16 v[100:103], v[184:187], v[148:151], v[100:103]
    v_mfma_f32_16x16x32_bf16 v[104:107], v[184:187], v[152:155], v[104:107]
    v_mfma_f32_16x16x32_bf16 v[108:111], v[184:187], v[156:159], v[108:111]
    v_mfma_f32_16x16x32_bf16 v[112:115], v[144:147], v[188:191], v[112:115]
    v_mfma_f32_16x16x32_bf16 v[116:119], v[148:151], v[188:191], v[116:119]
    v_mfma_f32_16x16x32_bf16 v[120:123], v[152:155], v[188:191], v[120:123]
    v_mfma_f32_16x16x32_bf16 v[124:127], v[156:159], v[188:191], v[124:127]
    s_waitcnt vmcnt(8)
    ds_write_b128 v233, v[192:195] offset:0
    ds_write_b128 v233, v[196:199] offset:4096
    ds_write_b128 v233, v[200:203] offset:8192
    ds_write_b128 v233, v[204:207] offset:12288
    ds_write_b128 v234, v[208:211] offset:0
    ds_write_b128 v234, v[212:215] offset:4096
    ds_write_b128 v234, v[216:219] offset:8192
    ds_write_b128 v234, v[220:223] offset:12288
    s_waitcnt lgkmcnt(0)
    buffer_load_dwordx4 v[192:195], v232, s[16:19], s24 offen offset:768
    buffer_load_dwordx4 v[196:199], v232, s[16:19], s25 offen offset:768
    buffer_load_dwordx4 v[200:203], v232, s[16:19], s26 offen offset:768
    buffer_load_dwordx4 v[204:207], v232, s[16:19], s27 offen offset:768
    global_load_dwordx4 v[208:211], v[224:225], off
    global_load_dwordx4 v[212:215], v[226:227], off
    global_load_dwordx4 v[216:219], v[228:229], off
    global_load_dwordx4 v[220:223], v[230:231], off
    v_add_co_u32 v224, vcc, s31, v224
    v_addc_co_u32 v225, vcc, 0, v225, vcc
    v_add_co_u32 v226, vcc, s31, v226
    v_addc_co_u32 v227, vcc, 0, v227, vcc
    v_add_co_u32 v228, vcc, s31, v228
    v_addc_co_u32 v229, vcc, 0, v229, vcc
    v_add_co_u32 v230, vcc, s31, v230
    v_addc_co_u32 v231, vcc, 0, v231, vcc
    s_barrier
    ds_read_b128 v[128:131], v235 offset:0
    ds_read_b128 v[132:135], v235 offset:2048
    ds_read_b128 v[136:139], v235 offset:4096
    ds_read_b128 v[140:143], v235 offset:6144
    ds_read_b64_tr_b16 v[160:161], v237 offset:0
    ds_read_b64_tr_b16 v[162:163], v237 offset:1024
    ds_read_b64_tr_b16 v[164:165], v238 offset:0
    ds_read_b64_tr_b16 v[166:167], v238 offset:1024
    ds_read_b64_tr_b16 v[168:169], v239 offset:0
    ds_read_b64_tr_b16 v[170:171], v239 offset:1024
    ds_read_b64_tr_b16 v[172:173], v240 offset:0
    ds_read_b64_tr_b16 v[174:175], v240 offset:1024
    ds_read_b128 v[144:147], v236 offset:0
    ds_read_b128 v[148:151], v236 offset:2048
    ds_read_b128 v[152:155], v236 offset:4096
    ds_read_b128 v[156:159], v236 offset:6144
    ds_read_b64_tr_b16 v[176:177], v237 offset:8192
    ds_read_b64_tr_b16 v[178:179], v237 offset:9216
    ds_read_b64_tr_b16 v[180:181], v238 offset:8192
    ds_read_b64_tr_b16 v[182:183], v238 offset:9216
    ds_read_b64_tr_b16 v[184:185], v239 offset:8192
    ds_read_b64_tr_b16 v[186:187], v239 offset:9216
    ds_read_b64_tr_b16 v[188:189], v240 offset:8192
    ds_read_b64_tr_b16 v[190:191], v240 offset:9216
    s_waitcnt lgkmcnt(12)
    v_mfma_f32_16x16x32_bf16 v[64:67], v[160:163], v[128:131], v[64:67]
    v_mfma_f32_16x16x32_bf16 v[68:71], v[160:163], v[132:135], v[68:71]
    v_mfma_f32_16x16x32_bf16 v[72:75], v[160:163], v[136:139], v[72:75]
    v_mfma_f32_16x16x32_bf16 v[76:79], v[160:163], v[140:143], v[76:79]
    v_mfma_f32_16x16x32_bf16 v[80:83], v[128:131], v[164:167], v[80:83]
    v_mfma_f32_16x16x32_bf16 v[84:87], v[132:135], v[164:167], v[84:87]
    v_mfma_f32_16x16x32_bf16 v[88:91], v[136:139], v[164:167], v[88:91]
    v_mfma_f32_16x16x32_bf16 v[92:95], v[140:143], v[164:167], v[92:95]
    v_mfma_f32_16x16x32_bf16 v[96:99], v[168:171], v[128:131], v[96:99]
    v_mfma_f32_16x16x32_bf16 v[100:103], v[168:171], v[132:135], v[100:103]
    v_mfma_f32_16x16x32_bf16 v[104:107], v[168:171], v[136:139], v[104:107]
    v_mfma_f32_16x16x32_bf16 v[108:111], v[168:171], v[140:143], v[108:111]
    v_mfma_f32_16x16x32_bf16 v[112:115], v[128:131], v[172:175], v[112:115]
    v_mfma_f32_16x16x32_bf16 v[116:119], v[132:135], v[172:175], v[116:119]
    v_mfma_f32_16x16x32_bf16 v[120:123], v[136:139], v[172:175], v[120:123]
    v_mfma_f32_16x16x32_bf16 v[124:127], v[140:143], v[172:175], v[124:127]
    s_waitcnt lgkmcnt(0)
    v_mfma_f32_16x16x32_bf16 v[64:67], v[176:179], v[144:147], v[64:67]
    v_mfma_f32_16x16x32_bf16 v[68:71], v[176:179], v[148:151], v[68:71]
    v_mfma_f32_16x16x32_bf16 v[72:75], v[176:179], v[152:155], v[72:75]
    v_mfma_f32_16x16x32_bf16 v[76:79], v[176:179], v[156:159], v[76:79]
    v_mfma_f32_16x16x32_bf16 v[80:83], v[144:147], v[180:183], v[80:83]
    v_mfma_f32_16x16x32_bf16 v[84:87], v[148:151], v[180:183], v[84:87]
    v_mfma_f32_16x16x32_bf16 v[88:91], v[152:155], v[180:183], v[88:91]
    v_mfma_f32_16x16x32_bf16 v[92:95], v[156:159], v[180:183], v[92:95]
    v_mfma_f32_16x16x32_bf16 v[96:99], v[184:187], v[144:147], v[96:99]
    v_mfma_f32_16x16x32_bf16 v[100:103], v[184:187], v[148:151], v[100:103]
    v_mfma_f32_16x16x32_bf16 v[104:107], v[184:187], v[152:155], v[104:107]
    v_mfma_f32_16x16x32_bf16 v[108:111], v[184:187], v[156:159], v[108:111]
    v_mfma_f32_16x16x32_bf16 v[112:115], v[144:147], v[188:191], v[112:115]
    v_mfma_f32_16x16x32_bf16 v[116:119], v[148:151], v[188:191], v[116:119]
    v_mfma_f32_16x16x32_bf16 v[120:123], v[152:155], v[188:191], v[120:123]
    v_mfma_f32_16x16x32_bf16 v[124:127], v[156:159], v[188:191], v[124:127]
    s_waitcnt vmcnt(8)
    ds_write_b128 v233, v[32:35] offset:16384
    ds_write_b128 v233, v[36:39] offset:20480
    ds_write_b128 v233, v[40:43] offset:24576
    ds_write_b128 v233, v[44:47] offset:28672
    ds_write_b128 v234, v[48:51] offset:16384
    ds_write_b128 v234, v[52:55] offset:20480
    ds_write_b128 v234, v[56:59] offset:24576
    ds_write_b128 v234, v[60:63] offset:28672
    s_waitcnt lgkmcnt(0)
    buffer_load_dwordx4 v[32:35], v232, s[16:19], s24 offen offset:896
    buffer_load_dwordx4 v[36:39], v232, s[16:19], s25 offen offset:896
    buffer_load_dwordx4 v[40:43], v232, s[16:19], s26 offen offset:896
    buffer_load_dwordx4 v[44:47], v232, s[16:19], s27 offen offset:896
    global_load_dwordx4 v[48:51], v[224:225], off
    global_load_dwordx4 v[52:55], v[226:227], off
    global_load_dwordx4 v[56:59], v[228:229], off
    global_load_dwordx4 v[60:63], v[230:231], off
    v_add_co_u32 v224, vcc, s31, v224
    v_addc_co_u32 v225, vcc, 0, v225, vcc
    v_add_co_u32 v226, vcc, s31, v226
    v_addc_co_u32 v227, vcc, 0, v227, vcc
    v_add_co_u32 v228, vcc, s31, v228
    v_addc_co_u32 v229, vcc, 0, v229, vcc
    v_add_co_u32 v230, vcc, s31, v230
    v_addc_co_u32 v231, vcc, 0, v231, vcc
    s_barrier
    ds_read_b128 v[128:131], v235 offset:16384
    ds_read_b128 v[132:135], v235 offset:18432
    ds_read_b128 v[136:139], v235 offset:20480
    ds_read_b128 v[140:143], v235 offset:22528
    ds_read_b64_tr_b16 v[160:161], v237 offset:16384
    ds_read_b64_tr_b16 v[162:163], v237 offset:17408
    ds_read_b64_tr_b16 v[164:165], v238 offset:16384
    ds_read_b64_tr_b16 v[166:167], v238 offset:17408
    ds_read_b64_tr_b16 v[168:169], v239 offset:16384
    ds_read_b64_tr_b16 v[170:171], v239 offset:17408
    ds_read_b64_tr_b16 v[172:173], v240 offset:16384
    ds_read_b64_tr_b16 v[174:175], v240 offset:17408
    ds_read_b128 v[144:147], v236 offset:16384
    ds_read_b128 v[148:151], v236 offset:18432
    ds_read_b128 v[152:155], v236 offset:20480
    ds_read_b128 v[156:159], v236 offset:22528
    ds_read_b64_tr_b16 v[176:177], v237 offset:24576
    ds_read_b64_tr_b16 v[178:179], v237 offset:25600
    ds_read_b64_tr_b16 v[180:181], v238 offset:24576
    ds_read_b64_tr_b16 v[182:183], v238 offset:25600
    ds_read_b64_tr_b16 v[184:185], v239 offset:24576
    ds_read_b64_tr_b16 v[186:187], v239 offset:25600
    ds_read_b64_tr_b16 v[188:189], v240 offset:24576
    ds_read_b64_tr_b16 v[190:191], v240 offset:25600
    s_waitcnt lgkmcnt(12)
    v_mfma_f32_16x16x32_bf16 v[64:67], v[160:163], v[128:131], v[64:67]
    v_mfma_f32_16x16x32_bf16 v[68:71], v[160:163], v[132:135], v[68:71]
    v_mfma_f32_16x16x32_bf16 v[72:75], v[160:163], v[136:139], v[72:75]
    v_mfma_f32_16x16x32_bf16 v[76:79], v[160:163], v[140:143], v[76:79]
    v_mfma_f32_16x16x32_bf16 v[80:83], v[128:131], v[164:167], v[80:83]
    v_mfma_f32_16x16x32_bf16 v[84:87], v[132:135], v[164:167], v[84:87]
    v_mfma_f32_16x16x32_bf16 v[88:91], v[136:139], v[164:167], v[88:91]
    v_mfma_f32_16x16x32_bf16 v[92:95], v[140:143], v[164:167], v[92:95]
    v_mfma_f32_16x16x32_bf16 v[96:99], v[168:171], v[128:131], v[96:99]
    v_mfma_f32_16x16x32_bf16 v[100:103], v[168:171], v[132:135], v[100:103]
    v_mfma_f32_16x16x32_bf16 v[104:107], v[168:171], v[136:139], v[104:107]
    v_mfma_f32_16x16x32_bf16 v[108:111], v[168:171], v[140:143], v[108:111]
    v_mfma_f32_16x16x32_bf16 v[112:115], v[128:131], v[172:175], v[112:115]
    v_mfma_f32_16x16x32_bf16 v[116:119], v[132:135], v[172:175], v[116:119]
    v_mfma_f32_16x16x32_bf16 v[120:123], v[136:139], v[172:175], v[120:123]
    v_mfma_f32_16x16x32_bf16 v[124:127], v[140:143], v[172:175], v[124:127]
    s_waitcnt lgkmcnt(0)
    v_mfma_f32_16x16x32_bf16 v[64:67], v[176:179], v[144:147], v[64:67]
    v_mfma_f32_16x16x32_bf16 v[68:71], v[176:179], v[148:151], v[68:71]
    v_mfma_f32_16x16x32_bf16 v[72:75], v[176:179], v[152:155], v[72:75]
    v_mfma_f32_16x16x32_bf16 v[76:79], v[176:179], v[156:159], v[76:79]
    v_mfma_f32_16x16x32_bf16 v[80:83], v[144:147], v[180:183], v[80:83]
    v_mfma_f32_16x16x32_bf16 v[84:87], v[148:151], v[180:183], v[84:87]
    v_mfma_f32_16x16x32_bf16 v[88:91], v[152:155], v[180:183], v[88:91]
    v_mfma_f32_16x16x32_bf16 v[92:95], v[156:159], v[180:183], v[92:95]
    v_mfma_f32_16x16x32_bf16 v[96:99], v[184:187], v[144:147], v[96:99]
    v_mfma_f32_16x16x32_bf16 v[100:103], v[184:187], v[148:151], v[100:103]
    v_mfma_f32_16x16x32_bf16 v[104:107], v[184:187], v[152:155], v[104:107]
    v_mfma_f32_16x16x32_bf16 v[108:111], v[184:187], v[156:159], v[108:111]
    v_mfma_f32_16x16x32_bf16 v[112:115], v[144:147], v[188:191], v[112:115]
    v_mfma_f32_16x16x32_bf16 v[116:119], v[148:151], v[188:191], v[116:119]
    v_mfma_f32_16x16x32_bf16 v[120:123], v[152:155], v[188:191], v[120:123]
    v_mfma_f32_16x16x32_bf16 v[124:127], v[156:159], v[188:191], v[124:127]
    s_waitcnt vmcnt(8)
    ds_write_b128 v233, v[192:195] offset:0
    ds_write_b128 v233, v[196:199] offset:4096
    ds_write_b128 v233, v[200:203] offset:8192
    ds_write_b128 v233, v[204:207] offset:12288
    ds_write_b128 v234, v[208:211] offset:0
    ds_write_b128 v234, v[212:215] offset:4096
    ds_write_b128 v234, v[216:219] offset:8192
    ds_write_b128 v234, v[220:223] offset:12288
    s_waitcnt lgkmcnt(0)
    s_barrier
    ds_read_b128 v[128:131], v235 offset:0
    ds_read_b128 v[132:135], v235 offset:2048
    ds_read_b128 v[136:139], v235 offset:4096
    ds_read_b128 v[140:143], v235 offset:6144
    ds_read_b64_tr_b16 v[160:161], v237 offset:0
    ds_read_b64_tr_b16 v[162:163], v237 offset:1024
    ds_read_b64_tr_b16 v[164:165], v238 offset:0
    ds_read_b64_tr_b16 v[166:167], v238 offset:1024
    ds_read_b64_tr_b16 v[168:169], v239 offset:0
    ds_read_b64_tr_b16 v[170:171], v239 offset:1024
    ds_read_b64_tr_b16 v[172:173], v240 offset:0
    ds_read_b64_tr_b16 v[174:175], v240 offset:1024
    ds_read_b128 v[144:147], v236 offset:0
    ds_read_b128 v[148:151], v236 offset:2048
    ds_read_b128 v[152:155], v236 offset:4096
    ds_read_b128 v[156:159], v236 offset:6144
    ds_read_b64_tr_b16 v[176:177], v237 offset:8192
    ds_read_b64_tr_b16 v[178:179], v237 offset:9216
    ds_read_b64_tr_b16 v[180:181], v238 offset:8192
    ds_read_b64_tr_b16 v[182:183], v238 offset:9216
    ds_read_b64_tr_b16 v[184:185], v239 offset:8192
    ds_read_b64_tr_b16 v[186:187], v239 offset:9216
    ds_read_b64_tr_b16 v[188:189], v240 offset:8192
    ds_read_b64_tr_b16 v[190:191], v240 offset:9216
    s_waitcnt lgkmcnt(12)
    v_mfma_f32_16x16x32_bf16 v[64:67], v[160:163], v[128:131], v[64:67]
    v_mfma_f32_16x16x32_bf16 v[68:71], v[160:163], v[132:135], v[68:71]
    v_mfma_f32_16x16x32_bf16 v[72:75], v[160:163], v[136:139], v[72:75]
    v_mfma_f32_16x16x32_bf16 v[76:79], v[160:163], v[140:143], v[76:79]
    v_mfma_f32_16x16x32_bf16 v[80:83], v[128:131], v[164:167], v[80:83]
    v_mfma_f32_16x16x32_bf16 v[84:87], v[132:135], v[164:167], v[84:87]
    v_mfma_f32_16x16x32_bf16 v[88:91], v[136:139], v[164:167], v[88:91]
    v_mfma_f32_16x16x32_bf16 v[92:95], v[140:143], v[164:167], v[92:95]
    v_mfma_f32_16x16x32_bf16 v[96:99], v[168:171], v[128:131], v[96:99]
    v_mfma_f32_16x16x32_bf16 v[100:103], v[168:171], v[132:135], v[100:103]
    v_mfma_f32_16x16x32_bf16 v[104:107], v[168:171], v[136:139], v[104:107]
    v_mfma_f32_16x16x32_bf16 v[108:111], v[168:171], v[140:143], v[108:111]
    v_mfma_f32_16x16x32_bf16 v[112:115], v[128:131], v[172:175], v[112:115]
    v_mfma_f32_16x16x32_bf16 v[116:119], v[132:135], v[172:175], v[116:119]
    v_mfma_f32_16x16x32_bf16 v[120:123], v[136:139], v[172:175], v[120:123]
    v_mfma_f32_16x16x32_bf16 v[124:127], v[140:143], v[172:175], v[124:127]
    s_waitcnt lgkmcnt(0)
    v_mfma_f32_16x16x32_bf16 v[64:67], v[176:179], v[144:147], v[64:67]
    v_mfma_f32_16x16x32_bf16 v[68:71], v[176:179], v[148:151], v[68:71]
    v_mfma_f32_16x16x32_bf16 v[72:75], v[176:179], v[152:155], v[72:75]
    v_mfma_f32_16x16x32_bf16 v[76:79], v[176:179], v[156:159], v[76:79]
    v_mfma_f32_16x16x32_bf16 v[80:83], v[144:147], v[180:183], v[80:83]
    v_mfma_f32_16x16x32_bf16 v[84:87], v[148:151], v[180:183], v[84:87]
    v_mfma_f32_16x16x32_bf16 v[88:91], v[152:155], v[180:183], v[88:91]
    v_mfma_f32_16x16x32_bf16 v[92:95], v[156:159], v[180:183], v[92:95]
    v_mfma_f32_16x16x32_bf16 v[96:99], v[184:187], v[144:147], v[96:99]
    v_mfma_f32_16x16x32_bf16 v[100:103], v[184:187], v[148:151], v[100:103]
    v_mfma_f32_16x16x32_bf16 v[104:107], v[184:187], v[152:155], v[104:107]
    v_mfma_f32_16x16x32_bf16 v[108:111], v[184:187], v[156:159], v[108:111]
    v_mfma_f32_16x16x32_bf16 v[112:115], v[144:147], v[188:191], v[112:115]
    v_mfma_f32_16x16x32_bf16 v[116:119], v[148:151], v[188:191], v[116:119]
    v_mfma_f32_16x16x32_bf16 v[120:123], v[152:155], v[188:191], v[120:123]
    v_mfma_f32_16x16x32_bf16 v[124:127], v[156:159], v[188:191], v[124:127]
    s_waitcnt vmcnt(0)
    ds_write_b128 v233, v[32:35] offset:16384
    ds_write_b128 v233, v[36:39] offset:20480
    ds_write_b128 v233, v[40:43] offset:24576
    ds_write_b128 v233, v[44:47] offset:28672
    ds_write_b128 v234, v[48:51] offset:16384
    ds_write_b128 v234, v[52:55] offset:20480
    ds_write_b128 v234, v[56:59] offset:24576
    ds_write_b128 v234, v[60:63] offset:28672
    s_waitcnt lgkmcnt(0)
    s_barrier
    ds_read_b128 v[128:131], v235 offset:16384
    ds_read_b128 v[132:135], v235 offset:18432
    ds_read_b128 v[136:139], v235 offset:20480
    ds_read_b128 v[140:143], v235 offset:22528
    ds_read_b64_tr_b16 v[160:161], v237 offset:16384
    ds_read_b64_tr_b16 v[162:163], v237 offset:17408
    ds_read_b64_tr_b16 v[164:165], v238 offset:16384
    ds_read_b64_tr_b16 v[166:167], v238 offset:17408
    ds_read_b64_tr_b16 v[168:169], v239 offset:16384
    ds_read_b64_tr_b16 v[170:171], v239 offset:17408
    ds_read_b64_tr_b16 v[172:173], v240 offset:16384
    ds_read_b64_tr_b16 v[174:175], v240 offset:17408
    ds_read_b128 v[144:147], v236 offset:16384
    ds_read_b128 v[148:151], v236 offset:18432
    ds_read_b128 v[152:155], v236 offset:20480
    ds_read_b128 v[156:159], v236 offset:22528
    ds_read_b64_tr_b16 v[176:177], v237 offset:24576
    ds_read_b64_tr_b16 v[178:179], v237 offset:25600
    ds_read_b64_tr_b16 v[180:181], v238 offset:24576
    ds_read_b64_tr_b16 v[182:183], v238 offset:25600
    ds_read_b64_tr_b16 v[184:185], v239 offset:24576
    ds_read_b64_tr_b16 v[186:187], v239 offset:25600
    ds_read_b64_tr_b16 v[188:189], v240 offset:24576
    ds_read_b64_tr_b16 v[190:191], v240 offset:25600
    s_waitcnt lgkmcnt(12)
    v_mfma_f32_16x16x32_bf16 v[64:67], v[160:163], v[128:131], v[64:67]
    v_mfma_f32_16x16x32_bf16 v[68:71], v[160:163], v[132:135], v[68:71]
    v_mfma_f32_16x16x32_bf16 v[72:75], v[160:163], v[136:139], v[72:75]
    v_mfma_f32_16x16x32_bf16 v[76:79], v[160:163], v[140:143], v[76:79]
    v_mfma_f32_16x16x32_bf16 v[80:83], v[128:131], v[164:167], v[80:83]
    v_mfma_f32_16x16x32_bf16 v[84:87], v[132:135], v[164:167], v[84:87]
    v_mfma_f32_16x16x32_bf16 v[88:91], v[136:139], v[164:167], v[88:91]
    v_mfma_f32_16x16x32_bf16 v[92:95], v[140:143], v[164:167], v[92:95]
    v_mfma_f32_16x16x32_bf16 v[96:99], v[168:171], v[128:131], v[96:99]
    v_mfma_f32_16x16x32_bf16 v[100:103], v[168:171], v[132:135], v[100:103]
    v_mfma_f32_16x16x32_bf16 v[104:107], v[168:171], v[136:139], v[104:107]
    v_mfma_f32_16x16x32_bf16 v[108:111], v[168:171], v[140:143], v[108:111]
    v_mfma_f32_16x16x32_bf16 v[112:115], v[128:131], v[172:175], v[112:115]
    v_mfma_f32_16x16x32_bf16 v[116:119], v[132:135], v[172:175], v[116:119]
    v_mfma_f32_16x16x32_bf16 v[120:123], v[136:139], v[172:175], v[120:123]
    v_mfma_f32_16x16x32_bf16 v[124:127], v[140:143], v[172:175], v[124:127]
    s_waitcnt lgkmcnt(0)
    v_mfma_f32_16x16x32_bf16 v[64:67], v[176:179], v[144:147], v[64:67]
    v_mfma_f32_16x16x32_bf16 v[68:71], v[176:179], v[148:151], v[68:71]
    v_mfma_f32_16x16x32_bf16 v[72:75], v[176:179], v[152:155], v[72:75]
    v_mfma_f32_16x16x32_bf16 v[76:79], v[176:179], v[156:159], v[76:79]
    v_mfma_f32_16x16x32_bf16 v[80:83], v[144:147], v[180:183], v[80:83]
    v_mfma_f32_16x16x32_bf16 v[84:87], v[148:151], v[180:183], v[84:87]
    v_mfma_f32_16x16x32_bf16 v[88:91], v[152:155], v[180:183], v[88:91]
    v_mfma_f32_16x16x32_bf16 v[92:95], v[156:159], v[180:183], v[92:95]
    v_mfma_f32_16x16x32_bf16 v[96:99], v[184:187], v[144:147], v[96:99]
    v_mfma_f32_16x16x32_bf16 v[100:103], v[184:187], v[148:151], v[100:103]
    v_mfma_f32_16x16x32_bf16 v[104:107], v[184:187], v[152:155], v[104:107]
    v_mfma_f32_16x16x32_bf16 v[108:111], v[184:187], v[156:159], v[108:111]
    v_mfma_f32_16x16x32_bf16 v[112:115], v[144:147], v[188:191], v[112:115]
    v_mfma_f32_16x16x32_bf16 v[116:119], v[148:151], v[188:191], v[116:119]
    v_mfma_f32_16x16x32_bf16 v[120:123], v[152:155], v[188:191], v[120:123]
    v_mfma_f32_16x16x32_bf16 v[124:127], v[156:159], v[188:191], v[124:127]
    s_barrier
    s_nop 7
    s_nop 7
    v_lshlrev_b32 v23, 12, v2
    v_and_b32 v3, 15, v1
    v_lshlrev_b32 v4, 6, v3
    v_lshrrev_b32 v5, 4, v1
    v_lshlrev_b32 v6, 4, v5
    v_add3_u32 v23, v23, v4, v6
    v_lshrrev_b32 v4, 2, v3
    v_and_b32 v6, 3, v3
    v_lshlrev_b32 v7, 2, v5
    v_add_u32 v7, v7, v4
    v_lshlrev_b32 v7, 6, v7
    v_lshlrev_b32 v6, 3, v6
    v_lshlrev_b32 v28, 12, v2
    v_add3_u32 v28, v28, v7, v6
    v_readfirstlane_b32 s37, v2
    s_and_b32 s37, s37, 1
    s_lshl_b32 s37, s37, 1
    s_lshl_b32 s38, s29, 2
    s_add_u32 s37, s37, s38
    v_lshlrev_b32 v29, 7, v3
    v_lshlrev_b32 v4, 4, v5
    v_add_u32 v29, v29, v4
    v_lshlrev_b32 v30, 4, v5
    v_mov_b32 v19, v3
    v_mov_b32 v31, 0x3f803f80
    s_add_u32 s38, s37, 0
    s_mul_i32 s39, s38, 2176
    s_add_u32 s39, s39, 13631488
    s_lshl_b32 s38, s38, 9
    buffer_load_ushort v3, v22, s[20:23], s38 offen offset:0
    buffer_load_ushort v4, v22, s[20:23], s38 offen offset:32
    buffer_load_ushort v5, v22, s[20:23], s38 offen offset:64
    buffer_load_ushort v6, v22, s[20:23], s38 offen offset:96
    s_waitcnt vmcnt(0)
    v_lshl_or_b32 v24, v4, 16, v3
    v_lshl_or_b32 v25, v6, 16, v5
    v_cvt_pk_bf16_f32 v26, v64, v65
    v_cvt_pk_bf16_f32 v27, v66, v67
    s_nop 1
    v_mfma_f32_16x16x16_bf16 v[64:67], v[24:25], v[26:27], 0
    v_cvt_pk_bf16_f32 v26, v68, v69
    v_cvt_pk_bf16_f32 v27, v70, v71
    s_nop 1
    v_mfma_f32_16x16x16_bf16 v[68:71], v[24:25], v[26:27], 0
    v_cvt_pk_bf16_f32 v26, v72, v73
    v_cvt_pk_bf16_f32 v27, v74, v75
    s_nop 1
    v_mfma_f32_16x16x16_bf16 v[72:75], v[24:25], v[26:27], 0
    v_cvt_pk_bf16_f32 v26, v76, v77
    v_cvt_pk_bf16_f32 v27, v78, v79
    s_nop 1
    v_mfma_f32_16x16x16_bf16 v[76:79], v[24:25], v[26:27], 0
    s_nop 7
    s_nop 7
    v_cvt_pk_bf16_f32 v5, v64, v65
    v_lshlrev_b32 v64, 16, v5
    v_and_b32 v65, 0xffff0000, v5
    v_cvt_pk_bf16_f32 v5, v66, v67
    v_lshlrev_b32 v66, 16, v5
    v_and_b32 v67, 0xffff0000, v5
    v_cvt_pk_bf16_f32 v5, v68, v69
    v_lshlrev_b32 v68, 16, v5
    v_and_b32 v69, 0xffff0000, v5
    v_cvt_pk_bf16_f32 v5, v70, v71
    v_lshlrev_b32 v70, 16, v5
    v_and_b32 v71, 0xffff0000, v5
    v_cvt_pk_bf16_f32 v5, v72, v73
    v_lshlrev_b32 v72, 16, v5
    v_and_b32 v73, 0xffff0000, v5
    v_cvt_pk_bf16_f32 v5, v74, v75
    v_lshlrev_b32 v74, 16, v5
    v_and_b32 v75, 0xffff0000, v5
    v_cvt_pk_bf16_f32 v5, v76, v77
    v_lshlrev_b32 v76, 16, v5
    v_and_b32 v77, 0xffff0000, v5
    v_cvt_pk_bf16_f32 v5, v78, v79
    v_lshlrev_b32 v78, 16, v5
    v_and_b32 v79, 0xffff0000, v5
    v_max_f32 v32, v64, v65
    v_max3_f32 v32, v32, v66, v67
    v_min_f32 v36, v64, v65
    v_min3_f32 v36, v36, v66, v67
    v_max_f32 v33, v68, v69
    v_max3_f32 v33, v33, v70, v71
    v_min_f32 v37, v68, v69
    v_min3_f32 v37, v37, v70, v71
    v_max_f32 v34, v72, v73
    v_max3_f32 v34, v34, v74, v75
    v_min_f32 v38, v72, v73
    v_min3_f32 v38, v38, v74, v75
    v_max_f32 v35, v76, v77
    v_max3_f32 v35, v35, v78, v79
    v_min_f32 v39, v76, v77
    v_min3_f32 v39, v39, v78, v79
    ds_bpermute_b32 v40, v20, v32
    ds_bpermute_b32 v44, v20, v36
    ds_bpermute_b32 v41, v20, v33
    ds_bpermute_b32 v45, v20, v37
    ds_bpermute_b32 v42, v20, v34
    ds_bpermute_b32 v46, v20, v38
    ds_bpermute_b32 v43, v20, v35
    ds_bpermute_b32 v47, v20, v39
    s_waitcnt lgkmcnt(0)
    v_max_f32 v32, v32, v40
    v_min_f32 v36, v36, v44
    v_max_f32 v33, v33, v41
    v_min_f32 v37, v37, v45
    v_max_f32 v34, v34, v42
    v_min_f32 v38, v38, v46
    v_max_f32 v35, v35, v43
    v_min_f32 v39, v39, v47
    ds_bpermute_b32 v40, v21, v32
    ds_bpermute_b32 v44, v21, v36
    ds_bpermute_b32 v41, v21, v33
    ds_bpermute_b32 v45, v21, v37
    ds_bpermute_b32 v42, v21, v34
    ds_bpermute_b32 v46, v21, v38
    ds_bpermute_b32 v43, v21, v35
    ds_bpermute_b32 v47, v21, v39
    s_waitcnt lgkmcnt(0)
    v_max_f32 v32, v32, v40
    v_min_f32 v36, v36, v44
    v_max_f32 v33, v33, v41
    v_min_f32 v37, v37, v45
    v_max_f32 v34, v34, v42
    v_min_f32 v38, v38, v46
    v_max_f32 v35, v35, v43
    v_min_f32 v39, v39, v47
    s_mov_b32 s40, 1069066811
    v_sub_f32 v48, v36, v64
    v_mul_f32 v48, s40, v48
    v_exp_f32 v48, v48
    v_sub_f32 v64, v64, v32
    v_mul_f32 v64, s40, v64
    v_exp_f32 v64, v64
    v_sub_f32 v49, v36, v65
    v_mul_f32 v49, s40, v49
    v_exp_f32 v49, v49
    v_sub_f32 v65, v65, v32
    v_mul_f32 v65, s40, v65
    v_exp_f32 v65, v65
    v_sub_f32 v50, v36, v66
    v_mul_f32 v50, s40, v50
    v_exp_f32 v50, v50
    v_sub_f32 v66, v66, v32
    v_mul_f32 v66, s40, v66
    v_exp_f32 v66, v66
    v_sub_f32 v51, v36, v67
    v_mul_f32 v51, s40, v51
    v_exp_f32 v51, v51
    v_sub_f32 v67, v67, v32
    v_mul_f32 v67, s40, v67
    v_exp_f32 v67, v67
    v_sub_f32 v52, v37, v68
    v_mul_f32 v52, s40, v52
    v_exp_f32 v52, v52
    v_sub_f32 v68, v68, v33
    v_mul_f32 v68, s40, v68
    v_exp_f32 v68, v68
    v_sub_f32 v53, v37, v69
    v_mul_f32 v53, s40, v53
    v_exp_f32 v53, v53
    v_sub_f32 v69, v69, v33
    v_mul_f32 v69, s40, v69
    v_exp_f32 v69, v69
    v_sub_f32 v54, v37, v70
    v_mul_f32 v54, s40, v54
    v_exp_f32 v54, v54
    v_sub_f32 v70, v70, v33
    v_mul_f32 v70, s40, v70
    v_exp_f32 v70, v70
    v_sub_f32 v55, v37, v71
    v_mul_f32 v55, s40, v55
    v_exp_f32 v55, v55
    v_sub_f32 v71, v71, v33
    v_mul_f32 v71, s40, v71
    v_exp_f32 v71, v71
    v_sub_f32 v56, v38, v72
    v_mul_f32 v56, s40, v56
    v_exp_f32 v56, v56
    v_sub_f32 v72, v72, v34
    v_mul_f32 v72, s40, v72
    v_exp_f32 v72, v72
    v_sub_f32 v57, v38, v73
    v_mul_f32 v57, s40, v57
    v_exp_f32 v57, v57
    v_sub_f32 v73, v73, v34
    v_mul_f32 v73, s40, v73
    v_exp_f32 v73, v73
    v_sub_f32 v58, v38, v74
    v_mul_f32 v58, s40, v58
    v_exp_f32 v58, v58
    v_sub_f32 v74, v74, v34
    v_mul_f32 v74, s40, v74
    v_exp_f32 v74, v74
    v_sub_f32 v59, v38, v75
    v_mul_f32 v59, s40, v59
    v_exp_f32 v59, v59
    v_sub_f32 v75, v75, v34
    v_mul_f32 v75, s40, v75
    v_exp_f32 v75, v75
    v_sub_f32 v60, v39, v76
    v_mul_f32 v60, s40, v60
    v_exp_f32 v60, v60
    v_sub_f32 v76, v76, v35
    v_mul_f32 v76, s40, v76
    v_exp_f32 v76, v76
    v_sub_f32 v61, v39, v77
    v_mul_f32 v61, s40, v61
    v_exp_f32 v61, v61
    v_sub_f32 v77, v77, v35
    v_mul_f32 v77, s40, v77
    v_exp_f32 v77, v77
    v_sub_f32 v62, v39, v78
    v_mul_f32 v62, s40, v62
    v_exp_f32 v62, v62
    v_sub_f32 v78, v78, v35
    v_mul_f32 v78, s40, v78
    v_exp_f32 v78, v78
    v_sub_f32 v63, v39, v79
    v_mul_f32 v63, s40, v63
    v_exp_f32 v63, v63
    v_sub_f32 v79, v79, v35
    v_mul_f32 v79, s40, v79
    v_exp_f32 v79, v79
    s_nop 0
    v_add_f32 v32, v64, v65
    v_add_f32 v32, v32, v66
    v_add_f32 v32, v32, v67
    v_add_f32 v36, v48, v49
    v_add_f32 v36, v36, v50
    v_add_f32 v36, v36, v51
    v_add_f32 v33, v68, v69
    v_add_f32 v33, v33, v70
    v_add_f32 v33, v33, v71
    v_add_f32 v37, v52, v53
    v_add_f32 v37, v37, v54
    v_add_f32 v37, v37, v55
    v_add_f32 v34, v72, v73
    v_add_f32 v34, v34, v74
    v_add_f32 v34, v34, v75
    v_add_f32 v38, v56, v57
    v_add_f32 v38, v38, v58
    v_add_f32 v38, v38, v59
    v_add_f32 v35, v76, v77
    v_add_f32 v35, v35, v78
    v_add_f32 v35, v35, v79
    v_add_f32 v39, v60, v61
    v_add_f32 v39, v39, v62
    v_add_f32 v39, v39, v63
    ds_bpermute_b32 v40, v20, v32
    ds_bpermute_b32 v44, v20, v36
    ds_bpermute_b32 v41, v20, v33
    ds_bpermute_b32 v45, v20, v37
    ds_bpermute_b32 v42, v20, v34
    ds_bpermute_b32 v46, v20, v38
    ds_bpermute_b32 v43, v20, v35
    ds_bpermute_b32 v47, v20, v39
    s_waitcnt lgkmcnt(0)
    v_add_f32 v32, v32, v40
    v_add_f32 v36, v36, v44
    v_add_f32 v33, v33, v41
    v_add_f32 v37, v37, v45
    v_add_f32 v34, v34, v42
    v_add_f32 v38, v38, v46
    v_add_f32 v35, v35, v43
    v_add_f32 v39, v39, v47
    ds_bpermute_b32 v40, v21, v32
    ds_bpermute_b32 v44, v21, v36
    ds_bpermute_b32 v41, v21, v33
    ds_bpermute_b32 v45, v21, v37
    ds_bpermute_b32 v42, v21, v34
    ds_bpermute_b32 v46, v21, v38
    ds_bpermute_b32 v43, v21, v35
    ds_bpermute_b32 v47, v21, v39
    s_waitcnt lgkmcnt(0)
    v_add_f32 v32, v32, v40
    v_add_f32 v36, v36, v44
    v_add_f32 v33, v33, v41
    v_add_f32 v37, v37, v45
    v_add_f32 v34, v34, v42
    v_add_f32 v38, v38, v46
    v_add_f32 v35, v35, v43
    v_add_f32 v39, v39, v47
    v_rcp_f32 v32, v32
    v_rcp_f32 v36, v36
    v_rcp_f32 v33, v33
    v_rcp_f32 v37, v37
    v_rcp_f32 v34, v34
    v_rcp_f32 v38, v38
    v_rcp_f32 v35, v35
    v_rcp_f32 v39, v39
    s_nop 0
    v_mul_f32 v64, v64, v32
    v_mul_f32 v48, v48, v36
    v_mul_f32 v65, v65, v32
    v_mul_f32 v49, v49, v36
    v_mul_f32 v66, v66, v32
    v_mul_f32 v50, v50, v36
    v_mul_f32 v67, v67, v32
    v_mul_f32 v51, v51, v36
    v_cvt_pk_bf16_f32 v50, v50, v51
    v_cvt_pk_bf16_f32 v51, v48, v49
    v_cvt_pk_bf16_f32 v48, v64, v65
    v_cvt_pk_bf16_f32 v49, v66, v67
    v_mov_b32 v3, v50
    v_mov_b32 v50, v51
    v_mov_b32 v51, v3
    v_mul_f32 v68, v68, v33
    v_mul_f32 v52, v52, v37
    v_mul_f32 v69, v69, v33
    v_mul_f32 v53, v53, v37
    v_mul_f32 v70, v70, v33
    v_mul_f32 v54, v54, v37
    v_mul_f32 v71, v71, v33
    v_mul_f32 v55, v55, v37
    v_cvt_pk_bf16_f32 v54, v54, v55
    v_cvt_pk_bf16_f32 v55, v52, v53
    v_cvt_pk_bf16_f32 v52, v68, v69
    v_cvt_pk_bf16_f32 v53, v70, v71
    v_mov_b32 v3, v54
    v_mov_b32 v54, v55
    v_mov_b32 v55, v3
    v_mul_f32 v72, v72, v34
    v_mul_f32 v56, v56, v38
    v_mul_f32 v73, v73, v34
    v_mul_f32 v57, v57, v38
    v_mul_f32 v74, v74, v34
    v_mul_f32 v58, v58, v38
    v_mul_f32 v75, v75, v34
    v_mul_f32 v59, v59, v38
    v_cvt_pk_bf16_f32 v58, v58, v59
    v_cvt_pk_bf16_f32 v59, v56, v57
    v_cvt_pk_bf16_f32 v56, v72, v73
    v_cvt_pk_bf16_f32 v57, v74, v75
    v_mov_b32 v3, v58
    v_mov_b32 v58, v59
    v_mov_b32 v59, v3
    v_mul_f32 v76, v76, v35
    v_mul_f32 v60, v60, v39
    v_mul_f32 v77, v77, v35
    v_mul_f32 v61, v61, v39
    v_mul_f32 v78, v78, v35
    v_mul_f32 v62, v62, v39
    v_mul_f32 v79, v79, v35
    v_mul_f32 v63, v63, v39
    v_cvt_pk_bf16_f32 v62, v62, v63
    v_cvt_pk_bf16_f32 v63, v60, v61
    v_cvt_pk_bf16_f32 v60, v76, v77
    v_cvt_pk_bf16_f32 v61, v78, v79
    v_mov_b32 v3, v62
    v_mov_b32 v62, v63
    v_mov_b32 v63, v3
    ds_write_b128 v23, v[48:51] offset:0
    ds_write_b128 v23, v[52:55] offset:1024
    ds_write_b128 v23, v[56:59] offset:2048
    ds_write_b128 v23, v[60:63] offset:3072
    v_cvt_pk_bf16_f32 v128, v80, v81
    v_cvt_pk_bf16_f32 v129, v82, v83
    v_cvt_pk_bf16_f32 v130, v84, v85
    v_cvt_pk_bf16_f32 v131, v86, v87
    v_cvt_pk_bf16_f32 v132, v88, v89
    v_cvt_pk_bf16_f32 v133, v90, v91
    v_cvt_pk_bf16_f32 v134, v92, v93
    v_cvt_pk_bf16_f32 v135, v94, v95
    s_waitcnt lgkmcnt(0)
    ds_read_b64_tr_b16 v[136:137], v28 offset:0
    ds_read_b64_tr_b16 v[138:139], v28 offset:1024
    ds_read_b64_tr_b16 v[140:141], v28 offset:2048
    ds_read_b64_tr_b16 v[142:143], v28 offset:3072
    ds_read_b64_tr_b16 v[144:145], v28 offset:32
    ds_read_b64_tr_b16 v[146:147], v28 offset:1056
    ds_read_b64_tr_b16 v[148:149], v28 offset:2080
    ds_read_b64_tr_b16 v[150:151], v28 offset:3104
    s_waitcnt lgkmcnt(0)
    v_mfma_f32_16x16x32_bf16 v[152:155], v[136:139], v[128:131], 0
    v_mfma_f32_16x16x32_bf16 v[152:155], v[140:143], v[132:135], v[152:155]
    v_mfma_f32_16x16x32_bf16 v[156:159], v[144:147], v[128:131], 0
    v_mfma_f32_16x16x32_bf16 v[156:159], v[148:151], v[132:135], v[156:159]
    v_mov_b32 v168, v31
    v_mov_b32 v169, v31
    v_mov_b32 v170, v31
    v_mov_b32 v171, v31
    s_nop 1
    v_mfma_f32_16x16x32_bf16 v[160:163], v[136:139], v[168:171], 0
    v_mfma_f32_16x16x32_bf16 v[160:163], v[140:143], v[168:171], v[160:163]
    v_mfma_f32_16x16x32_bf16 v[164:167], v[144:147], v[168:171], 0
    v_mfma_f32_16x16x32_bf16 v[164:167], v[148:151], v[168:171], v[164:167]
    s_nop 7
    s_nop 7
    buffer_atomic_add_f32 v152, v29, s[16:19], s39 offen offset:0
    buffer_atomic_add_f32 v153, v29, s[16:19], s39 offen offset:4
    buffer_atomic_add_f32 v154, v29, s[16:19], s39 offen offset:8
    buffer_atomic_add_f32 v155, v29, s[16:19], s39 offen offset:12
    buffer_atomic_add_f32 v156, v29, s[16:19], s39 offen offset:64
    buffer_atomic_add_f32 v157, v29, s[16:19], s39 offen offset:68
    buffer_atomic_add_f32 v158, v29, s[16:19], s39 offen offset:72
    buffer_atomic_add_f32 v159, v29, s[16:19], s39 offen offset:76
    v_cmp_eq_u32 vcc, 0, v19
    s_and_saveexec_b64 s[42:43], vcc
    buffer_atomic_add_f32 v160, v30, s[16:19], s39 offen offset:2048
    buffer_atomic_add_f32 v161, v30, s[16:19], s39 offen offset:2052
    buffer_atomic_add_f32 v162, v30, s[16:19], s39 offen offset:2056
    buffer_atomic_add_f32 v163, v30, s[16:19], s39 offen offset:2060
    buffer_atomic_add_f32 v164, v30, s[16:19], s39 offen offset:2112
    buffer_atomic_add_f32 v165, v30, s[16:19], s39 offen offset:2116
    buffer_atomic_add_f32 v166, v30, s[16:19], s39 offen offset:2120
    buffer_atomic_add_f32 v167, v30, s[16:19], s39 offen offset:2124
    s_mov_b64 exec, s[42:43]
    s_waitcnt vmcnt(0)
    s_add_u32 s38, s37, 1
    s_mul_i32 s39, s38, 2176
    s_add_u32 s39, s39, 13631488
    s_lshl_b32 s38, s38, 9
    buffer_load_ushort v3, v22, s[20:23], s38 offen offset:0
    buffer_load_ushort v4, v22, s[20:23], s38 offen offset:32
    buffer_load_ushort v5, v22, s[20:23], s38 offen offset:64
    buffer_load_ushort v6, v22, s[20:23], s38 offen offset:96
    s_waitcnt vmcnt(0)
    v_lshl_or_b32 v24, v4, 16, v3
    v_lshl_or_b32 v25, v6, 16, v5
    v_cvt_pk_bf16_f32 v26, v96, v97
    v_cvt_pk_bf16_f32 v27, v98, v99
    s_nop 1
    v_mfma_f32_16x16x16_bf16 v[96:99], v[24:25], v[26:27], 0
    v_cvt_pk_bf16_f32 v26, v100, v101
    v_cvt_pk_bf16_f32 v27, v102, v103
    s_nop 1
    v_mfma_f32_16x16x16_bf16 v[100:103], v[24:25], v[26:27], 0
    v_cvt_pk_bf16_f32 v26, v104, v105
    v_cvt_pk_bf16_f32 v27, v106, v107
    s_nop 1
    v_mfma_f32_16x16x16_bf16 v[104:107], v[24:25], v[26:27], 0
    v_cvt_pk_bf16_f32 v26, v108, v109
    v_cvt_pk_bf16_f32 v27, v110, v111
    s_nop 1
    v_mfma_f32_16x16x16_bf16 v[108:111], v[24:25], v[26:27], 0
    s_nop 7
    s_nop 7
    v_cvt_pk_bf16_f32 v5, v96, v97
    v_lshlrev_b32 v96, 16, v5
    v_and_b32 v97, 0xffff0000, v5
    v_cvt_pk_bf16_f32 v5, v98, v99
    v_lshlrev_b32 v98, 16, v5
    v_and_b32 v99, 0xffff0000, v5
    v_cvt_pk_bf16_f32 v5, v100, v101
    v_lshlrev_b32 v100, 16, v5
    v_and_b32 v101, 0xffff0000, v5
    v_cvt_pk_bf16_f32 v5, v102, v103
    v_lshlrev_b32 v102, 16, v5
    v_and_b32 v103, 0xffff0000, v5
    v_cvt_pk_bf16_f32 v5, v104, v105
    v_lshlrev_b32 v104, 16, v5
    v_and_b32 v105, 0xffff0000, v5
    v_cvt_pk_bf16_f32 v5, v106, v107
    v_lshlrev_b32 v106, 16, v5
    v_and_b32 v107, 0xffff0000, v5
    v_cvt_pk_bf16_f32 v5, v108, v109
    v_lshlrev_b32 v108, 16, v5
    v_and_b32 v109, 0xffff0000, v5
    v_cvt_pk_bf16_f32 v5, v110, v111
    v_lshlrev_b32 v110, 16, v5
    v_and_b32 v111, 0xffff0000, v5
    v_max_f32 v32, v96, v97
    v_max3_f32 v32, v32, v98, v99
    v_min_f32 v36, v96, v97
    v_min3_f32 v36, v36, v98, v99
    v_max_f32 v33, v100, v101
    v_max3_f32 v33, v33, v102, v103
    v_min_f32 v37, v100, v101
    v_min3_f32 v37, v37, v102, v103
    v_max_f32 v34, v104, v105
    v_max3_f32 v34, v34, v106, v107
    v_min_f32 v38, v104, v105
    v_min3_f32 v38, v38, v106, v107
    v_max_f32 v35, v108, v109
    v_max3_f32 v35, v35, v110, v111
    v_min_f32 v39, v108, v109
    v_min3_f32 v39, v39, v110, v111
    ds_bpermute_b32 v40, v20, v32
    ds_bpermute_b32 v44, v20, v36
    ds_bpermute_b32 v41, v20, v33
    ds_bpermute_b32 v45, v20, v37
    ds_bpermute_b32 v42, v20, v34
    ds_bpermute_b32 v46, v20, v38
    ds_bpermute_b32 v43, v20, v35
    ds_bpermute_b32 v47, v20, v39
    s_waitcnt lgkmcnt(0)
    v_max_f32 v32, v32, v40
    v_min_f32 v36, v36, v44
    v_max_f32 v33, v33, v41
    v_min_f32 v37, v37, v45
    v_max_f32 v34, v34, v42
    v_min_f32 v38, v38, v46
    v_max_f32 v35, v35, v43
    v_min_f32 v39, v39, v47
    ds_bpermute_b32 v40, v21, v32
    ds_bpermute_b32 v44, v21, v36
    ds_bpermute_b32 v41, v21, v33
    ds_bpermute_b32 v45, v21, v37
    ds_bpermute_b32 v42, v21, v34
    ds_bpermute_b32 v46, v21, v38
    ds_bpermute_b32 v43, v21, v35
    ds_bpermute_b32 v47, v21, v39
    s_waitcnt lgkmcnt(0)
    v_max_f32 v32, v32, v40
    v_min_f32 v36, v36, v44
    v_max_f32 v33, v33, v41
    v_min_f32 v37, v37, v45
    v_max_f32 v34, v34, v42
    v_min_f32 v38, v38, v46
    v_max_f32 v35, v35, v43
    v_min_f32 v39, v39, v47
    s_mov_b32 s40, 1069066811
    v_sub_f32 v48, v36, v96
    v_mul_f32 v48, s40, v48
    v_exp_f32 v48, v48
    v_sub_f32 v96, v96, v32
    v_mul_f32 v96, s40, v96
    v_exp_f32 v96, v96
    v_sub_f32 v49, v36, v97
    v_mul_f32 v49, s40, v49
    v_exp_f32 v49, v49
    v_sub_f32 v97, v97, v32
    v_mul_f32 v97, s40, v97
    v_exp_f32 v97, v97
    v_sub_f32 v50, v36, v98
    v_mul_f32 v50, s40, v50
    v_exp_f32 v50, v50
    v_sub_f32 v98, v98, v32
    v_mul_f32 v98, s40, v98
    v_exp_f32 v98, v98
    v_sub_f32 v51, v36, v99
    v_mul_f32 v51, s40, v51
    v_exp_f32 v51, v51
    v_sub_f32 v99, v99, v32
    v_mul_f32 v99, s40, v99
    v_exp_f32 v99, v99
    v_sub_f32 v52, v37, v100
    v_mul_f32 v52, s40, v52
    v_exp_f32 v52, v52
    v_sub_f32 v100, v100, v33
    v_mul_f32 v100, s40, v100
    v_exp_f32 v100, v100
    v_sub_f32 v53, v37, v101
    v_mul_f32 v53, s40, v53
    v_exp_f32 v53, v53
    v_sub_f32 v101, v101, v33
    v_mul_f32 v101, s40, v101
    v_exp_f32 v101, v101
    v_sub_f32 v54, v37, v102
    v_mul_f32 v54, s40, v54
    v_exp_f32 v54, v54
    v_sub_f32 v102, v102, v33
    v_mul_f32 v102, s40, v102
    v_exp_f32 v102, v102
    v_sub_f32 v55, v37, v103
    v_mul_f32 v55, s40, v55
    v_exp_f32 v55, v55
    v_sub_f32 v103, v103, v33
    v_mul_f32 v103, s40, v103
    v_exp_f32 v103, v103
    v_sub_f32 v56, v38, v104
    v_mul_f32 v56, s40, v56
    v_exp_f32 v56, v56
    v_sub_f32 v104, v104, v34
    v_mul_f32 v104, s40, v104
    v_exp_f32 v104, v104
    v_sub_f32 v57, v38, v105
    v_mul_f32 v57, s40, v57
    v_exp_f32 v57, v57
    v_sub_f32 v105, v105, v34
    v_mul_f32 v105, s40, v105
    v_exp_f32 v105, v105
    v_sub_f32 v58, v38, v106
    v_mul_f32 v58, s40, v58
    v_exp_f32 v58, v58
    v_sub_f32 v106, v106, v34
    v_mul_f32 v106, s40, v106
    v_exp_f32 v106, v106
    v_sub_f32 v59, v38, v107
    v_mul_f32 v59, s40, v59
    v_exp_f32 v59, v59
    v_sub_f32 v107, v107, v34
    v_mul_f32 v107, s40, v107
    v_exp_f32 v107, v107
    v_sub_f32 v60, v39, v108
    v_mul_f32 v60, s40, v60
    v_exp_f32 v60, v60
    v_sub_f32 v108, v108, v35
    v_mul_f32 v108, s40, v108
    v_exp_f32 v108, v108
    v_sub_f32 v61, v39, v109
    v_mul_f32 v61, s40, v61
    v_exp_f32 v61, v61
    v_sub_f32 v109, v109, v35
    v_mul_f32 v109, s40, v109
    v_exp_f32 v109, v109
    v_sub_f32 v62, v39, v110
    v_mul_f32 v62, s40, v62
    v_exp_f32 v62, v62
    v_sub_f32 v110, v110, v35
    v_mul_f32 v110, s40, v110
    v_exp_f32 v110, v110
    v_sub_f32 v63, v39, v111
    v_mul_f32 v63, s40, v63
    v_exp_f32 v63, v63
    v_sub_f32 v111, v111, v35
    v_mul_f32 v111, s40, v111
    v_exp_f32 v111, v111
    s_nop 0
    v_add_f32 v32, v96, v97
    v_add_f32 v32, v32, v98
    v_add_f32 v32, v32, v99
    v_add_f32 v36, v48, v49
    v_add_f32 v36, v36, v50
    v_add_f32 v36, v36, v51
    v_add_f32 v33, v100, v101
    v_add_f32 v33, v33, v102
    v_add_f32 v33, v33, v103
    v_add_f32 v37, v52, v53
    v_add_f32 v37, v37, v54
    v_add_f32 v37, v37, v55
    v_add_f32 v34, v104, v105
    v_add_f32 v34, v34, v106
    v_add_f32 v34, v34, v107
    v_add_f32 v38, v56, v57
    v_add_f32 v38, v38, v58
    v_add_f32 v38, v38, v59
    v_add_f32 v35, v108, v109
    v_add_f32 v35, v35, v110
    v_add_f32 v35, v35, v111
    v_add_f32 v39, v60, v61
    v_add_f32 v39, v39, v62
    v_add_f32 v39, v39, v63
    ds_bpermute_b32 v40, v20, v32
    ds_bpermute_b32 v44, v20, v36
    ds_bpermute_b32 v41, v20, v33
    ds_bpermute_b32 v45, v20, v37
    ds_bpermute_b32 v42, v20, v34
    ds_bpermute_b32 v46, v20, v38
    ds_bpermute_b32 v43, v20, v35
    ds_bpermute_b32 v47, v20, v39
    s_waitcnt lgkmcnt(0)
    v_add_f32 v32, v32, v40
    v_add_f32 v36, v36, v44
    v_add_f32 v33, v33, v41
    v_add_f32 v37, v37, v45
    v_add_f32 v34, v34, v42
    v_add_f32 v38, v38, v46
    v_add_f32 v35, v35, v43
    v_add_f32 v39, v39, v47
    ds_bpermute_b32 v40, v21, v32
    ds_bpermute_b32 v44, v21, v36
    ds_bpermute_b32 v41, v21, v33
    ds_bpermute_b32 v45, v21, v37
    ds_bpermute_b32 v42, v21, v34
    ds_bpermute_b32 v46, v21, v38
    ds_bpermute_b32 v43, v21, v35
    ds_bpermute_b32 v47, v21, v39
    s_waitcnt lgkmcnt(0)
    v_add_f32 v32, v32, v40
    v_add_f32 v36, v36, v44
    v_add_f32 v33, v33, v41
    v_add_f32 v37, v37, v45
    v_add_f32 v34, v34, v42
    v_add_f32 v38, v38, v46
    v_add_f32 v35, v35, v43
    v_add_f32 v39, v39, v47
    v_rcp_f32 v32, v32
    v_rcp_f32 v36, v36
    v_rcp_f32 v33, v33
    v_rcp_f32 v37, v37
    v_rcp_f32 v34, v34
    v_rcp_f32 v38, v38
    v_rcp_f32 v35, v35
    v_rcp_f32 v39, v39
    s_nop 0
    v_mul_f32 v96, v96, v32
    v_mul_f32 v48, v48, v36
    v_mul_f32 v97, v97, v32
    v_mul_f32 v49, v49, v36
    v_mul_f32 v98, v98, v32
    v_mul_f32 v50, v50, v36
    v_mul_f32 v99, v99, v32
    v_mul_f32 v51, v51, v36
    v_cvt_pk_bf16_f32 v50, v50, v51
    v_cvt_pk_bf16_f32 v51, v48, v49
    v_cvt_pk_bf16_f32 v48, v96, v97
    v_cvt_pk_bf16_f32 v49, v98, v99
    v_mov_b32 v3, v50
    v_mov_b32 v50, v51
    v_mov_b32 v51, v3
    v_mul_f32 v100, v100, v33
    v_mul_f32 v52, v52, v37
    v_mul_f32 v101, v101, v33
    v_mul_f32 v53, v53, v37
    v_mul_f32 v102, v102, v33
    v_mul_f32 v54, v54, v37
    v_mul_f32 v103, v103, v33
    v_mul_f32 v55, v55, v37
    v_cvt_pk_bf16_f32 v54, v54, v55
    v_cvt_pk_bf16_f32 v55, v52, v53
    v_cvt_pk_bf16_f32 v52, v100, v101
    v_cvt_pk_bf16_f32 v53, v102, v103
    v_mov_b32 v3, v54
    v_mov_b32 v54, v55
    v_mov_b32 v55, v3
    v_mul_f32 v104, v104, v34
    v_mul_f32 v56, v56, v38
    v_mul_f32 v105, v105, v34
    v_mul_f32 v57, v57, v38
    v_mul_f32 v106, v106, v34
    v_mul_f32 v58, v58, v38
    v_mul_f32 v107, v107, v34
    v_mul_f32 v59, v59, v38
    v_cvt_pk_bf16_f32 v58, v58, v59
    v_cvt_pk_bf16_f32 v59, v56, v57
    v_cvt_pk_bf16_f32 v56, v104, v105
    v_cvt_pk_bf16_f32 v57, v106, v107
    v_mov_b32 v3, v58
    v_mov_b32 v58, v59
    v_mov_b32 v59, v3
    v_mul_f32 v108, v108, v35
    v_mul_f32 v60, v60, v39
    v_mul_f32 v109, v109, v35
    v_mul_f32 v61, v61, v39
    v_mul_f32 v110, v110, v35
    v_mul_f32 v62, v62, v39
    v_mul_f32 v111, v111, v35
    v_mul_f32 v63, v63, v39
    v_cvt_pk_bf16_f32 v62, v62, v63
    v_cvt_pk_bf16_f32 v63, v60, v61
    v_cvt_pk_bf16_f32 v60, v108, v109
    v_cvt_pk_bf16_f32 v61, v110, v111
    v_mov_b32 v3, v62
    v_mov_b32 v62, v63
    v_mov_b32 v63, v3
    ds_write_b128 v23, v[48:51] offset:0
    ds_write_b128 v23, v[52:55] offset:1024
    ds_write_b128 v23, v[56:59] offset:2048
    ds_write_b128 v23, v[60:63] offset:3072
    v_cvt_pk_bf16_f32 v128, v112, v113
    v_cvt_pk_bf16_f32 v129, v114, v115
    v_cvt_pk_bf16_f32 v130, v116, v117
    v_cvt_pk_bf16_f32 v131, v118, v119
    v_cvt_pk_bf16_f32 v132, v120, v121
    v_cvt_pk_bf16_f32 v133, v122, v123
    v_cvt_pk_bf16_f32 v134, v124, v125
    v_cvt_pk_bf16_f32 v135, v126, v127
    s_waitcnt lgkmcnt(0)
    ds_read_b64_tr_b16 v[136:137], v28 offset:0
    ds_read_b64_tr_b16 v[138:139], v28 offset:1024
    ds_read_b64_tr_b16 v[140:141], v28 offset:2048
    ds_read_b64_tr_b16 v[142:143], v28 offset:3072
    ds_read_b64_tr_b16 v[144:145], v28 offset:32
    ds_read_b64_tr_b16 v[146:147], v28 offset:1056
    ds_read_b64_tr_b16 v[148:149], v28 offset:2080
    ds_read_b64_tr_b16 v[150:151], v28 offset:3104
    s_waitcnt lgkmcnt(0)
    v_mfma_f32_16x16x32_bf16 v[152:155], v[136:139], v[128:131], 0
    v_mfma_f32_16x16x32_bf16 v[152:155], v[140:143], v[132:135], v[152:155]
    v_mfma_f32_16x16x32_bf16 v[156:159], v[144:147], v[128:131], 0
    v_mfma_f32_16x16x32_bf16 v[156:159], v[148:151], v[132:135], v[156:159]
    v_mov_b32 v168, v31
    v_mov_b32 v169, v31
    v_mov_b32 v170, v31
    v_mov_b32 v171, v31
    s_nop 1
    v_mfma_f32_16x16x32_bf16 v[160:163], v[136:139], v[168:171], 0
    v_mfma_f32_16x16x32_bf16 v[160:163], v[140:143], v[168:171], v[160:163]
    v_mfma_f32_16x16x32_bf16 v[164:167], v[144:147], v[168:171], 0
    v_mfma_f32_16x16x32_bf16 v[164:167], v[148:151], v[168:171], v[164:167]
    s_nop 7
    s_nop 7
    buffer_atomic_add_f32 v152, v29, s[16:19], s39 offen offset:0
    buffer_atomic_add_f32 v153, v29, s[16:19], s39 offen offset:4
    buffer_atomic_add_f32 v154, v29, s[16:19], s39 offen offset:8
    buffer_atomic_add_f32 v155, v29, s[16:19], s39 offen offset:12
    buffer_atomic_add_f32 v156, v29, s[16:19], s39 offen offset:64
    buffer_atomic_add_f32 v157, v29, s[16:19], s39 offen offset:68
    buffer_atomic_add_f32 v158, v29, s[16:19], s39 offen offset:72
    buffer_atomic_add_f32 v159, v29, s[16:19], s39 offen offset:76
    v_cmp_eq_u32 vcc, 0, v19
    s_and_saveexec_b64 s[42:43], vcc
    buffer_atomic_add_f32 v160, v30, s[16:19], s39 offen offset:2048
    buffer_atomic_add_f32 v161, v30, s[16:19], s39 offen offset:2052
    buffer_atomic_add_f32 v162, v30, s[16:19], s39 offen offset:2056
    buffer_atomic_add_f32 v163, v30, s[16:19], s39 offen offset:2060
    buffer_atomic_add_f32 v164, v30, s[16:19], s39 offen offset:2112
    buffer_atomic_add_f32 v165, v30, s[16:19], s39 offen offset:2116
    buffer_atomic_add_f32 v166, v30, s[16:19], s39 offen offset:2120
    buffer_atomic_add_f32 v167, v30, s[16:19], s39 offen offset:2124
    s_mov_b64 exec, s[42:43]
    s_waitcnt vmcnt(0)
K1_END:
    s_endpgm
.globl gemm2_kernel
.p2align 8
.type gemm2_kernel,@function
gemm2_kernel:
    s_cmp_ge_u32 s2, 256
    s_cbranch_scc1 K2_END
    s_load_dwordx2 s[4:5], s[0:1], 0
    s_load_dwordx2 s[6:7], s[0:1], 24
    s_load_dwordx4 s[8:11], s[0:1], 56
    s_load_dwordx2 s[12:13], s[0:1], 80
    s_and_b32 s36, s2, 31
    s_lshr_b32 s37, s2, 5
    v_and_b32 v1, 63, v0
    v_lshrrev_b32 v2, 6, v0
    s_waitcnt lgkmcnt(0)
    s_mov_b32 s16, s12
    s_mov_b32 s17, s13
    s_mov_b32 s18, 13701120
    s_mov_b32 s19, 0x00020000
    s_mov_b32 s20, s6
    s_mov_b32 s21, s7
    s_mov_b32 s22, 524288
    s_mov_b32 s23, 0x00020000
    s_mov_b32 s24, s8
    s_mov_b32 s25, s9
    s_mov_b32 s26, 1835008
    s_mov_b32 s27, 0x00020000
    s_mov_b32 s28, s4
    s_mov_b32 s29, s5
    s_mov_b32 s30, 2097152
    s_mov_b32 s31, 0x00020000
    s_mov_b32 s32, s10
    s_mov_b32 s33, s11
    s_mov_b32 s34, 2097152
    s_mov_b32 s35, 0x00020000
    v_and_b32 v3, 15, v1
    v_lshrrev_b32 v4, 4, v1
    v_lshrrev_b32 v5, 3, v0
    v_and_b32 v6, 7, v0
    v_lshlrev_b32 v7, 10, v5
    v_lshlrev_b32 v8, 4, v6
    s_lshl_b32 s38, s37, 7
    v_add3_u32 v145, v7, v8, s38
    s_lshl_b32 s38, s36, 6
    v_add_u32 v7, s38, v5
    s_mov_b32 s39, 3584
    v_mul_lo_u32 v7, v7, s39
    v_add_u32 v144, v7, v8
    v_and_b32 v7, 7, v5
    v_xor_b32 v7, v7, v6
    v_lshlrev_b32 v7, 4, v7
    v_lshl_add_u32 v146, v5, 7, v7
    v_add_u32 v146, 65536, v146
    v_lshrrev_b32 v7, 1, v5
    v_and_b32 v7, 1, v7
    v_lshrrev_b32 v8, 3, v5
    v_and_b32 v8, 1, v8
    v_lshl_or_b32 v7, v8, 1, v7
    v_lshrrev_b32 v8, 1, v6
    v_xor_b32 v7, v7, v8
    v_lshlrev_b32 v7, 5, v7
    v_and_b32 v8, 1, v6
    v_lshlrev_b32 v8, 4, v8
    v_lshlrev_b32 v9, 7, v5
    v_add3_u32 v147, v7, v8, v9
    v_add_u32 v147, 81920, v147
    v_lshrrev_b32 v5, 1, v2
    v_lshlrev_b32 v5, 5, v5
    v_add_u32 v5, v5, v3
    v_lshlrev_b32 v5, 7, v5
    v_and_b32 v6, 7, v1
    v_xor_b32 v7, v4, v6
    v_lshl_add_u32 v148, v7, 4, v5
    v_add_u32 v7, 4, v4
    v_xor_b32 v7, v7, v6
    v_lshl_add_u32 v149, v7, 4, v5
    v_add_u32 v156, 65536, v148
    v_add_u32 v157, 65536, v149
    v_lshrrev_b32 v5, 2, v3
    v_and_b32 v6, 3, v3
    v_lshlrev_b32 v7, 3, v4
    v_add_u32 v7, v7, v5
    v_lshlrev_b32 v7, 7, v7
    v_lshl_add_u32 v7, v6, 3, v7
    v_add_u32 v7, 81920, v7
    v_lshrrev_b32 v8, 1, v5
    v_and_b32 v9, 1, v4
    v_lshl_or_b32 v8, v9, 1, v8
    v_and_b32 v9, 1, v2
    v_lshlrev_b32 v9, 1, v9
    v_add_u32 v10, 0, v9
    v_xor_b32 v10, v10, v8
    v_lshlrev_b32 v10, 5, v10
    v_add_u32 v150, v7, v10
    v_add_u32 v10, 1, v9
    v_xor_b32 v10, v10, v8
    v_lshlrev_b32 v10, 5, v10
    v_add_u32 v151, v7, v10
    v_lshrrev_b32 v5, 1, v4
    v_add_u32 v5, 0, v5
    v_and_b32 v6, 7, v3
    v_xor_b32 v5, v5, v6
    v_lshlrev_b32 v5, 4, v5
    v_and_b32 v6, 1, v4
    v_lshlrev_b32 v6, 3, v6
    v_lshlrev_b32 v7, 7, v3
    v_add3_u32 v152, v5, v6, v7
    v_lshrrev_b32 v5, 1, v4
    v_add_u32 v5, 2, v5
    v_and_b32 v6, 7, v3
    v_xor_b32 v5, v5, v6
    v_lshlrev_b32 v5, 4, v5
    v_and_b32 v6, 1, v4
    v_lshlrev_b32 v6, 3, v6
    v_lshlrev_b32 v7, 7, v3
    v_add3_u32 v153, v5, v6, v7
    v_lshrrev_b32 v5, 1, v4
    v_add_u32 v5, 4, v5
    v_and_b32 v6, 7, v3
    v_xor_b32 v5, v5, v6
    v_lshlrev_b32 v5, 4, v5
    v_and_b32 v6, 1, v4
    v_lshlrev_b32 v6, 3, v6
    v_lshlrev_b32 v7, 7, v3
    v_add3_u32 v154, v5, v6, v7
    v_lshrrev_b32 v5, 1, v4
    v_add_u32 v5, 6, v5
    v_and_b32 v6, 7, v3
    v_xor_b32 v5, v5, v6
    v_lshlrev_b32 v5, 4, v5
    v_and_b32 v6, 1, v4
    v_lshlrev_b32 v6, 3, v6
    v_lshlrev_b32 v7, 7, v3
    v_add3_u32 v155, v5, v6, v7
    s_mov_b32 s40, 0
    buffer_load_dwordx4 v[136:139], v145, s[20:23], s40 offen
    s_mov_b32 s40, 32768
    buffer_load_dwordx4 v[140:143], v145, s[20:23], s40 offen
    s_mov_b32 s40, 65536
    buffer_load_dwordx4 v[168:171], v145, s[20:23], s40 offen
    s_mov_b32 s40, 98304
    buffer_load_dwordx4 v[172:175], v145, s[20:23], s40 offen
    s_mov_b32 s40, 131072
    buffer_load_dwordx4 v[184:187], v145, s[20:23], s40 offen
    s_mov_b32 s40, 163840
    buffer_load_dwordx4 v[188:191], v145, s[20:23], s40 offen
    s_lshl_b32 s38, s36, 6
    v_add_u32 v20, s38, v3
    v_lshlrev_b32 v20, 11, v20
    v_lshl_add_u32 v20, v4, 4, v20
    v_lshlrev_b32 v21, 7, v3
    v_lshl_add_u32 v21, v4, 5, v21
    v_lshlrev_b32 v22, 5, v4
    v_readfirstlane_b32 s41, v2
    s_lshl_b32 s41, s41, 3
    s_mov_b32 s45, 0x358637bd
    s_add_u32 s42, s41, 0
    s_mul_i32 s43, s42, 2176
    s_add_u32 s43, s43, 13631488
    s_lshl_b32 s44, s42, 6
    s_add_u32 s44, s44, 2097152
    buffer_load_dwordx4 v[24:27], v21, s[16:19], s43 offen
    buffer_load_dwordx4 v[28:31], v21, s[16:19], s43 offen offset:16
    buffer_load_dwordx4 v[32:35], v22, s[16:19], s43 offen offset:2048
    buffer_load_dwordx4 v[36:39], v22, s[16:19], s43 offen offset:2064
    s_mov_b32 s46, 0
    s_add_u32 s46, s46, s44
    buffer_load_dwordx4 v[40:43], v20, s[16:19], s46 offen
    s_mov_b32 s46, 32768
    s_add_u32 s46, s46, s44
    buffer_load_dwordx4 v[44:47], v20, s[16:19], s46 offen
    s_mov_b32 s46, 65536
    s_add_u32 s46, s46, s44
    buffer_load_dwordx4 v[48:51], v20, s[16:19], s46 offen
    s_mov_b32 s46, 98304
    s_add_u32 s46, s46, s44
    buffer_load_dwordx4 v[52:55], v20, s[16:19], s46 offen
    s_add_u32 s42, s41, 1
    s_mul_i32 s43, s42, 2176
    s_add_u32 s43, s43, 13631488
    s_lshl_b32 s44, s42, 6
    s_add_u32 s44, s44, 2097152
    buffer_load_dwordx4 v[192:195], v21, s[16:19], s43 offen
    buffer_load_dwordx4 v[196:199], v21, s[16:19], s43 offen offset:16
    buffer_load_dwordx4 v[200:203], v22, s[16:19], s43 offen offset:2048
    buffer_load_dwordx4 v[204:207], v22, s[16:19], s43 offen offset:2064
    s_mov_b32 s46, 0
    s_add_u32 s46, s46, s44
    buffer_load_dwordx4 v[208:211], v20, s[16:19], s46 offen
    s_mov_b32 s46, 32768
    s_add_u32 s46, s46, s44
    buffer_load_dwordx4 v[212:215], v20, s[16:19], s46 offen
    s_mov_b32 s46, 65536
    s_add_u32 s46, s46, s44
    buffer_load_dwordx4 v[216:219], v20, s[16:19], s46 offen
    s_mov_b32 s46, 98304
    s_add_u32 s46, s46, s44
    buffer_load_dwordx4 v[220:223], v20, s[16:19], s46 offen
    s_waitcnt vmcnt(8)
    v_cvt_pk_bf16_f32 v24, v24, v25
    v_cvt_pk_bf16_f32 v25, v26, v27
    v_cvt_pk_bf16_f32 v26, v28, v29
    v_cvt_pk_bf16_f32 v27, v30, v31
    v_cvt_pk_bf16_f32 v32, v32, v33
    v_cvt_pk_bf16_f32 v33, v34, v35
    v_cvt_pk_bf16_f32 v34, v36, v37
    v_cvt_pk_bf16_f32 v35, v38, v39
    s_nop 1
    v_mfma_f32_16x16x32_bf16 v[96:99], v[24:27], v[40:43], 0
    v_mfma_f32_16x16x32_bf16 v[112:115], v[32:35], v[40:43], 0
    v_mfma_f32_16x16x32_bf16 v[100:103], v[24:27], v[44:47], 0
    v_mfma_f32_16x16x32_bf16 v[116:119], v[32:35], v[44:47], 0
    v_mfma_f32_16x16x32_bf16 v[104:107], v[24:27], v[48:51], 0
    v_mfma_f32_16x16x32_bf16 v[120:123], v[32:35], v[48:51], 0
    v_mfma_f32_16x16x32_bf16 v[108:111], v[24:27], v[52:55], 0
    v_mfma_f32_16x16x32_bf16 v[124:127], v[32:35], v[52:55], 0
    s_nop 7
    s_nop 7
    v_cvt_pk_bf16_f32 v5, v112, v112
    v_and_b32 v5, 0xffff0000, v5
    v_add_f32 v5, s45, v5
    v_cvt_pk_bf16_f32 v5, v5, v5
    v_and_b32 v5, 0xffff0000, v5
    v_rcp_f32 v5, v5
    v_cvt_pk_bf16_f32 v6, v96, v97
    v_lshlrev_b32 v96, 16, v6
    v_and_b32 v97, 0xffff0000, v6
    v_cvt_pk_bf16_f32 v6, v98, v99
    v_lshlrev_b32 v98, 16, v6
    v_and_b32 v99, 0xffff0000, v6
    v_mul_f32 v96, v96, v5
    v_mul_f32 v97, v97, v5
    v_mul_f32 v98, v98, v5
    v_mul_f32 v99, v99, v5
    v_cvt_pk_bf16_f32 v6, v96, v97
    v_cvt_pk_bf16_f32 v7, v98, v99
    v_lshlrev_b32 v8, 14, v2
    v_add_u32 v8, v8, v152
    ds_write_b64 v8, v[6:7] offset:0
    v_cvt_pk_bf16_f32 v5, v116, v116
    v_and_b32 v5, 0xffff0000, v5
    v_add_f32 v5, s45, v5
    v_cvt_pk_bf16_f32 v5, v5, v5
    v_and_b32 v5, 0xffff0000, v5
    v_rcp_f32 v5, v5
    v_cvt_pk_bf16_f32 v6, v100, v101
    v_lshlrev_b32 v100, 16, v6
    v_and_b32 v101, 0xffff0000, v6
    v_cvt_pk_bf16_f32 v6, v102, v103
    v_lshlrev_b32 v102, 16, v6
    v_and_b32 v103, 0xffff0000, v6
    v_mul_f32 v100, v100, v5
    v_mul_f32 v101, v101, v5
    v_mul_f32 v102, v102, v5
    v_mul_f32 v103, v103, v5
    v_cvt_pk_bf16_f32 v6, v100, v101
    v_cvt_pk_bf16_f32 v7, v102, v103
    v_lshlrev_b32 v8, 14, v2
    v_add_u32 v8, v8, v152
    ds_write_b64 v8, v[6:7] offset:2048
    v_cvt_pk_bf16_f32 v5, v120, v120
    v_and_b32 v5, 0xffff0000, v5
    v_add_f32 v5, s45, v5
    v_cvt_pk_bf16_f32 v5, v5, v5
    v_and_b32 v5, 0xffff0000, v5
    v_rcp_f32 v5, v5
    v_cvt_pk_bf16_f32 v6, v104, v105
    v_lshlrev_b32 v104, 16, v6
    v_and_b32 v105, 0xffff0000, v6
    v_cvt_pk_bf16_f32 v6, v106, v107
    v_lshlrev_b32 v106, 16, v6
    v_and_b32 v107, 0xffff0000, v6
    v_mul_f32 v104, v104, v5
    v_mul_f32 v105, v105, v5
    v_mul_f32 v106, v106, v5
    v_mul_f32 v107, v107, v5
    v_cvt_pk_bf16_f32 v6, v104, v105
    v_cvt_pk_bf16_f32 v7, v106, v107
    v_lshlrev_b32 v8, 14, v2
    v_add_u32 v8, v8, v152
    ds_write_b64 v8, v[6:7] offset:4096
    v_cvt_pk_bf16_f32 v5, v124, v124
    v_and_b32 v5, 0xffff0000, v5
    v_add_f32 v5, s45, v5
    v_cvt_pk_bf16_f32 v5, v5, v5
    v_and_b32 v5, 0xffff0000, v5
    v_rcp_f32 v5, v5
    v_cvt_pk_bf16_f32 v6, v108, v109
    v_lshlrev_b32 v108, 16, v6
    v_and_b32 v109, 0xffff0000, v6
    v_cvt_pk_bf16_f32 v6, v110, v111
    v_lshlrev_b32 v110, 16, v6
    v_and_b32 v111, 0xffff0000, v6
    v_mul_f32 v108, v108, v5
    v_mul_f32 v109, v109, v5
    v_mul_f32 v110, v110, v5
    v_mul_f32 v111, v111, v5
    v_cvt_pk_bf16_f32 v6, v108, v109
    v_cvt_pk_bf16_f32 v7, v110, v111
    v_lshlrev_b32 v8, 14, v2
    v_add_u32 v8, v8, v152
    ds_write_b64 v8, v[6:7] offset:6144
    s_add_u32 s42, s41, 2
    s_mul_i32 s43, s42, 2176
    s_add_u32 s43, s43, 13631488
    s_lshl_b32 s44, s42, 6
    s_add_u32 s44, s44, 2097152
    buffer_load_dwordx4 v[24:27], v21, s[16:19], s43 offen
    buffer_load_dwordx4 v[28:31], v21, s[16:19], s43 offen offset:16
    buffer_load_dwordx4 v[32:35], v22, s[16:19], s43 offen offset:2048
    buffer_load_dwordx4 v[36:39], v22, s[16:19], s43 offen offset:2064
    s_mov_b32 s46, 0
    s_add_u32 s46, s46, s44
    buffer_load_dwordx4 v[40:43], v20, s[16:19], s46 offen
    s_mov_b32 s46, 32768
    s_add_u32 s46, s46, s44
    buffer_load_dwordx4 v[44:47], v20, s[16:19], s46 offen
    s_mov_b32 s46, 65536
    s_add_u32 s46, s46, s44
    buffer_load_dwordx4 v[48:51], v20, s[16:19], s46 offen
    s_mov_b32 s46, 98304
    s_add_u32 s46, s46, s44
    buffer_load_dwordx4 v[52:55], v20, s[16:19], s46 offen
    s_waitcnt vmcnt(8)
    v_cvt_pk_bf16_f32 v192, v192, v193
    v_cvt_pk_bf16_f32 v193, v194, v195
    v_cvt_pk_bf16_f32 v194, v196, v197
    v_cvt_pk_bf16_f32 v195, v198, v199
    v_cvt_pk_bf16_f32 v200, v200, v201
    v_cvt_pk_bf16_f32 v201, v202, v203
    v_cvt_pk_bf16_f32 v202, v204, v205
    v_cvt_pk_bf16_f32 v203, v206, v207
    s_nop 1
    v_mfma_f32_16x16x32_bf16 v[96:99], v[192:195], v[208:211], 0
    v_mfma_f32_16x16x32_bf16 v[112:115], v[200:203], v[208:211], 0
    v_mfma_f32_16x16x32_bf16 v[100:103], v[192:195], v[212:215], 0
    v_mfma_f32_16x16x32_bf16 v[116:119], v[200:203], v[212:215], 0
    v_mfma_f32_16x16x32_bf16 v[104:107], v[192:195], v[216:219], 0
    v_mfma_f32_16x16x32_bf16 v[120:123], v[200:203], v[216:219], 0
    v_mfma_f32_16x16x32_bf16 v[108:111], v[192:195], v[220:223], 0
    v_mfma_f32_16x16x32_bf16 v[124:127], v[200:203], v[220:223], 0
    s_nop 7
    s_nop 7
    v_cvt_pk_bf16_f32 v5, v112, v112
    v_and_b32 v5, 0xffff0000, v5
    v_add_f32 v5, s45, v5
    v_cvt_pk_bf16_f32 v5, v5, v5
    v_and_b32 v5, 0xffff0000, v5
    v_rcp_f32 v5, v5
    v_cvt_pk_bf16_f32 v6, v96, v97
    v_lshlrev_b32 v96, 16, v6
    v_and_b32 v97, 0xffff0000, v6
    v_cvt_pk_bf16_f32 v6, v98, v99
    v_lshlrev_b32 v98, 16, v6
    v_and_b32 v99, 0xffff0000, v6
    v_mul_f32 v96, v96, v5
    v_mul_f32 v97, v97, v5
    v_mul_f32 v98, v98, v5
    v_mul_f32 v99, v99, v5
    v_cvt_pk_bf16_f32 v6, v96, v97
    v_cvt_pk_bf16_f32 v7, v98, v99
    v_lshlrev_b32 v8, 14, v2
    v_add_u32 v8, v8, v153
    ds_write_b64 v8, v[6:7] offset:0
    v_cvt_pk_bf16_f32 v5, v116, v116
    v_and_b32 v5, 0xffff0000, v5
    v_add_f32 v5, s45, v5
    v_cvt_pk_bf16_f32 v5, v5, v5
    v_and_b32 v5, 0xffff0000, v5
    v_rcp_f32 v5, v5
    v_cvt_pk_bf16_f32 v6, v100, v101
    v_lshlrev_b32 v100, 16, v6
    v_and_b32 v101, 0xffff0000, v6
    v_cvt_pk_bf16_f32 v6, v102, v103
    v_lshlrev_b32 v102, 16, v6
    v_and_b32 v103, 0xffff0000, v6
    v_mul_f32 v100, v100, v5
    v_mul_f32 v101, v101, v5
    v_mul_f32 v102, v102, v5
    v_mul_f32 v103, v103, v5
    v_cvt_pk_bf16_f32 v6, v100, v101
    v_cvt_pk_bf16_f32 v7, v102, v103
    v_lshlrev_b32 v8, 14, v2
    v_add_u32 v8, v8, v153
    ds_write_b64 v8, v[6:7] offset:2048
    v_cvt_pk_bf16_f32 v5, v120, v120
    v_and_b32 v5, 0xffff0000, v5
    v_add_f32 v5, s45, v5
    v_cvt_pk_bf16_f32 v5, v5, v5
    v_and_b32 v5, 0xffff0000, v5
    v_rcp_f32 v5, v5
    v_cvt_pk_bf16_f32 v6, v104, v105
    v_lshlrev_b32 v104, 16, v6
    v_and_b32 v105, 0xffff0000, v6
    v_cvt_pk_bf16_f32 v6, v106, v107
    v_lshlrev_b32 v106, 16, v6
    v_and_b32 v107, 0xffff0000, v6
    v_mul_f32 v104, v104, v5
    v_mul_f32 v105, v105, v5
    v_mul_f32 v106, v106, v5
    v_mul_f32 v107, v107, v5
    v_cvt_pk_bf16_f32 v6, v104, v105
    v_cvt_pk_bf16_f32 v7, v106, v107
    v_lshlrev_b32 v8, 14, v2
    v_add_u32 v8, v8, v153
    ds_write_b64 v8, v[6:7] offset:4096
    v_cvt_pk_bf16_f32 v5, v124, v124
    v_and_b32 v5, 0xffff0000, v5
    v_add_f32 v5, s45, v5
    v_cvt_pk_bf16_f32 v5, v5, v5
    v_and_b32 v5, 0xffff0000, v5
    v_rcp_f32 v5, v5
    v_cvt_pk_bf16_f32 v6, v108, v109
    v_lshlrev_b32 v108, 16, v6
    v_and_b32 v109, 0xffff0000, v6
    v_cvt_pk_bf16_f32 v6, v110, v111
    v_lshlrev_b32 v110, 16, v6
    v_and_b32 v111, 0xffff0000, v6
    v_mul_f32 v108, v108, v5
    v_mul_f32 v109, v109, v5
    v_mul_f32 v110, v110, v5
    v_mul_f32 v111, v111, v5
    v_cvt_pk_bf16_f32 v6, v108, v109
    v_cvt_pk_bf16_f32 v7, v110, v111
    v_lshlrev_b32 v8, 14, v2
    v_add_u32 v8, v8, v153
    ds_write_b64 v8, v[6:7] offset:6144
    s_add_u32 s42, s41, 3
    s_mul_i32 s43, s42, 2176
    s_add_u32 s43, s43, 13631488
    s_lshl_b32 s44, s42, 6
    s_add_u32 s44, s44, 2097152
    buffer_load_dwordx4 v[192:195], v21, s[16:19], s43 offen
    buffer_load_dwordx4 v[196:199], v21, s[16:19], s43 offen offset:16
    buffer_load_dwordx4 v[200:203], v22, s[16:19], s43 offen offset:2048
    buffer_load_dwordx4 v[204:207], v22, s[16:19], s43 offen offset:2064
    s_mov_b32 s46, 0
    s_add_u32 s46, s46, s44
    buffer_load_dwordx4 v[208:211], v20, s[16:19], s46 offen
    s_mov_b32 s46, 32768
    s_add_u32 s46, s46, s44
    buffer_load_dwordx4 v[212:215], v20, s[16:19], s46 offen
    s_mov_b32 s46, 65536
    s_add_u32 s46, s46, s44
    buffer_load_dwordx4 v[216:219], v20, s[16:19], s46 offen
    s_mov_b32 s46, 98304
    s_add_u32 s46, s46, s44
    buffer_load_dwordx4 v[220:223], v20, s[16:19], s46 offen
    s_waitcnt vmcnt(8)
    v_cvt_pk_bf16_f32 v24, v24, v25
    v_cvt_pk_bf16_f32 v25, v26, v27
    v_cvt_pk_bf16_f32 v26, v28, v29
    v_cvt_pk_bf16_f32 v27, v30, v31
    v_cvt_pk_bf16_f32 v32, v32, v33
    v_cvt_pk_bf16_f32 v33, v34, v35
    v_cvt_pk_bf16_f32 v34, v36, v37
    v_cvt_pk_bf16_f32 v35, v38, v39
    s_nop 1
    v_mfma_f32_16x16x32_bf16 v[96:99], v[24:27], v[40:43], 0
    v_mfma_f32_16x16x32_bf16 v[112:115], v[32:35], v[40:43], 0
    v_mfma_f32_16x16x32_bf16 v[100:103], v[24:27], v[44:47], 0
    v_mfma_f32_16x16x32_bf16 v[116:119], v[32:35], v[44:47], 0
    v_mfma_f32_16x16x32_bf16 v[104:107], v[24:27], v[48:51], 0
    v_mfma_f32_16x16x32_bf16 v[120:123], v[32:35], v[48:51], 0
    v_mfma_f32_16x16x32_bf16 v[108:111], v[24:27], v[52:55], 0
    v_mfma_f32_16x16x32_bf16 v[124:127], v[32:35], v[52:55], 0
    s_nop 7
    s_nop 7
    v_cvt_pk_bf16_f32 v5, v112, v112
    v_and_b32 v5, 0xffff0000, v5
    v_add_f32 v5, s45, v5
    v_cvt_pk_bf16_f32 v5, v5, v5
    v_and_b32 v5, 0xffff0000, v5
    v_rcp_f32 v5, v5
    v_cvt_pk_bf16_f32 v6, v96, v97
    v_lshlrev_b32 v96, 16, v6
    v_and_b32 v97, 0xffff0000, v6
    v_cvt_pk_bf16_f32 v6, v98, v99
    v_lshlrev_b32 v98, 16, v6
    v_and_b32 v99, 0xffff0000, v6
    v_mul_f32 v96, v96, v5
    v_mul_f32 v97, v97, v5
    v_mul_f32 v98, v98, v5
    v_mul_f32 v99, v99, v5
    v_cvt_pk_bf16_f32 v6, v96, v97
    v_cvt_pk_bf16_f32 v7, v98, v99
    v_lshlrev_b32 v8, 14, v2
    v_add_u32 v8, v8, v154
    ds_write_b64 v8, v[6:7] offset:0
    v_cvt_pk_bf16_f32 v5, v116, v116
    v_and_b32 v5, 0xffff0000, v5
    v_add_f32 v5, s45, v5
    v_cvt_pk_bf16_f32 v5, v5, v5
    v_and_b32 v5, 0xffff0000, v5
    v_rcp_f32 v5, v5
    v_cvt_pk_bf16_f32 v6, v100, v101
    v_lshlrev_b32 v100, 16, v6
    v_and_b32 v101, 0xffff0000, v6
    v_cvt_pk_bf16_f32 v6, v102, v103
    v_lshlrev_b32 v102, 16, v6
    v_and_b32 v103, 0xffff0000, v6
    v_mul_f32 v100, v100, v5
    v_mul_f32 v101, v101, v5
    v_mul_f32 v102, v102, v5
    v_mul_f32 v103, v103, v5
    v_cvt_pk_bf16_f32 v6, v100, v101
    v_cvt_pk_bf16_f32 v7, v102, v103
    v_lshlrev_b32 v8, 14, v2
    v_add_u32 v8, v8, v154
    ds_write_b64 v8, v[6:7] offset:2048
    v_cvt_pk_bf16_f32 v5, v120, v120
    v_and_b32 v5, 0xffff0000, v5
    v_add_f32 v5, s45, v5
    v_cvt_pk_bf16_f32 v5, v5, v5
    v_and_b32 v5, 0xffff0000, v5
    v_rcp_f32 v5, v5
    v_cvt_pk_bf16_f32 v6, v104, v105
    v_lshlrev_b32 v104, 16, v6
    v_and_b32 v105, 0xffff0000, v6
    v_cvt_pk_bf16_f32 v6, v106, v107
    v_lshlrev_b32 v106, 16, v6
    v_and_b32 v107, 0xffff0000, v6
    v_mul_f32 v104, v104, v5
    v_mul_f32 v105, v105, v5
    v_mul_f32 v106, v106, v5
    v_mul_f32 v107, v107, v5
    v_cvt_pk_bf16_f32 v6, v104, v105
    v_cvt_pk_bf16_f32 v7, v106, v107
    v_lshlrev_b32 v8, 14, v2
    v_add_u32 v8, v8, v154
    ds_write_b64 v8, v[6:7] offset:4096
    v_cvt_pk_bf16_f32 v5, v124, v124
    v_and_b32 v5, 0xffff0000, v5
    v_add_f32 v5, s45, v5
    v_cvt_pk_bf16_f32 v5, v5, v5
    v_and_b32 v5, 0xffff0000, v5
    v_rcp_f32 v5, v5
    v_cvt_pk_bf16_f32 v6, v108, v109
    v_lshlrev_b32 v108, 16, v6
    v_and_b32 v109, 0xffff0000, v6
    v_cvt_pk_bf16_f32 v6, v110, v111
    v_lshlrev_b32 v110, 16, v6
    v_and_b32 v111, 0xffff0000, v6
    v_mul_f32 v108, v108, v5
    v_mul_f32 v109, v109, v5
    v_mul_f32 v110, v110, v5
    v_mul_f32 v111, v111, v5
    v_cvt_pk_bf16_f32 v6, v108, v109
    v_cvt_pk_bf16_f32 v7, v110, v111
    v_lshlrev_b32 v8, 14, v2
    v_add_u32 v8, v8, v154
    ds_write_b64 v8, v[6:7] offset:6144
    s_add_u32 s42, s41, 4
    s_mul_i32 s43, s42, 2176
    s_add_u32 s43, s43, 13631488
    s_lshl_b32 s44, s42, 6
    s_add_u32 s44, s44, 2097152
    buffer_load_dwordx4 v[24:27], v21, s[16:19], s43 offen
    buffer_load_dwordx4 v[28:31], v21, s[16:19], s43 offen offset:16
    buffer_load_dwordx4 v[32:35], v22, s[16:19], s43 offen offset:2048
    buffer_load_dwordx4 v[36:39], v22, s[16:19], s43 offen offset:2064
    s_mov_b32 s46, 0
    s_add_u32 s46, s46, s44
    buffer_load_dwordx4 v[40:43], v20, s[16:19], s46 offen
    s_mov_b32 s46, 32768
    s_add_u32 s46, s46, s44
    buffer_load_dwordx4 v[44:47], v20, s[16:19], s46 offen
    s_mov_b32 s46, 65536
    s_add_u32 s46, s46, s44
    buffer_load_dwordx4 v[48:51], v20, s[16:19], s46 offen
    s_mov_b32 s46, 98304
    s_add_u32 s46, s46, s44
    buffer_load_dwordx4 v[52:55], v20, s[16:19], s46 offen
    s_waitcnt vmcnt(8)
    v_cvt_pk_bf16_f32 v192, v192, v193
    v_cvt_pk_bf16_f32 v193, v194, v195
    v_cvt_pk_bf16_f32 v194, v196, v197
    v_cvt_pk_bf16_f32 v195, v198, v199
    v_cvt_pk_bf16_f32 v200, v200, v201
    v_cvt_pk_bf16_f32 v201, v202, v203
    v_cvt_pk_bf16_f32 v202, v204, v205
    v_cvt_pk_bf16_f32 v203, v206, v207
    s_nop 1
    v_mfma_f32_16x16x32_bf16 v[96:99], v[192:195], v[208:211], 0
    v_mfma_f32_16x16x32_bf16 v[112:115], v[200:203], v[208:211], 0
    v_mfma_f32_16x16x32_bf16 v[100:103], v[192:195], v[212:215], 0
    v_mfma_f32_16x16x32_bf16 v[116:119], v[200:203], v[212:215], 0
    v_mfma_f32_16x16x32_bf16 v[104:107], v[192:195], v[216:219], 0
    v_mfma_f32_16x16x32_bf16 v[120:123], v[200:203], v[216:219], 0
    v_mfma_f32_16x16x32_bf16 v[108:111], v[192:195], v[220:223], 0
    v_mfma_f32_16x16x32_bf16 v[124:127], v[200:203], v[220:223], 0
    s_nop 7
    s_nop 7
    v_cvt_pk_bf16_f32 v5, v112, v112
    v_and_b32 v5, 0xffff0000, v5
    v_add_f32 v5, s45, v5
    v_cvt_pk_bf16_f32 v5, v5, v5
    v_and_b32 v5, 0xffff0000, v5
    v_rcp_f32 v5, v5
    v_cvt_pk_bf16_f32 v6, v96, v97
    v_lshlrev_b32 v96, 16, v6
    v_and_b32 v97, 0xffff0000, v6
    v_cvt_pk_bf16_f32 v6, v98, v99
    v_lshlrev_b32 v98, 16, v6
    v_and_b32 v99, 0xffff0000, v6
    v_mul_f32 v96, v96, v5
    v_mul_f32 v97, v97, v5
    v_mul_f32 v98, v98, v5
    v_mul_f32 v99, v99, v5
    v_cvt_pk_bf16_f32 v6, v96, v97
    v_cvt_pk_bf16_f32 v7, v98, v99
    v_lshlrev_b32 v8, 14, v2
    v_add_u32 v8, v8, v155
    ds_write_b64 v8, v[6:7] offset:0
    v_cvt_pk_bf16_f32 v5, v116, v116
    v_and_b32 v5, 0xffff0000, v5
    v_add_f32 v5, s45, v5
    v_cvt_pk_bf16_f32 v5, v5, v5
    v_and_b32 v5, 0xffff0000, v5
    v_rcp_f32 v5, v5
    v_cvt_pk_bf16_f32 v6, v100, v101
    v_lshlrev_b32 v100, 16, v6
    v_and_b32 v101, 0xffff0000, v6
    v_cvt_pk_bf16_f32 v6, v102, v103
    v_lshlrev_b32 v102, 16, v6
    v_and_b32 v103, 0xffff0000, v6
    v_mul_f32 v100, v100, v5
    v_mul_f32 v101, v101, v5
    v_mul_f32 v102, v102, v5
    v_mul_f32 v103, v103, v5
    v_cvt_pk_bf16_f32 v6, v100, v101
    v_cvt_pk_bf16_f32 v7, v102, v103
    v_lshlrev_b32 v8, 14, v2
    v_add_u32 v8, v8, v155
    ds_write_b64 v8, v[6:7] offset:2048
    v_cvt_pk_bf16_f32 v5, v120, v120
    v_and_b32 v5, 0xffff0000, v5
    v_add_f32 v5, s45, v5
    v_cvt_pk_bf16_f32 v5, v5, v5
    v_and_b32 v5, 0xffff0000, v5
    v_rcp_f32 v5, v5
    v_cvt_pk_bf16_f32 v6, v104, v105
    v_lshlrev_b32 v104, 16, v6
    v_and_b32 v105, 0xffff0000, v6
    v_cvt_pk_bf16_f32 v6, v106, v107
    v_lshlrev_b32 v106, 16, v6
    v_and_b32 v107, 0xffff0000, v6
    v_mul_f32 v104, v104, v5
    v_mul_f32 v105, v105, v5
    v_mul_f32 v106, v106, v5
    v_mul_f32 v107, v107, v5
    v_cvt_pk_bf16_f32 v6, v104, v105
    v_cvt_pk_bf16_f32 v7, v106, v107
    v_lshlrev_b32 v8, 14, v2
    v_add_u32 v8, v8, v155
    ds_write_b64 v8, v[6:7] offset:4096
    v_cvt_pk_bf16_f32 v5, v124, v124
    v_and_b32 v5, 0xffff0000, v5
    v_add_f32 v5, s45, v5
    v_cvt_pk_bf16_f32 v5, v5, v5
    v_and_b32 v5, 0xffff0000, v5
    v_rcp_f32 v5, v5
    v_cvt_pk_bf16_f32 v6, v108, v109
    v_lshlrev_b32 v108, 16, v6
    v_and_b32 v109, 0xffff0000, v6
    v_cvt_pk_bf16_f32 v6, v110, v111
    v_lshlrev_b32 v110, 16, v6
    v_and_b32 v111, 0xffff0000, v6
    v_mul_f32 v108, v108, v5
    v_mul_f32 v109, v109, v5
    v_mul_f32 v110, v110, v5
    v_mul_f32 v111, v111, v5
    v_cvt_pk_bf16_f32 v6, v108, v109
    v_cvt_pk_bf16_f32 v7, v110, v111
    v_lshlrev_b32 v8, 14, v2
    v_add_u32 v8, v8, v155
    ds_write_b64 v8, v[6:7] offset:6144
    s_add_u32 s42, s41, 5
    s_mul_i32 s43, s42, 2176
    s_add_u32 s43, s43, 13631488
    s_lshl_b32 s44, s42, 6
    s_add_u32 s44, s44, 2097152
    buffer_load_dwordx4 v[192:195], v21, s[16:19], s43 offen
    buffer_load_dwordx4 v[196:199], v21, s[16:19], s43 offen offset:16
    buffer_load_dwordx4 v[200:203], v22, s[16:19], s43 offen offset:2048
    buffer_load_dwordx4 v[204:207], v22, s[16:19], s43 offen offset:2064
    s_mov_b32 s46, 0
    s_add_u32 s46, s46, s44
    buffer_load_dwordx4 v[208:211], v20, s[16:19], s46 offen
    s_mov_b32 s46, 32768
    s_add_u32 s46, s46, s44
    buffer_load_dwordx4 v[212:215], v20, s[16:19], s46 offen
    s_mov_b32 s46, 65536
    s_add_u32 s46, s46, s44
    buffer_load_dwordx4 v[216:219], v20, s[16:19], s46 offen
    s_mov_b32 s46, 98304
    s_add_u32 s46, s46, s44
    buffer_load_dwordx4 v[220:223], v20, s[16:19], s46 offen
    s_waitcnt vmcnt(8)
    v_cvt_pk_bf16_f32 v24, v24, v25
    v_cvt_pk_bf16_f32 v25, v26, v27
    v_cvt_pk_bf16_f32 v26, v28, v29
    v_cvt_pk_bf16_f32 v27, v30, v31
    v_cvt_pk_bf16_f32 v32, v32, v33
    v_cvt_pk_bf16_f32 v33, v34, v35
    v_cvt_pk_bf16_f32 v34, v36, v37
    v_cvt_pk_bf16_f32 v35, v38, v39
    s_nop 1
    v_mfma_f32_16x16x32_bf16 v[96:99], v[24:27], v[40:43], 0
    v_mfma_f32_16x16x32_bf16 v[112:115], v[32:35], v[40:43], 0
    v_mfma_f32_16x16x32_bf16 v[100:103], v[24:27], v[44:47], 0
    v_mfma_f32_16x16x32_bf16 v[116:119], v[32:35], v[44:47], 0
    v_mfma_f32_16x16x32_bf16 v[104:107], v[24:27], v[48:51], 0
    v_mfma_f32_16x16x32_bf16 v[120:123], v[32:35], v[48:51], 0
    v_mfma_f32_16x16x32_bf16 v[108:111], v[24:27], v[52:55], 0
    v_mfma_f32_16x16x32_bf16 v[124:127], v[32:35], v[52:55], 0
    s_nop 7
    s_nop 7
    v_cvt_pk_bf16_f32 v5, v112, v112
    v_and_b32 v5, 0xffff0000, v5
    v_add_f32 v5, s45, v5
    v_cvt_pk_bf16_f32 v5, v5, v5
    v_and_b32 v5, 0xffff0000, v5
    v_rcp_f32 v5, v5
    v_cvt_pk_bf16_f32 v6, v96, v97
    v_lshlrev_b32 v96, 16, v6
    v_and_b32 v97, 0xffff0000, v6
    v_cvt_pk_bf16_f32 v6, v98, v99
    v_lshlrev_b32 v98, 16, v6
    v_and_b32 v99, 0xffff0000, v6
    v_mul_f32 v96, v96, v5
    v_mul_f32 v97, v97, v5
    v_mul_f32 v98, v98, v5
    v_mul_f32 v99, v99, v5
    v_cvt_pk_bf16_f32 v6, v96, v97
    v_cvt_pk_bf16_f32 v7, v98, v99
    v_lshlrev_b32 v8, 14, v2
    v_add_u32 v8, v8, v152
    ds_write_b64 v8, v[6:7] offset:8192
    v_cvt_pk_bf16_f32 v5, v116, v116
    v_and_b32 v5, 0xffff0000, v5
    v_add_f32 v5, s45, v5
    v_cvt_pk_bf16_f32 v5, v5, v5
    v_and_b32 v5, 0xffff0000, v5
    v_rcp_f32 v5, v5
    v_cvt_pk_bf16_f32 v6, v100, v101
    v_lshlrev_b32 v100, 16, v6
    v_and_b32 v101, 0xffff0000, v6
    v_cvt_pk_bf16_f32 v6, v102, v103
    v_lshlrev_b32 v102, 16, v6
    v_and_b32 v103, 0xffff0000, v6
    v_mul_f32 v100, v100, v5
    v_mul_f32 v101, v101, v5
    v_mul_f32 v102, v102, v5
    v_mul_f32 v103, v103, v5
    v_cvt_pk_bf16_f32 v6, v100, v101
    v_cvt_pk_bf16_f32 v7, v102, v103
    v_lshlrev_b32 v8, 14, v2
    v_add_u32 v8, v8, v152
    ds_write_b64 v8, v[6:7] offset:10240
    v_cvt_pk_bf16_f32 v5, v120, v120
    v_and_b32 v5, 0xffff0000, v5
    v_add_f32 v5, s45, v5
    v_cvt_pk_bf16_f32 v5, v5, v5
    v_and_b32 v5, 0xffff0000, v5
    v_rcp_f32 v5, v5
    v_cvt_pk_bf16_f32 v6, v104, v105
    v_lshlrev_b32 v104, 16, v6
    v_and_b32 v105, 0xffff0000, v6
    v_cvt_pk_bf16_f32 v6, v106, v107
    v_lshlrev_b32 v106, 16, v6
    v_and_b32 v107, 0xffff0000, v6
    v_mul_f32 v104, v104, v5
    v_mul_f32 v105, v105, v5
    v_mul_f32 v106, v106, v5
    v_mul_f32 v107, v107, v5
    v_cvt_pk_bf16_f32 v6, v104, v105
    v_cvt_pk_bf16_f32 v7, v106, v107
    v_lshlrev_b32 v8, 14, v2
    v_add_u32 v8, v8, v152
    ds_write_b64 v8, v[6:7] offset:12288
    v_cvt_pk_bf16_f32 v5, v124, v124
    v_and_b32 v5, 0xffff0000, v5
    v_add_f32 v5, s45, v5
    v_cvt_pk_bf16_f32 v5, v5, v5
    v_and_b32 v5, 0xffff0000, v5
    v_rcp_f32 v5, v5
    v_cvt_pk_bf16_f32 v6, v108, v109
    v_lshlrev_b32 v108, 16, v6
    v_and_b32 v109, 0xffff0000, v6
    v_cvt_pk_bf16_f32 v6, v110, v111
    v_lshlrev_b32 v110, 16, v6
    v_and_b32 v111, 0xffff0000, v6
    v_mul_f32 v108, v108, v5
    v_mul_f32 v109, v109, v5
    v_mul_f32 v110, v110, v5
    v_mul_f32 v111, v111, v5
    v_cvt_pk_bf16_f32 v6, v108, v109
    v_cvt_pk_bf16_f32 v7, v110, v111
    v_lshlrev_b32 v8, 14, v2
    v_add_u32 v8, v8, v152
    ds_write_b64 v8, v[6:7] offset:14336
    s_add_u32 s42, s41, 6
    s_mul_i32 s43, s42, 2176
    s_add_u32 s43, s43, 13631488
    s_lshl_b32 s44, s42, 6
    s_add_u32 s44, s44, 2097152
    buffer_load_dwordx4 v[24:27], v21, s[16:19], s43 offen
    buffer_load_dwordx4 v[28:31], v21, s[16:19], s43 offen offset:16
    buffer_load_dwordx4 v[32:35], v22, s[16:19], s43 offen offset:2048
    buffer_load_dwordx4 v[36:39], v22, s[16:19], s43 offen offset:2064
    s_mov_b32 s46, 0
    s_add_u32 s46, s46, s44
    buffer_load_dwordx4 v[40:43], v20, s[16:19], s46 offen
    s_mov_b32 s46, 32768
    s_add_u32 s46, s46, s44
    buffer_load_dwordx4 v[44:47], v20, s[16:19], s46 offen
    s_mov_b32 s46, 65536
    s_add_u32 s46, s46, s44
    buffer_load_dwordx4 v[48:51], v20, s[16:19], s46 offen
    s_mov_b32 s46, 98304
    s_add_u32 s46, s46, s44
    buffer_load_dwordx4 v[52:55], v20, s[16:19], s46 offen
    s_waitcnt vmcnt(8)
    v_cvt_pk_bf16_f32 v192, v192, v193
    v_cvt_pk_bf16_f32 v193, v194, v195
    v_cvt_pk_bf16_f32 v194, v196, v197
    v_cvt_pk_bf16_f32 v195, v198, v199
    v_cvt_pk_bf16_f32 v200, v200, v201
    v_cvt_pk_bf16_f32 v201, v202, v203
    v_cvt_pk_bf16_f32 v202, v204, v205
    v_cvt_pk_bf16_f32 v203, v206, v207
    s_nop 1
    v_mfma_f32_16x16x32_bf16 v[96:99], v[192:195], v[208:211], 0
    v_mfma_f32_16x16x32_bf16 v[112:115], v[200:203], v[208:211], 0
    v_mfma_f32_16x16x32_bf16 v[100:103], v[192:195], v[212:215], 0
    v_mfma_f32_16x16x32_bf16 v[116:119], v[200:203], v[212:215], 0
    v_mfma_f32_16x16x32_bf16 v[104:107], v[192:195], v[216:219], 0
    v_mfma_f32_16x16x32_bf16 v[120:123], v[200:203], v[216:219], 0
    v_mfma_f32_16x16x32_bf16 v[108:111], v[192:195], v[220:223], 0
    v_mfma_f32_16x16x32_bf16 v[124:127], v[200:203], v[220:223], 0
    s_nop 7
    s_nop 7
    v_cvt_pk_bf16_f32 v5, v112, v112
    v_and_b32 v5, 0xffff0000, v5
    v_add_f32 v5, s45, v5
    v_cvt_pk_bf16_f32 v5, v5, v5
    v_and_b32 v5, 0xffff0000, v5
    v_rcp_f32 v5, v5
    v_cvt_pk_bf16_f32 v6, v96, v97
    v_lshlrev_b32 v96, 16, v6
    v_and_b32 v97, 0xffff0000, v6
    v_cvt_pk_bf16_f32 v6, v98, v99
    v_lshlrev_b32 v98, 16, v6
    v_and_b32 v99, 0xffff0000, v6
    v_mul_f32 v96, v96, v5
    v_mul_f32 v97, v97, v5
    v_mul_f32 v98, v98, v5
    v_mul_f32 v99, v99, v5
    v_cvt_pk_bf16_f32 v6, v96, v97
    v_cvt_pk_bf16_f32 v7, v98, v99
    v_lshlrev_b32 v8, 14, v2
    v_add_u32 v8, v8, v153
    ds_write_b64 v8, v[6:7] offset:8192
    v_cvt_pk_bf16_f32 v5, v116, v116
    v_and_b32 v5, 0xffff0000, v5
    v_add_f32 v5, s45, v5
    v_cvt_pk_bf16_f32 v5, v5, v5
    v_and_b32 v5, 0xffff0000, v5
    v_rcp_f32 v5, v5
    v_cvt_pk_bf16_f32 v6, v100, v101
    v_lshlrev_b32 v100, 16, v6
    v_and_b32 v101, 0xffff0000, v6
    v_cvt_pk_bf16_f32 v6, v102, v103
    v_lshlrev_b32 v102, 16, v6
    v_and_b32 v103, 0xffff0000, v6
    v_mul_f32 v100, v100, v5
    v_mul_f32 v101, v101, v5
    v_mul_f32 v102, v102, v5
    v_mul_f32 v103, v103, v5
    v_cvt_pk_bf16_f32 v6, v100, v101
    v_cvt_pk_bf16_f32 v7, v102, v103
    v_lshlrev_b32 v8, 14, v2
    v_add_u32 v8, v8, v153
    ds_write_b64 v8, v[6:7] offset:10240
    v_cvt_pk_bf16_f32 v5, v120, v120
    v_and_b32 v5, 0xffff0000, v5
    v_add_f32 v5, s45, v5
    v_cvt_pk_bf16_f32 v5, v5, v5
    v_and_b32 v5, 0xffff0000, v5
    v_rcp_f32 v5, v5
    v_cvt_pk_bf16_f32 v6, v104, v105
    v_lshlrev_b32 v104, 16, v6
    v_and_b32 v105, 0xffff0000, v6
    v_cvt_pk_bf16_f32 v6, v106, v107
    v_lshlrev_b32 v106, 16, v6
    v_and_b32 v107, 0xffff0000, v6
    v_mul_f32 v104, v104, v5
    v_mul_f32 v105, v105, v5
    v_mul_f32 v106, v106, v5
    v_mul_f32 v107, v107, v5
    v_cvt_pk_bf16_f32 v6, v104, v105
    v_cvt_pk_bf16_f32 v7, v106, v107
    v_lshlrev_b32 v8, 14, v2
    v_add_u32 v8, v8, v153
    ds_write_b64 v8, v[6:7] offset:12288
    v_cvt_pk_bf16_f32 v5, v124, v124
    v_and_b32 v5, 0xffff0000, v5
    v_add_f32 v5, s45, v5
    v_cvt_pk_bf16_f32 v5, v5, v5
    v_and_b32 v5, 0xffff0000, v5
    v_rcp_f32 v5, v5
    v_cvt_pk_bf16_f32 v6, v108, v109
    v_lshlrev_b32 v108, 16, v6
    v_and_b32 v109, 0xffff0000, v6
    v_cvt_pk_bf16_f32 v6, v110, v111
    v_lshlrev_b32 v110, 16, v6
    v_and_b32 v111, 0xffff0000, v6
    v_mul_f32 v108, v108, v5
    v_mul_f32 v109, v109, v5
    v_mul_f32 v110, v110, v5
    v_mul_f32 v111, v111, v5
    v_cvt_pk_bf16_f32 v6, v108, v109
    v_cvt_pk_bf16_f32 v7, v110, v111
    v_lshlrev_b32 v8, 14, v2
    v_add_u32 v8, v8, v153
    ds_write_b64 v8, v[6:7] offset:14336
    s_add_u32 s42, s41, 7
    s_mul_i32 s43, s42, 2176
    s_add_u32 s43, s43, 13631488
    s_lshl_b32 s44, s42, 6
    s_add_u32 s44, s44, 2097152
    buffer_load_dwordx4 v[192:195], v21, s[16:19], s43 offen
    buffer_load_dwordx4 v[196:199], v21, s[16:19], s43 offen offset:16
    buffer_load_dwordx4 v[200:203], v22, s[16:19], s43 offen offset:2048
    buffer_load_dwordx4 v[204:207], v22, s[16:19], s43 offen offset:2064
    s_mov_b32 s46, 0
    s_add_u32 s46, s46, s44
    buffer_load_dwordx4 v[208:211], v20, s[16:19], s46 offen
    s_mov_b32 s46, 32768
    s_add_u32 s46, s46, s44
    buffer_load_dwordx4 v[212:215], v20, s[16:19], s46 offen
    s_mov_b32 s46, 65536
    s_add_u32 s46, s46, s44
    buffer_load_dwordx4 v[216:219], v20, s[16:19], s46 offen
    s_mov_b32 s46, 98304
    s_add_u32 s46, s46, s44
    buffer_load_dwordx4 v[220:223], v20, s[16:19], s46 offen
    s_waitcnt vmcnt(8)
    v_cvt_pk_bf16_f32 v24, v24, v25
    v_cvt_pk_bf16_f32 v25, v26, v27
    v_cvt_pk_bf16_f32 v26, v28, v29
    v_cvt_pk_bf16_f32 v27, v30, v31
    v_cvt_pk_bf16_f32 v32, v32, v33
    v_cvt_pk_bf16_f32 v33, v34, v35
    v_cvt_pk_bf16_f32 v34, v36, v37
    v_cvt_pk_bf16_f32 v35, v38, v39
    s_nop 1
    v_mfma_f32_16x16x32_bf16 v[96:99], v[24:27], v[40:43], 0
    v_mfma_f32_16x16x32_bf16 v[112:115], v[32:35], v[40:43], 0
    v_mfma_f32_16x16x32_bf16 v[100:103], v[24:27], v[44:47], 0
    v_mfma_f32_16x16x32_bf16 v[116:119], v[32:35], v[44:47], 0
    v_mfma_f32_16x16x32_bf16 v[104:107], v[24:27], v[48:51], 0
    v_mfma_f32_16x16x32_bf16 v[120:123], v[32:35], v[48:51], 0
    v_mfma_f32_16x16x32_bf16 v[108:111], v[24:27], v[52:55], 0
    v_mfma_f32_16x16x32_bf16 v[124:127], v[32:35], v[52:55], 0
    s_nop 7
    s_nop 7
    v_cvt_pk_bf16_f32 v5, v112, v112
    v_and_b32 v5, 0xffff0000, v5
    v_add_f32 v5, s45, v5
    v_cvt_pk_bf16_f32 v5, v5, v5
    v_and_b32 v5, 0xffff0000, v5
    v_rcp_f32 v5, v5
    v_cvt_pk_bf16_f32 v6, v96, v97
    v_lshlrev_b32 v96, 16, v6
    v_and_b32 v97, 0xffff0000, v6
    v_cvt_pk_bf16_f32 v6, v98, v99
    v_lshlrev_b32 v98, 16, v6
    v_and_b32 v99, 0xffff0000, v6
    v_mul_f32 v96, v96, v5
    v_mul_f32 v97, v97, v5
    v_mul_f32 v98, v98, v5
    v_mul_f32 v99, v99, v5
    v_cvt_pk_bf16_f32 v6, v96, v97
    v_cvt_pk_bf16_f32 v7, v98, v99
    v_lshlrev_b32 v8, 14, v2
    v_add_u32 v8, v8, v154
    ds_write_b64 v8, v[6:7] offset:8192
    v_cvt_pk_bf16_f32 v5, v116, v116
    v_and_b32 v5, 0xffff0000, v5
    v_add_f32 v5, s45, v5
    v_cvt_pk_bf16_f32 v5, v5, v5
    v_and_b32 v5, 0xffff0000, v5
    v_rcp_f32 v5, v5
    v_cvt_pk_bf16_f32 v6, v100, v101
    v_lshlrev_b32 v100, 16, v6
    v_and_b32 v101, 0xffff0000, v6
    v_cvt_pk_bf16_f32 v6, v102, v103
    v_lshlrev_b32 v102, 16, v6
    v_and_b32 v103, 0xffff0000, v6
    v_mul_f32 v100, v100, v5
    v_mul_f32 v101, v101, v5
    v_mul_f32 v102, v102, v5
    v_mul_f32 v103, v103, v5
    v_cvt_pk_bf16_f32 v6, v100, v101
    v_cvt_pk_bf16_f32 v7, v102, v103
    v_lshlrev_b32 v8, 14, v2
    v_add_u32 v8, v8, v154
    ds_write_b64 v8, v[6:7] offset:10240
    v_cvt_pk_bf16_f32 v5, v120, v120
    v_and_b32 v5, 0xffff0000, v5
    v_add_f32 v5, s45, v5
    v_cvt_pk_bf16_f32 v5, v5, v5
    v_and_b32 v5, 0xffff0000, v5
    v_rcp_f32 v5, v5
    v_cvt_pk_bf16_f32 v6, v104, v105
    v_lshlrev_b32 v104, 16, v6
    v_and_b32 v105, 0xffff0000, v6
    v_cvt_pk_bf16_f32 v6, v106, v107
    v_lshlrev_b32 v106, 16, v6
    v_and_b32 v107, 0xffff0000, v6
    v_mul_f32 v104, v104, v5
    v_mul_f32 v105, v105, v5
    v_mul_f32 v106, v106, v5
    v_mul_f32 v107, v107, v5
    v_cvt_pk_bf16_f32 v6, v104, v105
    v_cvt_pk_bf16_f32 v7, v106, v107
    v_lshlrev_b32 v8, 14, v2
    v_add_u32 v8, v8, v154
    ds_write_b64 v8, v[6:7] offset:12288
    v_cvt_pk_bf16_f32 v5, v124, v124
    v_and_b32 v5, 0xffff0000, v5
    v_add_f32 v5, s45, v5
    v_cvt_pk_bf16_f32 v5, v5, v5
    v_and_b32 v5, 0xffff0000, v5
    v_rcp_f32 v5, v5
    v_cvt_pk_bf16_f32 v6, v108, v109
    v_lshlrev_b32 v108, 16, v6
    v_and_b32 v109, 0xffff0000, v6
    v_cvt_pk_bf16_f32 v6, v110, v111
    v_lshlrev_b32 v110, 16, v6
    v_and_b32 v111, 0xffff0000, v6
    v_mul_f32 v108, v108, v5
    v_mul_f32 v109, v109, v5
    v_mul_f32 v110, v110, v5
    v_mul_f32 v111, v111, v5
    v_cvt_pk_bf16_f32 v6, v108, v109
    v_cvt_pk_bf16_f32 v7, v110, v111
    v_lshlrev_b32 v8, 14, v2
    v_add_u32 v8, v8, v154
    ds_write_b64 v8, v[6:7] offset:14336
    s_waitcnt vmcnt(0)
    v_cvt_pk_bf16_f32 v192, v192, v193
    v_cvt_pk_bf16_f32 v193, v194, v195
    v_cvt_pk_bf16_f32 v194, v196, v197
    v_cvt_pk_bf16_f32 v195, v198, v199
    v_cvt_pk_bf16_f32 v200, v200, v201
    v_cvt_pk_bf16_f32 v201, v202, v203
    v_cvt_pk_bf16_f32 v202, v204, v205
    v_cvt_pk_bf16_f32 v203, v206, v207
    s_nop 1
    v_mfma_f32_16x16x32_bf16 v[96:99], v[192:195], v[208:211], 0
    v_mfma_f32_16x16x32_bf16 v[112:115], v[200:203], v[208:211], 0
    v_mfma_f32_16x16x32_bf16 v[100:103], v[192:195], v[212:215], 0
    v_mfma_f32_16x16x32_bf16 v[116:119], v[200:203], v[212:215], 0
    v_mfma_f32_16x16x32_bf16 v[104:107], v[192:195], v[216:219], 0
    v_mfma_f32_16x16x32_bf16 v[120:123], v[200:203], v[216:219], 0
    v_mfma_f32_16x16x32_bf16 v[108:111], v[192:195], v[220:223], 0
    v_mfma_f32_16x16x32_bf16 v[124:127], v[200:203], v[220:223], 0
    s_nop 7
    s_nop 7
    v_cvt_pk_bf16_f32 v5, v112, v112
    v_and_b32 v5, 0xffff0000, v5
    v_add_f32 v5, s45, v5
    v_cvt_pk_bf16_f32 v5, v5, v5
    v_and_b32 v5, 0xffff0000, v5
    v_rcp_f32 v5, v5
    v_cvt_pk_bf16_f32 v6, v96, v97
    v_lshlrev_b32 v96, 16, v6
    v_and_b32 v97, 0xffff0000, v6
    v_cvt_pk_bf16_f32 v6, v98, v99
    v_lshlrev_b32 v98, 16, v6
    v_and_b32 v99, 0xffff0000, v6
    v_mul_f32 v96, v96, v5
    v_mul_f32 v97, v97, v5
    v_mul_f32 v98, v98, v5
    v_mul_f32 v99, v99, v5
    v_cvt_pk_bf16_f32 v6, v96, v97
    v_cvt_pk_bf16_f32 v7, v98, v99
    v_lshlrev_b32 v8, 14, v2
    v_add_u32 v8, v8, v155
    ds_write_b64 v8, v[6:7] offset:8192
    v_cvt_pk_bf16_f32 v5, v116, v116
    v_and_b32 v5, 0xffff0000, v5
    v_add_f32 v5, s45, v5
    v_cvt_pk_bf16_f32 v5, v5, v5
    v_and_b32 v5, 0xffff0000, v5
    v_rcp_f32 v5, v5
    v_cvt_pk_bf16_f32 v6, v100, v101
    v_lshlrev_b32 v100, 16, v6
    v_and_b32 v101, 0xffff0000, v6
    v_cvt_pk_bf16_f32 v6, v102, v103
    v_lshlrev_b32 v102, 16, v6
    v_and_b32 v103, 0xffff0000, v6
    v_mul_f32 v100, v100, v5
    v_mul_f32 v101, v101, v5
    v_mul_f32 v102, v102, v5
    v_mul_f32 v103, v103, v5
    v_cvt_pk_bf16_f32 v6, v100, v101
    v_cvt_pk_bf16_f32 v7, v102, v103
    v_lshlrev_b32 v8, 14, v2
    v_add_u32 v8, v8, v155
    ds_write_b64 v8, v[6:7] offset:10240
    v_cvt_pk_bf16_f32 v5, v120, v120
    v_and_b32 v5, 0xffff0000, v5
    v_add_f32 v5, s45, v5
    v_cvt_pk_bf16_f32 v5, v5, v5
    v_and_b32 v5, 0xffff0000, v5
    v_rcp_f32 v5, v5
    v_cvt_pk_bf16_f32 v6, v104, v105
    v_lshlrev_b32 v104, 16, v6
    v_and_b32 v105, 0xffff0000, v6
    v_cvt_pk_bf16_f32 v6, v106, v107
    v_lshlrev_b32 v106, 16, v6
    v_and_b32 v107, 0xffff0000, v6
    v_mul_f32 v104, v104, v5
    v_mul_f32 v105, v105, v5
    v_mul_f32 v106, v106, v5
    v_mul_f32 v107, v107, v5
    v_cvt_pk_bf16_f32 v6, v104, v105
    v_cvt_pk_bf16_f32 v7, v106, v107
    v_lshlrev_b32 v8, 14, v2
    v_add_u32 v8, v8, v155
    ds_write_b64 v8, v[6:7] offset:12288
    v_cvt_pk_bf16_f32 v5, v124, v124
    v_and_b32 v5, 0xffff0000, v5
    v_add_f32 v5, s45, v5
    v_cvt_pk_bf16_f32 v5, v5, v5
    v_and_b32 v5, 0xffff0000, v5
    v_rcp_f32 v5, v5
    v_cvt_pk_bf16_f32 v6, v108, v109
    v_lshlrev_b32 v108, 16, v6
    v_and_b32 v109, 0xffff0000, v6
    v_cvt_pk_bf16_f32 v6, v110, v111
    v_lshlrev_b32 v110, 16, v6
    v_and_b32 v111, 0xffff0000, v6
    v_mul_f32 v108, v108, v5
    v_mul_f32 v109, v109, v5
    v_mul_f32 v110, v110, v5
    v_mul_f32 v111, v111, v5
    v_cvt_pk_bf16_f32 v6, v108, v109
    v_cvt_pk_bf16_f32 v7, v110, v111
    v_lshlrev_b32 v8, 14, v2
    v_add_u32 v8, v8, v155
    ds_write_b64 v8, v[6:7] offset:14336
    s_waitcnt vmcnt(0)
    ds_write_b128 v147, v[136:139] offset:0
    ds_write_b128 v147, v[140:143] offset:4096
    s_waitcnt lgkmcnt(0)
    s_mov_b32 s40, 196608
    buffer_load_dwordx4 v[136:139], v145, s[20:23], s40 offen
    s_mov_b32 s40, 229376
    buffer_load_dwordx4 v[140:143], v145, s[20:23], s40 offen
    s_barrier
    ds_read_b128 v[96:99], v148 offset:0
    ds_read_b128 v[100:103], v148 offset:2048
    ds_read_b64_tr_b16 v[112:113], v150 offset:0
    ds_read_b64_tr_b16 v[114:115], v150 offset:512
    ds_read_b64_tr_b16 v[116:117], v151 offset:0
    ds_read_b64_tr_b16 v[118:119], v151 offset:512
    ds_read_b128 v[104:107], v149 offset:0
    ds_read_b128 v[108:111], v149 offset:2048
    ds_read_b64_tr_b16 v[120:121], v150 offset:4096
    ds_read_b64_tr_b16 v[122:123], v150 offset:4608
    ds_read_b64_tr_b16 v[124:125], v151 offset:4096
    ds_read_b64_tr_b16 v[126:127], v151 offset:4608
    s_waitcnt lgkmcnt(6)
    v_mfma_f32_16x16x32_bf16 v[64:67], v[112:115], v[96:99], 0
    v_mfma_f32_16x16x32_bf16 v[68:71], v[112:115], v[100:103], 0
    v_mfma_f32_16x16x32_bf16 v[72:75], v[116:119], v[96:99], 0
    v_mfma_f32_16x16x32_bf16 v[76:79], v[116:119], v[100:103], 0
    s_waitcnt lgkmcnt(0)
    v_mfma_f32_16x16x32_bf16 v[64:67], v[120:123], v[104:107], v[64:67]
    v_mfma_f32_16x16x32_bf16 v[68:71], v[120:123], v[108:111], v[68:71]
    v_mfma_f32_16x16x32_bf16 v[72:75], v[124:127], v[104:107], v[72:75]
    v_mfma_f32_16x16x32_bf16 v[76:79], v[124:127], v[108:111], v[76:79]
    s_waitcnt vmcnt(4)
    ds_write_b128 v147, v[168:171] offset:8192
    ds_write_b128 v147, v[172:175] offset:12288
    s_waitcnt lgkmcnt(0)
    s_mov_b32 s40, 262144
    buffer_load_dwordx4 v[168:171], v145, s[20:23], s40 offen
    s_mov_b32 s40, 294912
    buffer_load_dwordx4 v[172:175], v145, s[20:23], s40 offen
    s_barrier
    ds_read_b128 v[96:99], v148 offset:8192
    ds_read_b128 v[100:103], v148 offset:10240
    ds_read_b64_tr_b16 v[112:113], v150 offset:8192
    ds_read_b64_tr_b16 v[114:115], v150 offset:8704
    ds_read_b64_tr_b16 v[116:117], v151 offset:8192
    ds_read_b64_tr_b16 v[118:119], v151 offset:8704
    ds_read_b128 v[104:107], v149 offset:8192
    ds_read_b128 v[108:111], v149 offset:10240
    ds_read_b64_tr_b16 v[120:121], v150 offset:12288
    ds_read_b64_tr_b16 v[122:123], v150 offset:12800
    ds_read_b64_tr_b16 v[124:125], v151 offset:12288
    ds_read_b64_tr_b16 v[126:127], v151 offset:12800
    s_waitcnt lgkmcnt(6)
    v_mfma_f32_16x16x32_bf16 v[64:67], v[112:115], v[96:99], v[64:67]
    v_mfma_f32_16x16x32_bf16 v[68:71], v[112:115], v[100:103], v[68:71]
    v_mfma_f32_16x16x32_bf16 v[72:75], v[116:119], v[96:99], v[72:75]
    v_mfma_f32_16x16x32_bf16 v[76:79], v[116:119], v[100:103], v[76:79]
    s_waitcnt lgkmcnt(0)
    v_mfma_f32_16x16x32_bf16 v[64:67], v[120:123], v[104:107], v[64:67]
    v_mfma_f32_16x16x32_bf16 v[68:71], v[120:123], v[108:111], v[68:71]
    v_mfma_f32_16x16x32_bf16 v[72:75], v[124:127], v[104:107], v[72:75]
    v_mfma_f32_16x16x32_bf16 v[76:79], v[124:127], v[108:111], v[76:79]
    s_waitcnt vmcnt(4)
    ds_write_b128 v147, v[184:187] offset:0
    ds_write_b128 v147, v[188:191] offset:4096
    s_waitcnt lgkmcnt(0)
    s_mov_b32 s40, 327680
    buffer_load_dwordx4 v[184:187], v145, s[20:23], s40 offen
    s_mov_b32 s40, 360448
    buffer_load_dwordx4 v[188:191], v145, s[20:23], s40 offen
    s_barrier
    ds_read_b128 v[96:99], v148 offset:16384
    ds_read_b128 v[100:103], v148 offset:18432
    ds_read_b64_tr_b16 v[112:113], v150 offset:0
    ds_read_b64_tr_b16 v[114:115], v150 offset:512
    ds_read_b64_tr_b16 v[116:117], v151 offset:0
    ds_read_b64_tr_b16 v[118:119], v151 offset:512
    ds_read_b128 v[104:107], v149 offset:16384
    ds_read_b128 v[108:111], v149 offset:18432
    ds_read_b64_tr_b16 v[120:121], v150 offset:4096
    ds_read_b64_tr_b16 v[122:123], v150 offset:4608
    ds_read_b64_tr_b16 v[124:125], v151 offset:4096
    ds_read_b64_tr_b16 v[126:127], v151 offset:4608
    s_waitcnt lgkmcnt(6)
    v_mfma_f32_16x16x32_bf16 v[64:67], v[112:115], v[96:99], v[64:67]
    v_mfma_f32_16x16x32_bf16 v[68:71], v[112:115], v[100:103], v[68:71]
    v_mfma_f32_16x16x32_bf16 v[72:75], v[116:119], v[96:99], v[72:75]
    v_mfma_f32_16x16x32_bf16 v[76:79], v[116:119], v[100:103], v[76:79]
    s_waitcnt lgkmcnt(0)
    v_mfma_f32_16x16x32_bf16 v[64:67], v[120:123], v[104:107], v[64:67]
    v_mfma_f32_16x16x32_bf16 v[68:71], v[120:123], v[108:111], v[68:71]
    v_mfma_f32_16x16x32_bf16 v[72:75], v[124:127], v[104:107], v[72:75]
    v_mfma_f32_16x16x32_bf16 v[76:79], v[124:127], v[108:111], v[76:79]
    s_waitcnt vmcnt(4)
    ds_write_b128 v147, v[136:139] offset:8192
    ds_write_b128 v147, v[140:143] offset:12288
    s_waitcnt lgkmcnt(0)
    s_mov_b32 s40, 393216
    buffer_load_dwordx4 v[136:139], v145, s[20:23], s40 offen
    s_mov_b32 s40, 425984
    buffer_load_dwordx4 v[140:143], v145, s[20:23], s40 offen
    s_barrier
    ds_read_b128 v[96:99], v148 offset:24576
    ds_read_b128 v[100:103], v148 offset:26624
    ds_read_b64_tr_b16 v[112:113], v150 offset:8192
    ds_read_b64_tr_b16 v[114:115], v150 offset:8704
    ds_read_b64_tr_b16 v[116:117], v151 offset:8192
    ds_read_b64_tr_b16 v[118:119], v151 offset:8704
    ds_read_b128 v[104:107], v149 offset:24576
    ds_read_b128 v[108:111], v149 offset:26624
    ds_read_b64_tr_b16 v[120:121], v150 offset:12288
    ds_read_b64_tr_b16 v[122:123], v150 offset:12800
    ds_read_b64_tr_b16 v[124:125], v151 offset:12288
    ds_read_b64_tr_b16 v[126:127], v151 offset:12800
    s_waitcnt lgkmcnt(6)
    v_mfma_f32_16x16x32_bf16 v[64:67], v[112:115], v[96:99], v[64:67]
    v_mfma_f32_16x16x32_bf16 v[68:71], v[112:115], v[100:103], v[68:71]
    v_mfma_f32_16x16x32_bf16 v[72:75], v[116:119], v[96:99], v[72:75]
    v_mfma_f32_16x16x32_bf16 v[76:79], v[116:119], v[100:103], v[76:79]
    s_waitcnt lgkmcnt(0)
    v_mfma_f32_16x16x32_bf16 v[64:67], v[120:123], v[104:107], v[64:67]
    v_mfma_f32_16x16x32_bf16 v[68:71], v[120:123], v[108:111], v[68:71]
    v_mfma_f32_16x16x32_bf16 v[72:75], v[124:127], v[104:107], v[72:75]
    v_mfma_f32_16x16x32_bf16 v[76:79], v[124:127], v[108:111], v[76:79]
    s_waitcnt vmcnt(4)
    ds_write_b128 v147, v[168:171] offset:0
    ds_write_b128 v147, v[172:175] offset:4096
    s_waitcnt lgkmcnt(0)
    s_mov_b32 s40, 458752
    buffer_load_dwordx4 v[168:171], v145, s[20:23], s40 offen
    s_mov_b32 s40, 491520
    buffer_load_dwordx4 v[172:175], v145, s[20:23], s40 offen
    s_barrier
    ds_read_b128 v[96:99], v148 offset:32768
    ds_read_b128 v[100:103], v148 offset:34816
    ds_read_b64_tr_b16 v[112:113], v150 offset:0
    ds_read_b64_tr_b16 v[114:115], v150 offset:512
    ds_read_b64_tr_b16 v[116:117], v151 offset:0
    ds_read_b64_tr_b16 v[118:119], v151 offset:512
    ds_read_b128 v[104:107], v149 offset:32768
    ds_read_b128 v[108:111], v149 offset:34816
    ds_read_b64_tr_b16 v[120:121], v150 offset:4096
    ds_read_b64_tr_b16 v[122:123], v150 offset:4608
    ds_read_b64_tr_b16 v[124:125], v151 offset:4096
    ds_read_b64_tr_b16 v[126:127], v151 offset:4608
    s_waitcnt lgkmcnt(6)
    v_mfma_f32_16x16x32_bf16 v[64:67], v[112:115], v[96:99], v[64:67]
    v_mfma_f32_16x16x32_bf16 v[68:71], v[112:115], v[100:103], v[68:71]
    v_mfma_f32_16x16x32_bf16 v[72:75], v[116:119], v[96:99], v[72:75]
    v_mfma_f32_16x16x32_bf16 v[76:79], v[116:119], v[100:103], v[76:79]
    s_waitcnt lgkmcnt(0)
    v_mfma_f32_16x16x32_bf16 v[64:67], v[120:123], v[104:107], v[64:67]
    v_mfma_f32_16x16x32_bf16 v[68:71], v[120:123], v[108:111], v[68:71]
    v_mfma_f32_16x16x32_bf16 v[72:75], v[124:127], v[104:107], v[72:75]
    v_mfma_f32_16x16x32_bf16 v[76:79], v[124:127], v[108:111], v[76:79]
    s_waitcnt vmcnt(4)
    ds_write_b128 v147, v[184:187] offset:8192
    ds_write_b128 v147, v[188:191] offset:12288
    s_waitcnt lgkmcnt(0)
    s_mov_b32 s40, 0
    buffer_load_dwordx4 v[184:187], v145, s[24:27], s40 offen
    s_mov_b32 s40, 32768
    buffer_load_dwordx4 v[188:191], v145, s[24:27], s40 offen
    s_mov_b32 s40, 6291456
    buffer_load_dwordx4 v[176:179], v144, s[16:19], s40 offen offset:0
    s_mov_b32 s40, 6406144
    buffer_load_dwordx4 v[180:183], v144, s[16:19], s40 offen offset:0
    s_barrier
    ds_read_b128 v[96:99], v148 offset:40960
    ds_read_b128 v[100:103], v148 offset:43008
    ds_read_b64_tr_b16 v[112:113], v150 offset:8192
    ds_read_b64_tr_b16 v[114:115], v150 offset:8704
    ds_read_b64_tr_b16 v[116:117], v151 offset:8192
    ds_read_b64_tr_b16 v[118:119], v151 offset:8704
    ds_read_b128 v[104:107], v149 offset:40960
    ds_read_b128 v[108:111], v149 offset:43008
    ds_read_b64_tr_b16 v[120:121], v150 offset:12288
    ds_read_b64_tr_b16 v[122:123], v150 offset:12800
    ds_read_b64_tr_b16 v[124:125], v151 offset:12288
    ds_read_b64_tr_b16 v[126:127], v151 offset:12800
    s_waitcnt lgkmcnt(6)
    v_mfma_f32_16x16x32_bf16 v[64:67], v[112:115], v[96:99], v[64:67]
    v_mfma_f32_16x16x32_bf16 v[68:71], v[112:115], v[100:103], v[68:71]
    v_mfma_f32_16x16x32_bf16 v[72:75], v[116:119], v[96:99], v[72:75]
    v_mfma_f32_16x16x32_bf16 v[76:79], v[116:119], v[100:103], v[76:79]
    s_waitcnt lgkmcnt(0)
    v_mfma_f32_16x16x32_bf16 v[64:67], v[120:123], v[104:107], v[64:67]
    v_mfma_f32_16x16x32_bf16 v[68:71], v[120:123], v[108:111], v[68:71]
    v_mfma_f32_16x16x32_bf16 v[72:75], v[124:127], v[104:107], v[72:75]
    v_mfma_f32_16x16x32_bf16 v[76:79], v[124:127], v[108:111], v[76:79]
    s_waitcnt vmcnt(6)
    ds_write_b128 v147, v[136:139] offset:0
    ds_write_b128 v147, v[140:143] offset:4096
    s_waitcnt lgkmcnt(0)
    s_mov_b32 s40, 65536
    buffer_load_dwordx4 v[136:139], v145, s[24:27], s40 offen
    s_mov_b32 s40, 98304
    buffer_load_dwordx4 v[140:143], v145, s[24:27], s40 offen
    s_mov_b32 s40, 6291456
    buffer_load_dwordx4 v[128:131], v144, s[16:19], s40 offen offset:128
    s_mov_b32 s40, 6406144
    buffer_load_dwordx4 v[132:135], v144, s[16:19], s40 offen offset:128
    s_barrier
    ds_read_b128 v[96:99], v148 offset:49152
    ds_read_b128 v[100:103], v148 offset:51200
    ds_read_b64_tr_b16 v[112:113], v150 offset:0
    ds_read_b64_tr_b16 v[114:115], v150 offset:512
    ds_read_b64_tr_b16 v[116:117], v151 offset:0
    ds_read_b64_tr_b16 v[118:119], v151 offset:512
    ds_read_b128 v[104:107], v149 offset:49152
    ds_read_b128 v[108:111], v149 offset:51200
    ds_read_b64_tr_b16 v[120:121], v150 offset:4096
    ds_read_b64_tr_b16 v[122:123], v150 offset:4608
    ds_read_b64_tr_b16 v[124:125], v151 offset:4096
    ds_read_b64_tr_b16 v[126:127], v151 offset:4608
    s_waitcnt lgkmcnt(6)
    v_mfma_f32_16x16x32_bf16 v[64:67], v[112:115], v[96:99], v[64:67]
    v_mfma_f32_16x16x32_bf16 v[68:71], v[112:115], v[100:103], v[68:71]
    v_mfma_f32_16x16x32_bf16 v[72:75], v[116:119], v[96:99], v[72:75]
    v_mfma_f32_16x16x32_bf16 v[76:79], v[116:119], v[100:103], v[76:79]
    s_waitcnt lgkmcnt(0)
    v_mfma_f32_16x16x32_bf16 v[64:67], v[120:123], v[104:107], v[64:67]
    v_mfma_f32_16x16x32_bf16 v[68:71], v[120:123], v[108:111], v[68:71]
    v_mfma_f32_16x16x32_bf16 v[72:75], v[124:127], v[104:107], v[72:75]
    v_mfma_f32_16x16x32_bf16 v[76:79], v[124:127], v[108:111], v[76:79]
    s_waitcnt vmcnt(8)
    ds_write_b128 v147, v[168:171] offset:8192
    ds_write_b128 v147, v[172:175] offset:12288
    s_waitcnt lgkmcnt(0)
    s_mov_b32 s40, 131072
    buffer_load_dwordx4 v[168:171], v145, s[24:27], s40 offen
    s_mov_b32 s40, 163840
    buffer_load_dwordx4 v[172:175], v145, s[24:27], s40 offen
    s_mov_b32 s40, 6291456
    buffer_load_dwordx4 v[160:163], v144, s[16:19], s40 offen offset:256
    s_mov_b32 s40, 6406144
    buffer_load_dwordx4 v[164:167], v144, s[16:19], s40 offen offset:256
    s_barrier
    ds_read_b128 v[96:99], v148 offset:57344
    ds_read_b128 v[100:103], v148 offset:59392
    ds_read_b64_tr_b16 v[112:113], v150 offset:8192
    ds_read_b64_tr_b16 v[114:115], v150 offset:8704
    ds_read_b64_tr_b16 v[116:117], v151 offset:8192
    ds_read_b64_tr_b16 v[118:119], v151 offset:8704
    ds_read_b128 v[104:107], v149 offset:57344
    ds_read_b128 v[108:111], v149 offset:59392
    ds_read_b64_tr_b16 v[120:121], v150 offset:12288
    ds_read_b64_tr_b16 v[122:123], v150 offset:12800
    ds_read_b64_tr_b16 v[124:125], v151 offset:12288
    ds_read_b64_tr_b16 v[126:127], v151 offset:12800
    s_waitcnt lgkmcnt(6)
    v_mfma_f32_16x16x32_bf16 v[64:67], v[112:115], v[96:99], v[64:67]
    v_mfma_f32_16x16x32_bf16 v[68:71], v[112:115], v[100:103], v[68:71]
    v_mfma_f32_16x16x32_bf16 v[72:75], v[116:119], v[96:99], v[72:75]
    v_mfma_f32_16x16x32_bf16 v[76:79], v[116:119], v[100:103], v[76:79]
    s_waitcnt lgkmcnt(0)
    v_mfma_f32_16x16x32_bf16 v[64:67], v[120:123], v[104:107], v[64:67]
    v_mfma_f32_16x16x32_bf16 v[68:71], v[120:123], v[108:111], v[68:71]
    v_mfma_f32_16x16x32_bf16 v[72:75], v[124:127], v[104:107], v[72:75]
    v_mfma_f32_16x16x32_bf16 v[76:79], v[124:127], v[108:111], v[76:79]
    s_waitcnt vmcnt(8)
    ds_write_b128 v147, v[184:187] offset:0
    ds_write_b128 v147, v[188:191] offset:4096
    ds_write_b128 v146, v[176:179] offset:0
    ds_write_b128 v146, v[180:183] offset:4096
    s_waitcnt lgkmcnt(0)
    s_mov_b32 s40, 196608
    buffer_load_dwordx4 v[184:187], v145, s[24:27], s40 offen
    s_mov_b32 s40, 229376
    buffer_load_dwordx4 v[188:191], v145, s[24:27], s40 offen
    s_mov_b32 s40, 6291456
    buffer_load_dwordx4 v[176:179], v144, s[16:19], s40 offen offset:384
    s_mov_b32 s40, 6406144
    buffer_load_dwordx4 v[180:183], v144, s[16:19], s40 offen offset:384
    s_barrier
    ds_read_b128 v[96:99], v156 offset:0
    ds_read_b128 v[100:103], v156 offset:2048
    ds_read_b64_tr_b16 v[112:113], v150 offset:0
    ds_read_b64_tr_b16 v[114:115], v150 offset:512
    ds_read_b64_tr_b16 v[116:117], v151 offset:0
    ds_read_b64_tr_b16 v[118:119], v151 offset:512
    ds_read_b128 v[104:107], v157 offset:0
    ds_read_b128 v[108:111], v157 offset:2048
    ds_read_b64_tr_b16 v[120:121], v150 offset:4096
    ds_read_b64_tr_b16 v[122:123], v150 offset:4608
    ds_read_b64_tr_b16 v[124:125], v151 offset:4096
    ds_read_b64_tr_b16 v[126:127], v151 offset:4608
    s_waitcnt lgkmcnt(6)
    v_mfma_f32_16x16x32_bf16 v[80:83], v[112:115], v[96:99], 0
    v_mfma_f32_16x16x32_bf16 v[84:87], v[112:115], v[100:103], 0
    v_mfma_f32_16x16x32_bf16 v[88:91], v[116:119], v[96:99], 0
    v_mfma_f32_16x16x32_bf16 v[92:95], v[116:119], v[100:103], 0
    s_waitcnt lgkmcnt(0)
    v_mfma_f32_16x16x32_bf16 v[80:83], v[120:123], v[104:107], v[80:83]
    v_mfma_f32_16x16x32_bf16 v[84:87], v[120:123], v[108:111], v[84:87]
    v_mfma_f32_16x16x32_bf16 v[88:91], v[124:127], v[104:107], v[88:91]
    v_mfma_f32_16x16x32_bf16 v[92:95], v[124:127], v[108:111], v[92:95]
    s_waitcnt vmcnt(8)
    ds_write_b128 v147, v[136:139] offset:8192
    ds_write_b128 v147, v[140:143] offset:12288
    ds_write_b128 v146, v[128:131] offset:8192
    ds_write_b128 v146, v[132:135] offset:12288
    s_waitcnt lgkmcnt(0)
    s_mov_b32 s40, 262144
    buffer_load_dwordx4 v[136:139], v145, s[24:27], s40 offen
    s_mov_b32 s40, 294912
    buffer_load_dwordx4 v[140:143], v145, s[24:27], s40 offen
    s_mov_b32 s40, 6291456
    buffer_load_dwordx4 v[128:131], v144, s[16:19], s40 offen offset:512
    s_mov_b32 s40, 6406144
    buffer_load_dwordx4 v[132:135], v144, s[16:19], s40 offen offset:512
    s_barrier
    ds_read_b128 v[96:99], v156 offset:8192
    ds_read_b128 v[100:103], v156 offset:10240
    ds_read_b64_tr_b16 v[112:113], v150 offset:8192
    ds_read_b64_tr_b16 v[114:115], v150 offset:8704
    ds_read_b64_tr_b16 v[116:117], v151 offset:8192
    ds_read_b64_tr_b16 v[118:119], v151 offset:8704
    ds_read_b128 v[104:107], v157 offset:8192
    ds_read_b128 v[108:111], v157 offset:10240
    ds_read_b64_tr_b16 v[120:121], v150 offset:12288
    ds_read_b64_tr_b16 v[122:123], v150 offset:12800
    ds_read_b64_tr_b16 v[124:125], v151 offset:12288
    ds_read_b64_tr_b16 v[126:127], v151 offset:12800
    s_waitcnt lgkmcnt(6)
    v_mfma_f32_16x16x32_bf16 v[80:83], v[112:115], v[96:99], v[80:83]
    v_mfma_f32_16x16x32_bf16 v[84:87], v[112:115], v[100:103], v[84:87]
    v_mfma_f32_16x16x32_bf16 v[88:91], v[116:119], v[96:99], v[88:91]
    v_mfma_f32_16x16x32_bf16 v[92:95], v[116:119], v[100:103], v[92:95]
    s_waitcnt lgkmcnt(0)
    v_mfma_f32_16x16x32_bf16 v[80:83], v[120:123], v[104:107], v[80:83]
    v_mfma_f32_16x16x32_bf16 v[84:87], v[120:123], v[108:111], v[84:87]
    v_mfma_f32_16x16x32_bf16 v[88:91], v[124:127], v[104:107], v[88:91]
    v_mfma_f32_16x16x32_bf16 v[92:95], v[124:127], v[108:111], v[92:95]
    s_waitcnt vmcnt(8)
    ds_write_b128 v147, v[168:171] offset:0
    ds_write_b128 v147, v[172:175] offset:4096
    ds_write_b128 v146, v[160:163] offset:0
    ds_write_b128 v146, v[164:167] offset:4096
    s_waitcnt lgkmcnt(0)
    s_mov_b32 s40, 327680
    buffer_load_dwordx4 v[168:171], v145, s[24:27], s40 offen
    s_mov_b32 s40, 360448
    buffer_load_dwordx4 v[172:175], v145, s[24:27], s40 offen
    s_mov_b32 s40, 6291456
    buffer_load_dwordx4 v[160:163], v144, s[16:19], s40 offen offset:640
    s_mov_b32 s40, 6406144
    buffer_load_dwordx4 v[164:167], v144, s[16:19], s40 offen offset:640
    s_barrier
    ds_read_b128 v[96:99], v156 offset:0
    ds_read_b128 v[100:103], v156 offset:2048
    ds_read_b64_tr_b16 v[112:113], v150 offset:0
    ds_read_b64_tr_b16 v[114:115], v150 offset:512
    ds_read_b64_tr_b16 v[116:117], v151 offset:0
    ds_read_b64_tr_b16 v[118:119], v151 offset:512
    ds_read_b128 v[104:107], v157 offset:0
    ds_read_b128 v[108:111], v157 offset:2048
    ds_read_b64_tr_b16 v[120:121], v150 offset:4096
    ds_read_b64_tr_b16 v[122:123], v150 offset:4608
    ds_read_b64_tr_b16 v[124:125], v151 offset:4096
    ds_read_b64_tr_b16 v[126:127], v151 offset:4608
    s_waitcnt lgkmcnt(6)
    v_mfma_f32_16x16x32_bf16 v[80:83], v[112:115], v[96:99], v[80:83]
    v_mfma_f32_16x16x32_bf16 v[84:87], v[112:115], v[100:103], v[84:87]
    v_mfma_f32_16x16x32_bf16 v[88:91], v[116:119], v[96:99], v[88:91]
    v_mfma_f32_16x16x32_bf16 v[92:95], v[116:119], v[100:103], v[92:95]
    s_waitcnt lgkmcnt(0)
    v_mfma_f32_16x16x32_bf16 v[80:83], v[120:123], v[104:107], v[80:83]
    v_mfma_f32_16x16x32_bf16 v[84:87], v[120:123], v[108:111], v[84:87]
    v_mfma_f32_16x16x32_bf16 v[88:91], v[124:127], v[104:107], v[88:91]
    v_mfma_f32_16x16x32_bf16 v[92:95], v[124:127], v[108:111], v[92:95]
    s_waitcnt vmcnt(8)
    ds_write_b128 v147, v[184:187] offset:8192
    ds_write_b128 v147, v[188:191] offset:12288
    ds_write_b128 v146, v[176:179] offset:8192
    ds_write_b128 v146, v[180:183] offset:12288
    s_waitcnt lgkmcnt(0)
    s_mov_b32 s40, 393216
    buffer_load_dwordx4 v[184:187], v145, s[24:27], s40 offen
    s_mov_b32 s40, 425984
    buffer_load_dwordx4 v[188:191], v145, s[24:27], s40 offen
    s_mov_b32 s40, 6291456
    buffer_load_dwordx4 v[176:179], v144, s[16:19], s40 offen offset:768
    s_mov_b32 s40, 6406144
    buffer_load_dwordx4 v[180:183], v144, s[16:19], s40 offen offset:768
    s_barrier
    ds_read_b128 v[96:99], v156 offset:8192
    ds_read_b128 v[100:103], v156 offset:10240
    ds_read_b64_tr_b16 v[112:113], v150 offset:8192
    ds_read_b64_tr_b16 v[114:115], v150 offset:8704
    ds_read_b64_tr_b16 v[116:117], v151 offset:8192
    ds_read_b64_tr_b16 v[118:119], v151 offset:8704
    ds_read_b128 v[104:107], v157 offset:8192
    ds_read_b128 v[108:111], v157 offset:10240
    ds_read_b64_tr_b16 v[120:121], v150 offset:12288
    ds_read_b64_tr_b16 v[122:123], v150 offset:12800
    ds_read_b64_tr_b16 v[124:125], v151 offset:12288
    ds_read_b64_tr_b16 v[126:127], v151 offset:12800
    s_waitcnt lgkmcnt(6)
    v_mfma_f32_16x16x32_bf16 v[80:83], v[112:115], v[96:99], v[80:83]
    v_mfma_f32_16x16x32_bf16 v[84:87], v[112:115], v[100:103], v[84:87]
    v_mfma_f32_16x16x32_bf16 v[88:91], v[116:119], v[96:99], v[88:91]
    v_mfma_f32_16x16x32_bf16 v[92:95], v[116:119], v[100:103], v[92:95]
    s_waitcnt lgkmcnt(0)
    v_mfma_f32_16x16x32_bf16 v[80:83], v[120:123], v[104:107], v[80:83]
    v_mfma_f32_16x16x32_bf16 v[84:87], v[120:123], v[108:111], v[84:87]
    v_mfma_f32_16x16x32_bf16 v[88:91], v[124:127], v[104:107], v[88:91]
    v_mfma_f32_16x16x32_bf16 v[92:95], v[124:127], v[108:111], v[92:95]
    s_waitcnt vmcnt(8)
    ds_write_b128 v147, v[136:139] offset:0
    ds_write_b128 v147, v[140:143] offset:4096
    ds_write_b128 v146, v[128:131] offset:0
    ds_write_b128 v146, v[132:135] offset:4096
    s_waitcnt lgkmcnt(0)
    s_mov_b32 s40, 458752
    buffer_load_dwordx4 v[136:139], v145, s[24:27], s40 offen
    s_mov_b32 s40, 491520
    buffer_load_dwordx4 v[140:143], v145, s[24:27], s40 offen
    s_mov_b32 s40, 6291456
    buffer_load_dwordx4 v[128:131], v144, s[16:19], s40 offen offset:896
    s_mov_b32 s40, 6406144
    buffer_load_dwordx4 v[132:135], v144, s[16:19], s40 offen offset:896
    s_barrier
    ds_read_b128 v[96:99], v156 offset:0
    ds_read_b128 v[100:103], v156 offset:2048
    ds_read_b64_tr_b16 v[112:113], v150 offset:0
    ds_read_b64_tr_b16 v[114:115], v150 offset:512
    ds_read_b64_tr_b16 v[116:117], v151 offset:0
    ds_read_b64_tr_b16 v[118:119], v151 offset:512
    ds_read_b128 v[104:107], v157 offset:0
    ds_read_b128 v[108:111], v157 offset:2048
    ds_read_b64_tr_b16 v[120:121], v150 offset:4096
    ds_read_b64_tr_b16 v[122:123], v150 offset:4608
    ds_read_b64_tr_b16 v[124:125], v151 offset:4096
    ds_read_b64_tr_b16 v[126:127], v151 offset:4608
    s_waitcnt lgkmcnt(6)
    v_mfma_f32_16x16x32_bf16 v[80:83], v[112:115], v[96:99], v[80:83]
    v_mfma_f32_16x16x32_bf16 v[84:87], v[112:115], v[100:103], v[84:87]
    v_mfma_f32_16x16x32_bf16 v[88:91], v[116:119], v[96:99], v[88:91]
    v_mfma_f32_16x16x32_bf16 v[92:95], v[116:119], v[100:103], v[92:95]
    s_waitcnt lgkmcnt(0)
    v_mfma_f32_16x16x32_bf16 v[80:83], v[120:123], v[104:107], v[80:83]
    v_mfma_f32_16x16x32_bf16 v[84:87], v[120:123], v[108:111], v[84:87]
    v_mfma_f32_16x16x32_bf16 v[88:91], v[124:127], v[104:107], v[88:91]
    v_mfma_f32_16x16x32_bf16 v[92:95], v[124:127], v[108:111], v[92:95]
    s_waitcnt vmcnt(8)
    ds_write_b128 v147, v[168:171] offset:8192
    ds_write_b128 v147, v[172:175] offset:12288
    ds_write_b128 v146, v[160:163] offset:8192
    ds_write_b128 v146, v[164:167] offset:12288
    s_waitcnt lgkmcnt(0)
    s_mov_b32 s40, 524288
    buffer_load_dwordx4 v[168:171], v145, s[24:27], s40 offen
    s_mov_b32 s40, 557056
    buffer_load_dwordx4 v[172:175], v145, s[24:27], s40 offen
    s_mov_b32 s40, 6291456
    buffer_load_dwordx4 v[160:163], v144, s[16:19], s40 offen offset:1024
    s_mov_b32 s40, 6406144
    buffer_load_dwordx4 v[164:167], v144, s[16:19], s40 offen offset:1024
    s_barrier
    ds_read_b128 v[96:99], v156 offset:8192
    ds_read_b128 v[100:103], v156 offset:10240
    ds_read_b64_tr_b16 v[112:113], v150 offset:8192
    ds_read_b64_tr_b16 v[114:115], v150 offset:8704
    ds_read_b64_tr_b16 v[116:117], v151 offset:8192
    ds_read_b64_tr_b16 v[118:119], v151 offset:8704
    ds_read_b128 v[104:107], v157 offset:8192
    ds_read_b128 v[108:111], v157 offset:10240
    ds_read_b64_tr_b16 v[120:121], v150 offset:12288
    ds_read_b64_tr_b16 v[122:123], v150 offset:12800
    ds_read_b64_tr_b16 v[124:125], v151 offset:12288
    ds_read_b64_tr_b16 v[126:127], v151 offset:12800
    s_waitcnt lgkmcnt(6)
    v_mfma_f32_16x16x32_bf16 v[80:83], v[112:115], v[96:99], v[80:83]
    v_mfma_f32_16x16x32_bf16 v[84:87], v[112:115], v[100:103], v[84:87]
    v_mfma_f32_16x16x32_bf16 v[88:91], v[116:119], v[96:99], v[88:91]
    v_mfma_f32_16x16x32_bf16 v[92:95], v[116:119], v[100:103], v[92:95]
    s_waitcnt lgkmcnt(0)
    v_mfma_f32_16x16x32_bf16 v[80:83], v[120:123], v[104:107], v[80:83]
    v_mfma_f32_16x16x32_bf16 v[84:87], v[120:123], v[108:111], v[84:87]
    v_mfma_f32_16x16x32_bf16 v[88:91], v[124:127], v[104:107], v[88:91]
    v_mfma_f32_16x16x32_bf16 v[92:95], v[124:127], v[108:111], v[92:95]
    s_waitcnt vmcnt(8)
    ds_write_b128 v147, v[184:187] offset:0
    ds_write_b128 v147, v[188:191] offset:4096
    ds_write_b128 v146, v[176:179] offset:0
    ds_write_b128 v146, v[180:183] offset:4096
    s_waitcnt lgkmcnt(0)
    s_mov_b32 s40, 589824
    buffer_load_dwordx4 v[184:187], v145, s[24:27], s40 offen
    s_mov_b32 s40, 622592
    buffer_load_dwordx4 v[188:191], v145, s[24:27], s40 offen
    s_mov_b32 s40, 6291456
    buffer_load_dwordx4 v[176:179], v144, s[16:19], s40 offen offset:1152
    s_mov_b32 s40, 6406144
    buffer_load_dwordx4 v[180:183], v144, s[16:19], s40 offen offset:1152
    s_barrier
    ds_read_b128 v[96:99], v156 offset:0
    ds_read_b128 v[100:103], v156 offset:2048
    ds_read_b64_tr_b16 v[112:113], v150 offset:0
    ds_read_b64_tr_b16 v[114:115], v150 offset:512
    ds_read_b64_tr_b16 v[116:117], v151 offset:0
    ds_read_b64_tr_b16 v[118:119], v151 offset:512
    ds_read_b128 v[104:107], v157 offset:0
    ds_read_b128 v[108:111], v157 offset:2048
    ds_read_b64_tr_b16 v[120:121], v150 offset:4096
    ds_read_b64_tr_b16 v[122:123], v150 offset:4608
    ds_read_b64_tr_b16 v[124:125], v151 offset:4096
    ds_read_b64_tr_b16 v[126:127], v151 offset:4608
    s_waitcnt lgkmcnt(6)
    v_mfma_f32_16x16x32_bf16 v[80:83], v[112:115], v[96:99], v[80:83]
    v_mfma_f32_16x16x32_bf16 v[84:87], v[112:115], v[100:103], v[84:87]
    v_mfma_f32_16x16x32_bf16 v[88:91], v[116:119], v[96:99], v[88:91]
    v_mfma_f32_16x16x32_bf16 v[92:95], v[116:119], v[100:103], v[92:95]
    s_waitcnt lgkmcnt(0)
    v_mfma_f32_16x16x32_bf16 v[80:83], v[120:123], v[104:107], v[80:83]
    v_mfma_f32_16x16x32_bf16 v[84:87], v[120:123], v[108:111], v[84:87]
    v_mfma_f32_16x16x32_bf16 v[88:91], v[124:127], v[104:107], v[88:91]
    v_mfma_f32_16x16x32_bf16 v[92:95], v[124:127], v[108:111], v[92:95]
    s_waitcnt vmcnt(8)
    ds_write_b128 v147, v[136:139] offset:8192
    ds_write_b128 v147, v[140:143] offset:12288
    ds_write_b128 v146, v[128:131] offset:8192
    ds_write_b128 v146, v[132:135] offset:12288
    s_waitcnt lgkmcnt(0)
    s_mov_b32 s40, 655360
    buffer_load_dwordx4 v[136:139], v145, s[24:27], s40 offen
    s_mov_b32 s40, 688128
    buffer_load_dwordx4 v[140:143], v145, s[24:27], s40 offen
    s_mov_b32 s40, 6291456
    buffer_load_dwordx4 v[128:131], v144, s[16:19], s40 offen offset:1280
    s_mov_b32 s40, 6406144
    buffer_load_dwordx4 v[132:135], v144, s[16:19], s40 offen offset:1280
    s_barrier
    ds_read_b128 v[96:99], v156 offset:8192
    ds_read_b128 v[100:103], v156 offset:10240
    ds_read_b64_tr_b16 v[112:113], v150 offset:8192
    ds_read_b64_tr_b16 v[114:115], v150 offset:8704
    ds_read_b64_tr_b16 v[116:117], v151 offset:8192
    ds_read_b64_tr_b16 v[118:119], v151 offset:8704
    ds_read_b128 v[104:107], v157 offset:8192
    ds_read_b128 v[108:111], v157 offset:10240
    ds_read_b64_tr_b16 v[120:121], v150 offset:12288
    ds_read_b64_tr_b16 v[122:123], v150 offset:12800
    ds_read_b64_tr_b16 v[124:125], v151 offset:12288
    ds_read_b64_tr_b16 v[126:127], v151 offset:12800
    s_waitcnt lgkmcnt(6)
    v_mfma_f32_16x16x32_bf16 v[80:83], v[112:115], v[96:99], v[80:83]
    v_mfma_f32_16x16x32_bf16 v[84:87], v[112:115], v[100:103], v[84:87]
    v_mfma_f32_16x16x32_bf16 v[88:91], v[116:119], v[96:99], v[88:91]
    v_mfma_f32_16x16x32_bf16 v[92:95], v[116:119], v[100:103], v[92:95]
    s_waitcnt lgkmcnt(0)
    v_mfma_f32_16x16x32_bf16 v[80:83], v[120:123], v[104:107], v[80:83]
    v_mfma_f32_16x16x32_bf16 v[84:87], v[120:123], v[108:111], v[84:87]
    v_mfma_f32_16x16x32_bf16 v[88:91], v[124:127], v[104:107], v[88:91]
    v_mfma_f32_16x16x32_bf16 v[92:95], v[124:127], v[108:111], v[92:95]
    s_waitcnt vmcnt(8)
    ds_write_b128 v147, v[168:171] offset:0
    ds_write_b128 v147, v[172:175] offset:4096
    ds_write_b128 v146, v[160:163] offset:0
    ds_write_b128 v146, v[164:167] offset:4096
    s_waitcnt lgkmcnt(0)
    s_mov_b32 s40, 720896
    buffer_load_dwordx4 v[168:171], v145, s[24:27], s40 offen
    s_mov_b32 s40, 753664
    buffer_load_dwordx4 v[172:175], v145, s[24:27], s40 offen
    s_mov_b32 s40, 6291456
    buffer_load_dwordx4 v[160:163], v144, s[16:19], s40 offen offset:1408
    s_mov_b32 s40, 6406144
    buffer_load_dwordx4 v[164:167], v144, s[16:19], s40 offen offset:1408
    s_barrier
    ds_read_b128 v[96:99], v156 offset:0
    ds_read_b128 v[100:103], v156 offset:2048
    ds_read_b64_tr_b16 v[112:113], v150 offset:0
    ds_read_b64_tr_b16 v[114:115], v150 offset:512
    ds_read_b64_tr_b16 v[116:117], v151 offset:0
    ds_read_b64_tr_b16 v[118:119], v151 offset:512
    ds_read_b128 v[104:107], v157 offset:0
    ds_read_b128 v[108:111], v157 offset:2048
    ds_read_b64_tr_b16 v[120:121], v150 offset:4096
    ds_read_b64_tr_b16 v[122:123], v150 offset:4608
    ds_read_b64_tr_b16 v[124:125], v151 offset:4096
    ds_read_b64_tr_b16 v[126:127], v151 offset:4608
    s_waitcnt lgkmcnt(6)
    v_mfma_f32_16x16x32_bf16 v[80:83], v[112:115], v[96:99], v[80:83]
    v_mfma_f32_16x16x32_bf16 v[84:87], v[112:115], v[100:103], v[84:87]
    v_mfma_f32_16x16x32_bf16 v[88:91], v[116:119], v[96:99], v[88:91]
    v_mfma_f32_16x16x32_bf16 v[92:95], v[116:119], v[100:103], v[92:95]
    s_waitcnt lgkmcnt(0)
    v_mfma_f32_16x16x32_bf16 v[80:83], v[120:123], v[104:107], v[80:83]
    v_mfma_f32_16x16x32_bf16 v[84:87], v[120:123], v[108:111], v[84:87]
    v_mfma_f32_16x16x32_bf16 v[88:91], v[124:127], v[104:107], v[88:91]
    v_mfma_f32_16x16x32_bf16 v[92:95], v[124:127], v[108:111], v[92:95]
    s_waitcnt vmcnt(8)
    ds_write_b128 v147, v[184:187] offset:8192
    ds_write_b128 v147, v[188:191] offset:12288
    ds_write_b128 v146, v[176:179] offset:8192
    ds_write_b128 v146, v[180:183] offset:12288
    s_waitcnt lgkmcnt(0)
    s_mov_b32 s40, 786432
    buffer_load_dwordx4 v[184:187], v145, s[24:27], s40 offen
    s_mov_b32 s40, 819200
    buffer_load_dwordx4 v[188:191], v145, s[24:27], s40 offen
    s_mov_b32 s40, 6291456
    buffer_load_dwordx4 v[176:179], v144, s[16:19], s40 offen offset:1536
    s_mov_b32 s40, 6406144
    buffer_load_dwordx4 v[180:183], v144, s[16:19], s40 offen offset:1536
    s_barrier
    ds_read_b128 v[96:99], v156 offset:8192
    ds_read_b128 v[100:103], v156 offset:10240
    ds_read_b64_tr_b16 v[112:113], v150 offset:8192
    ds_read_b64_tr_b16 v[114:115], v150 offset:8704
    ds_read_b64_tr_b16 v[116:117], v151 offset:8192
    ds_read_b64_tr_b16 v[118:119], v151 offset:8704
    ds_read_b128 v[104:107], v157 offset:8192
    ds_read_b128 v[108:111], v157 offset:10240
    ds_read_b64_tr_b16 v[120:121], v150 offset:12288
    ds_read_b64_tr_b16 v[122:123], v150 offset:12800
    ds_read_b64_tr_b16 v[124:125], v151 offset:12288
    ds_read_b64_tr_b16 v[126:127], v151 offset:12800
    s_waitcnt lgkmcnt(6)
    v_mfma_f32_16x16x32_bf16 v[80:83], v[112:115], v[96:99], v[80:83]
    v_mfma_f32_16x16x32_bf16 v[84:87], v[112:115], v[100:103], v[84:87]
    v_mfma_f32_16x16x32_bf16 v[88:91], v[116:119], v[96:99], v[88:91]
    v_mfma_f32_16x16x32_bf16 v[92:95], v[116:119], v[100:103], v[92:95]
    s_waitcnt lgkmcnt(0)
    v_mfma_f32_16x16x32_bf16 v[80:83], v[120:123], v[104:107], v[80:83]
    v_mfma_f32_16x16x32_bf16 v[84:87], v[120:123], v[108:111], v[84:87]
    v_mfma_f32_16x16x32_bf16 v[88:91], v[124:127], v[104:107], v[88:91]
    v_mfma_f32_16x16x32_bf16 v[92:95], v[124:127], v[108:111], v[92:95]
    s_waitcnt vmcnt(8)
    ds_write_b128 v147, v[136:139] offset:0
    ds_write_b128 v147, v[140:143] offset:4096
    ds_write_b128 v146, v[128:131] offset:0
    ds_write_b128 v146, v[132:135] offset:4096
    s_waitcnt lgkmcnt(0)
    s_mov_b32 s40, 851968
    buffer_load_dwordx4 v[136:139], v145, s[24:27], s40 offen
    s_mov_b32 s40, 884736
    buffer_load_dwordx4 v[140:143], v145, s[24:27], s40 offen
    s_mov_b32 s40, 6291456
    buffer_load_dwordx4 v[128:131], v144, s[16:19], s40 offen offset:1664
    s_mov_b32 s40, 6406144
    buffer_load_dwordx4 v[132:135], v144, s[16:19], s40 offen offset:1664
    s_barrier
    ds_read_b128 v[96:99], v156 offset:0
    ds_read_b128 v[100:103], v156 offset:2048
    ds_read_b64_tr_b16 v[112:113], v150 offset:0
    ds_read_b64_tr_b16 v[114:115], v150 offset:512
    ds_read_b64_tr_b16 v[116:117], v151 offset:0
    ds_read_b64_tr_b16 v[118:119], v151 offset:512
    ds_read_b128 v[104:107], v157 offset:0
    ds_read_b128 v[108:111], v157 offset:2048
    ds_read_b64_tr_b16 v[120:121], v150 offset:4096
    ds_read_b64_tr_b16 v[122:123], v150 offset:4608
    ds_read_b64_tr_b16 v[124:125], v151 offset:4096
    ds_read_b64_tr_b16 v[126:127], v151 offset:4608
    s_waitcnt lgkmcnt(6)
    v_mfma_f32_16x16x32_bf16 v[80:83], v[112:115], v[96:99], v[80:83]
    v_mfma_f32_16x16x32_bf16 v[84:87], v[112:115], v[100:103], v[84:87]
    v_mfma_f32_16x16x32_bf16 v[88:91], v[116:119], v[96:99], v[88:91]
    v_mfma_f32_16x16x32_bf16 v[92:95], v[116:119], v[100:103], v[92:95]
    s_waitcnt lgkmcnt(0)
    v_mfma_f32_16x16x32_bf16 v[80:83], v[120:123], v[104:107], v[80:83]
    v_mfma_f32_16x16x32_bf16 v[84:87], v[120:123], v[108:111], v[84:87]
    v_mfma_f32_16x16x32_bf16 v[88:91], v[124:127], v[104:107], v[88:91]
    v_mfma_f32_16x16x32_bf16 v[92:95], v[124:127], v[108:111], v[92:95]
    s_waitcnt vmcnt(8)
    ds_write_b128 v147, v[168:171] offset:8192
    ds_write_b128 v147, v[172:175] offset:12288
    ds_write_b128 v146, v[160:163] offset:8192
    ds_write_b128 v146, v[164:167] offset:12288
    s_waitcnt lgkmcnt(0)
    s_mov_b32 s40, 917504
    buffer_load_dwordx4 v[168:171], v145, s[24:27], s40 offen
    s_mov_b32 s40, 950272
    buffer_load_dwordx4 v[172:175], v145, s[24:27], s40 offen
    s_mov_b32 s40, 6291456
    buffer_load_dwordx4 v[160:163], v144, s[16:19], s40 offen offset:1792
    s_mov_b32 s40, 6406144
    buffer_load_dwordx4 v[164:167], v144, s[16:19], s40 offen offset:1792
    s_barrier
    ds_read_b128 v[96:99], v156 offset:8192
    ds_read_b128 v[100:103], v156 offset:10240
    ds_read_b64_tr_b16 v[112:113], v150 offset:8192
    ds_read_b64_tr_b16 v[114:115], v150 offset:8704
    ds_read_b64_tr_b16 v[116:117], v151 offset:8192
    ds_read_b64_tr_b16 v[118:119], v151 offset:8704
    ds_read_b128 v[104:107], v157 offset:8192
    ds_read_b128 v[108:111], v157 offset:10240
    ds_read_b64_tr_b16 v[120:121], v150 offset:12288
    ds_read_b64_tr_b16 v[122:123], v150 offset:12800
    ds_read_b64_tr_b16 v[124:125], v151 offset:12288
    ds_read_b64_tr_b16 v[126:127], v151 offset:12800
    s_waitcnt lgkmcnt(6)
    v_mfma_f32_16x16x32_bf16 v[80:83], v[112:115], v[96:99], v[80:83]
    v_mfma_f32_16x16x32_bf16 v[84:87], v[112:115], v[100:103], v[84:87]
    v_mfma_f32_16x16x32_bf16 v[88:91], v[116:119], v[96:99], v[88:91]
    v_mfma_f32_16x16x32_bf16 v[92:95], v[116:119], v[100:103], v[92:95]
    s_waitcnt lgkmcnt(0)
    v_mfma_f32_16x16x32_bf16 v[80:83], v[120:123], v[104:107], v[80:83]
    v_mfma_f32_16x16x32_bf16 v[84:87], v[120:123], v[108:111], v[84:87]
    v_mfma_f32_16x16x32_bf16 v[88:91], v[124:127], v[104:107], v[88:91]
    v_mfma_f32_16x16x32_bf16 v[92:95], v[124:127], v[108:111], v[92:95]
    s_waitcnt vmcnt(8)
    ds_write_b128 v147, v[184:187] offset:0
    ds_write_b128 v147, v[188:191] offset:4096
    ds_write_b128 v146, v[176:179] offset:0
    ds_write_b128 v146, v[180:183] offset:4096
    s_waitcnt lgkmcnt(0)
    s_mov_b32 s40, 983040
    buffer_load_dwordx4 v[184:187], v145, s[24:27], s40 offen
    s_mov_b32 s40, 1015808
    buffer_load_dwordx4 v[188:191], v145, s[24:27], s40 offen
    s_mov_b32 s40, 6291456
    buffer_load_dwordx4 v[176:179], v144, s[16:19], s40 offen offset:1920
    s_mov_b32 s40, 6406144
    buffer_load_dwordx4 v[180:183], v144, s[16:19], s40 offen offset:1920
    s_barrier
    ds_read_b128 v[96:99], v156 offset:0
    ds_read_b128 v[100:103], v156 offset:2048
    ds_read_b64_tr_b16 v[112:113], v150 offset:0
    ds_read_b64_tr_b16 v[114:115], v150 offset:512
    ds_read_b64_tr_b16 v[116:117], v151 offset:0
    ds_read_b64_tr_b16 v[118:119], v151 offset:512
    ds_read_b128 v[104:107], v157 offset:0
    ds_read_b128 v[108:111], v157 offset:2048
    ds_read_b64_tr_b16 v[120:121], v150 offset:4096
    ds_read_b64_tr_b16 v[122:123], v150 offset:4608
    ds_read_b64_tr_b16 v[124:125], v151 offset:4096
    ds_read_b64_tr_b16 v[126:127], v151 offset:4608
    s_waitcnt lgkmcnt(6)
    v_mfma_f32_16x16x32_bf16 v[80:83], v[112:115], v[96:99], v[80:83]
    v_mfma_f32_16x16x32_bf16 v[84:87], v[112:115], v[100:103], v[84:87]
    v_mfma_f32_16x16x32_bf16 v[88:91], v[116:119], v[96:99], v[88:91]
    v_mfma_f32_16x16x32_bf16 v[92:95], v[116:119], v[100:103], v[92:95]
    s_waitcnt lgkmcnt(0)
    v_mfma_f32_16x16x32_bf16 v[80:83], v[120:123], v[104:107], v[80:83]
    v_mfma_f32_16x16x32_bf16 v[84:87], v[120:123], v[108:111], v[84:87]
    v_mfma_f32_16x16x32_bf16 v[88:91], v[124:127], v[104:107], v[88:91]
    v_mfma_f32_16x16x32_bf16 v[92:95], v[124:127], v[108:111], v[92:95]
    s_waitcnt vmcnt(8)
    ds_write_b128 v147, v[136:139] offset:8192
    ds_write_b128 v147, v[140:143] offset:12288
    ds_write_b128 v146, v[128:131] offset:8192
    ds_write_b128 v146, v[132:135] offset:12288
    s_waitcnt lgkmcnt(0)
    s_mov_b32 s40, 1048576
    buffer_load_dwordx4 v[136:139], v145, s[24:27], s40 offen
    s_mov_b32 s40, 1081344
    buffer_load_dwordx4 v[140:143], v145, s[24:27], s40 offen
    s_mov_b32 s40, 6291456
    buffer_load_dwordx4 v[128:131], v144, s[16:19], s40 offen offset:2048
    s_mov_b32 s40, 6406144
    buffer_load_dwordx4 v[132:135], v144, s[16:19], s40 offen offset:2048
    s_barrier
    ds_read_b128 v[96:99], v156 offset:8192
    ds_read_b128 v[100:103], v156 offset:10240
    ds_read_b64_tr_b16 v[112:113], v150 offset:8192
    ds_read_b64_tr_b16 v[114:115], v150 offset:8704
    ds_read_b64_tr_b16 v[116:117], v151 offset:8192
    ds_read_b64_tr_b16 v[118:119], v151 offset:8704
    ds_read_b128 v[104:107], v157 offset:8192
    ds_read_b128 v[108:111], v157 offset:10240
    ds_read_b64_tr_b16 v[120:121], v150 offset:12288
    ds_read_b64_tr_b16 v[122:123], v150 offset:12800
    ds_read_b64_tr_b16 v[124:125], v151 offset:12288
    ds_read_b64_tr_b16 v[126:127], v151 offset:12800
    s_waitcnt lgkmcnt(6)
    v_mfma_f32_16x16x32_bf16 v[80:83], v[112:115], v[96:99], v[80:83]
    v_mfma_f32_16x16x32_bf16 v[84:87], v[112:115], v[100:103], v[84:87]
    v_mfma_f32_16x16x32_bf16 v[88:91], v[116:119], v[96:99], v[88:91]
    v_mfma_f32_16x16x32_bf16 v[92:95], v[116:119], v[100:103], v[92:95]
    s_waitcnt lgkmcnt(0)
    v_mfma_f32_16x16x32_bf16 v[80:83], v[120:123], v[104:107], v[80:83]
    v_mfma_f32_16x16x32_bf16 v[84:87], v[120:123], v[108:111], v[84:87]
    v_mfma_f32_16x16x32_bf16 v[88:91], v[124:127], v[104:107], v[88:91]
    v_mfma_f32_16x16x32_bf16 v[92:95], v[124:127], v[108:111], v[92:95]
    s_waitcnt vmcnt(8)
    ds_write_b128 v147, v[168:171] offset:0
    ds_write_b128 v147, v[172:175] offset:4096
    ds_write_b128 v146, v[160:163] offset:0
    ds_write_b128 v146, v[164:167] offset:4096
    s_waitcnt lgkmcnt(0)
    s_mov_b32 s40, 1114112
    buffer_load_dwordx4 v[168:171], v145, s[24:27], s40 offen
    s_mov_b32 s40, 1146880
    buffer_load_dwordx4 v[172:175], v145, s[24:27], s40 offen
    s_mov_b32 s40, 6291456
    buffer_load_dwordx4 v[160:163], v144, s[16:19], s40 offen offset:2176
    s_mov_b32 s40, 6406144
    buffer_load_dwordx4 v[164:167], v144, s[16:19], s40 offen offset:2176
    s_barrier
    ds_read_b128 v[96:99], v156 offset:0
    ds_read_b128 v[100:103], v156 offset:2048
    ds_read_b64_tr_b16 v[112:113], v150 offset:0
    ds_read_b64_tr_b16 v[114:115], v150 offset:512
    ds_read_b64_tr_b16 v[116:117], v151 offset:0
    ds_read_b64_tr_b16 v[118:119], v151 offset:512
    ds_read_b128 v[104:107], v157 offset:0
    ds_read_b128 v[108:111], v157 offset:2048
    ds_read_b64_tr_b16 v[120:121], v150 offset:4096
    ds_read_b64_tr_b16 v[122:123], v150 offset:4608
    ds_read_b64_tr_b16 v[124:125], v151 offset:4096
    ds_read_b64_tr_b16 v[126:127], v151 offset:4608
    s_waitcnt lgkmcnt(6)
    v_mfma_f32_16x16x32_bf16 v[80:83], v[112:115], v[96:99], v[80:83]
    v_mfma_f32_16x16x32_bf16 v[84:87], v[112:115], v[100:103], v[84:87]
    v_mfma_f32_16x16x32_bf16 v[88:91], v[116:119], v[96:99], v[88:91]
    v_mfma_f32_16x16x32_bf16 v[92:95], v[116:119], v[100:103], v[92:95]
    s_waitcnt lgkmcnt(0)
    v_mfma_f32_16x16x32_bf16 v[80:83], v[120:123], v[104:107], v[80:83]
    v_mfma_f32_16x16x32_bf16 v[84:87], v[120:123], v[108:111], v[84:87]
    v_mfma_f32_16x16x32_bf16 v[88:91], v[124:127], v[104:107], v[88:91]
    v_mfma_f32_16x16x32_bf16 v[92:95], v[124:127], v[108:111], v[92:95]
    s_waitcnt vmcnt(8)
    ds_write_b128 v147, v[184:187] offset:8192
    ds_write_b128 v147, v[188:191] offset:12288
    ds_write_b128 v146, v[176:179] offset:8192
    ds_write_b128 v146, v[180:183] offset:12288
    s_waitcnt lgkmcnt(0)
    s_mov_b32 s40, 1179648
    buffer_load_dwordx4 v[184:187], v145, s[24:27], s40 offen
    s_mov_b32 s40, 1212416
    buffer_load_dwordx4 v[188:191], v145, s[24:27], s40 offen
    s_mov_b32 s40, 6291456
    buffer_load_dwordx4 v[176:179], v144, s[16:19], s40 offen offset:2304
    s_mov_b32 s40, 6406144
    buffer_load_dwordx4 v[180:183], v144, s[16:19], s40 offen offset:2304
    s_barrier
    ds_read_b128 v[96:99], v156 offset:8192
    ds_read_b128 v[100:103], v156 offset:10240
    ds_read_b64_tr_b16 v[112:113], v150 offset:8192
    ds_read_b64_tr_b16 v[114:115], v150 offset:8704
    ds_read_b64_tr_b16 v[116:117], v151 offset:8192
    ds_read_b64_tr_b16 v[118:119], v151 offset:8704
    ds_read_b128 v[104:107], v157 offset:8192
    ds_read_b128 v[108:111], v157 offset:10240
    ds_read_b64_tr_b16 v[120:121], v150 offset:12288
    ds_read_b64_tr_b16 v[122:123], v150 offset:12800
    ds_read_b64_tr_b16 v[124:125], v151 offset:12288
    ds_read_b64_tr_b16 v[126:127], v151 offset:12800
    s_waitcnt lgkmcnt(6)
    v_mfma_f32_16x16x32_bf16 v[80:83], v[112:115], v[96:99], v[80:83]
    v_mfma_f32_16x16x32_bf16 v[84:87], v[112:115], v[100:103], v[84:87]
    v_mfma_f32_16x16x32_bf16 v[88:91], v[116:119], v[96:99], v[88:91]
    v_mfma_f32_16x16x32_bf16 v[92:95], v[116:119], v[100:103], v[92:95]
    s_waitcnt lgkmcnt(0)
    v_mfma_f32_16x16x32_bf16 v[80:83], v[120:123], v[104:107], v[80:83]
    v_mfma_f32_16x16x32_bf16 v[84:87], v[120:123], v[108:111], v[84:87]
    v_mfma_f32_16x16x32_bf16 v[88:91], v[124:127], v[104:107], v[88:91]
    v_mfma_f32_16x16x32_bf16 v[92:95], v[124:127], v[108:111], v[92:95]
    s_waitcnt vmcnt(8)
    ds_write_b128 v147, v[136:139] offset:0
    ds_write_b128 v147, v[140:143] offset:4096
    ds_write_b128 v146, v[128:131] offset:0
    ds_write_b128 v146, v[132:135] offset:4096
    s_waitcnt lgkmcnt(0)
    s_mov_b32 s40, 1245184
    buffer_load_dwordx4 v[136:139], v145, s[24:27], s40 offen
    s_mov_b32 s40, 1277952
    buffer_load_dwordx4 v[140:143], v145, s[24:27], s40 offen
    s_mov_b32 s40, 6291456
    buffer_load_dwordx4 v[128:131], v144, s[16:19], s40 offen offset:2432
    s_mov_b32 s40, 6406144
    buffer_load_dwordx4 v[132:135], v144, s[16:19], s40 offen offset:2432
    s_barrier
    ds_read_b128 v[96:99], v156 offset:0
    ds_read_b128 v[100:103], v156 offset:2048
    ds_read_b64_tr_b16 v[112:113], v150 offset:0
    ds_read_b64_tr_b16 v[114:115], v150 offset:512
    ds_read_b64_tr_b16 v[116:117], v151 offset:0
    ds_read_b64_tr_b16 v[118:119], v151 offset:512
    ds_read_b128 v[104:107], v157 offset:0
    ds_read_b128 v[108:111], v157 offset:2048
    ds_read_b64_tr_b16 v[120:121], v150 offset:4096
    ds_read_b64_tr_b16 v[122:123], v150 offset:4608
    ds_read_b64_tr_b16 v[124:125], v151 offset:4096
    ds_read_b64_tr_b16 v[126:127], v151 offset:4608
    s_waitcnt lgkmcnt(6)
    v_mfma_f32_16x16x32_bf16 v[80:83], v[112:115], v[96:99], v[80:83]
    v_mfma_f32_16x16x32_bf16 v[84:87], v[112:115], v[100:103], v[84:87]
    v_mfma_f32_16x16x32_bf16 v[88:91], v[116:119], v[96:99], v[88:91]
    v_mfma_f32_16x16x32_bf16 v[92:95], v[116:119], v[100:103], v[92:95]
    s_waitcnt lgkmcnt(0)
    v_mfma_f32_16x16x32_bf16 v[80:83], v[120:123], v[104:107], v[80:83]
    v_mfma_f32_16x16x32_bf16 v[84:87], v[120:123], v[108:111], v[84:87]
    v_mfma_f32_16x16x32_bf16 v[88:91], v[124:127], v[104:107], v[88:91]
    v_mfma_f32_16x16x32_bf16 v[92:95], v[124:127], v[108:111], v[92:95]
    s_waitcnt vmcnt(8)
    ds_write_b128 v147, v[168:171] offset:8192
    ds_write_b128 v147, v[172:175] offset:12288
    ds_write_b128 v146, v[160:163] offset:8192
    ds_write_b128 v146, v[164:167] offset:12288
    s_waitcnt lgkmcnt(0)
    s_mov_b32 s40, 1310720
    buffer_load_dwordx4 v[168:171], v145, s[24:27], s40 offen
    s_mov_b32 s40, 1343488
    buffer_load_dwordx4 v[172:175], v145, s[24:27], s40 offen
    s_mov_b32 s40, 6291456
    buffer_load_dwordx4 v[160:163], v144, s[16:19], s40 offen offset:2560
    s_mov_b32 s40, 6406144
    buffer_load_dwordx4 v[164:167], v144, s[16:19], s40 offen offset:2560
    s_barrier
    ds_read_b128 v[96:99], v156 offset:8192
    ds_read_b128 v[100:103], v156 offset:10240
    ds_read_b64_tr_b16 v[112:113], v150 offset:8192
    ds_read_b64_tr_b16 v[114:115], v150 offset:8704
    ds_read_b64_tr_b16 v[116:117], v151 offset:8192
    ds_read_b64_tr_b16 v[118:119], v151 offset:8704
    ds_read_b128 v[104:107], v157 offset:8192
    ds_read_b128 v[108:111], v157 offset:10240
    ds_read_b64_tr_b16 v[120:121], v150 offset:12288
    ds_read_b64_tr_b16 v[122:123], v150 offset:12800
    ds_read_b64_tr_b16 v[124:125], v151 offset:12288
    ds_read_b64_tr_b16 v[126:127], v151 offset:12800
    s_waitcnt lgkmcnt(6)
    v_mfma_f32_16x16x32_bf16 v[80:83], v[112:115], v[96:99], v[80:83]
    v_mfma_f32_16x16x32_bf16 v[84:87], v[112:115], v[100:103], v[84:87]
    v_mfma_f32_16x16x32_bf16 v[88:91], v[116:119], v[96:99], v[88:91]
    v_mfma_f32_16x16x32_bf16 v[92:95], v[116:119], v[100:103], v[92:95]
    s_waitcnt lgkmcnt(0)
    v_mfma_f32_16x16x32_bf16 v[80:83], v[120:123], v[104:107], v[80:83]
    v_mfma_f32_16x16x32_bf16 v[84:87], v[120:123], v[108:111], v[84:87]
    v_mfma_f32_16x16x32_bf16 v[88:91], v[124:127], v[104:107], v[88:91]
    v_mfma_f32_16x16x32_bf16 v[92:95], v[124:127], v[108:111], v[92:95]
    s_waitcnt vmcnt(8)
    ds_write_b128 v147, v[184:187] offset:0
    ds_write_b128 v147, v[188:191] offset:4096
    ds_write_b128 v146, v[176:179] offset:0
    ds_write_b128 v146, v[180:183] offset:4096
    s_waitcnt lgkmcnt(0)
    s_mov_b32 s40, 1376256
    buffer_load_dwordx4 v[184:187], v145, s[24:27], s40 offen
    s_mov_b32 s40, 1409024
    buffer_load_dwordx4 v[188:191], v145, s[24:27], s40 offen
    s_mov_b32 s40, 6291456
    buffer_load_dwordx4 v[176:179], v144, s[16:19], s40 offen offset:2688
    s_mov_b32 s40, 6406144
    buffer_load_dwordx4 v[180:183], v144, s[16:19], s40 offen offset:2688
    s_barrier
    ds_read_b128 v[96:99], v156 offset:0
    ds_read_b128 v[100:103], v156 offset:2048
    ds_read_b64_tr_b16 v[112:113], v150 offset:0
    ds_read_b64_tr_b16 v[114:115], v150 offset:512
    ds_read_b64_tr_b16 v[116:117], v151 offset:0
    ds_read_b64_tr_b16 v[118:119], v151 offset:512
    ds_read_b128 v[104:107], v157 offset:0
    ds_read_b128 v[108:111], v157 offset:2048
    ds_read_b64_tr_b16 v[120:121], v150 offset:4096
    ds_read_b64_tr_b16 v[122:123], v150 offset:4608
    ds_read_b64_tr_b16 v[124:125], v151 offset:4096
    ds_read_b64_tr_b16 v[126:127], v151 offset:4608
    s_waitcnt lgkmcnt(6)
    v_mfma_f32_16x16x32_bf16 v[80:83], v[112:115], v[96:99], v[80:83]
    v_mfma_f32_16x16x32_bf16 v[84:87], v[112:115], v[100:103], v[84:87]
    v_mfma_f32_16x16x32_bf16 v[88:91], v[116:119], v[96:99], v[88:91]
    v_mfma_f32_16x16x32_bf16 v[92:95], v[116:119], v[100:103], v[92:95]
    s_waitcnt lgkmcnt(0)
    v_mfma_f32_16x16x32_bf16 v[80:83], v[120:123], v[104:107], v[80:83]
    v_mfma_f32_16x16x32_bf16 v[84:87], v[120:123], v[108:111], v[84:87]
    v_mfma_f32_16x16x32_bf16 v[88:91], v[124:127], v[104:107], v[88:91]
    v_mfma_f32_16x16x32_bf16 v[92:95], v[124:127], v[108:111], v[92:95]
    s_waitcnt vmcnt(8)
    ds_write_b128 v147, v[136:139] offset:8192
    ds_write_b128 v147, v[140:143] offset:12288
    ds_write_b128 v146, v[128:131] offset:8192
    ds_write_b128 v146, v[132:135] offset:12288
    s_waitcnt lgkmcnt(0)
    s_mov_b32 s40, 1441792
    buffer_load_dwordx4 v[136:139], v145, s[24:27], s40 offen
    s_mov_b32 s40, 1474560
    buffer_load_dwordx4 v[140:143], v145, s[24:27], s40 offen
    s_mov_b32 s40, 6291456
    buffer_load_dwordx4 v[128:131], v144, s[16:19], s40 offen offset:2816
    s_mov_b32 s40, 6406144
    buffer_load_dwordx4 v[132:135], v144, s[16:19], s40 offen offset:2816
    s_barrier
    ds_read_b128 v[96:99], v156 offset:8192
    ds_read_b128 v[100:103], v156 offset:10240
    ds_read_b64_tr_b16 v[112:113], v150 offset:8192
    ds_read_b64_tr_b16 v[114:115], v150 offset:8704
    ds_read_b64_tr_b16 v[116:117], v151 offset:8192
    ds_read_b64_tr_b16 v[118:119], v151 offset:8704
    ds_read_b128 v[104:107], v157 offset:8192
    ds_read_b128 v[108:111], v157 offset:10240
    ds_read_b64_tr_b16 v[120:121], v150 offset:12288
    ds_read_b64_tr_b16 v[122:123], v150 offset:12800
    ds_read_b64_tr_b16 v[124:125], v151 offset:12288
    ds_read_b64_tr_b16 v[126:127], v151 offset:12800
    s_waitcnt lgkmcnt(6)
    v_mfma_f32_16x16x32_bf16 v[80:83], v[112:115], v[96:99], v[80:83]
    v_mfma_f32_16x16x32_bf16 v[84:87], v[112:115], v[100:103], v[84:87]
    v_mfma_f32_16x16x32_bf16 v[88:91], v[116:119], v[96:99], v[88:91]
    v_mfma_f32_16x16x32_bf16 v[92:95], v[116:119], v[100:103], v[92:95]
    s_waitcnt lgkmcnt(0)
    v_mfma_f32_16x16x32_bf16 v[80:83], v[120:123], v[104:107], v[80:83]
    v_mfma_f32_16x16x32_bf16 v[84:87], v[120:123], v[108:111], v[84:87]
    v_mfma_f32_16x16x32_bf16 v[88:91], v[124:127], v[104:107], v[88:91]
    v_mfma_f32_16x16x32_bf16 v[92:95], v[124:127], v[108:111], v[92:95]
    s_waitcnt vmcnt(8)
    ds_write_b128 v147, v[168:171] offset:0
    ds_write_b128 v147, v[172:175] offset:4096
    ds_write_b128 v146, v[160:163] offset:0
    ds_write_b128 v146, v[164:167] offset:4096
    s_waitcnt lgkmcnt(0)
    s_mov_b32 s40, 1507328
    buffer_load_dwordx4 v[168:171], v145, s[24:27], s40 offen
    s_mov_b32 s40, 1540096
    buffer_load_dwordx4 v[172:175], v145, s[24:27], s40 offen
    s_mov_b32 s40, 6291456
    buffer_load_dwordx4 v[160:163], v144, s[16:19], s40 offen offset:2944
    s_mov_b32 s40, 6406144
    buffer_load_dwordx4 v[164:167], v144, s[16:19], s40 offen offset:2944
    s_barrier
    ds_read_b128 v[96:99], v156 offset:0
    ds_read_b128 v[100:103], v156 offset:2048
    ds_read_b64_tr_b16 v[112:113], v150 offset:0
    ds_read_b64_tr_b16 v[114:115], v150 offset:512
    ds_read_b64_tr_b16 v[116:117], v151 offset:0
    ds_read_b64_tr_b16 v[118:119], v151 offset:512
    ds_read_b128 v[104:107], v157 offset:0
    ds_read_b128 v[108:111], v157 offset:2048
    ds_read_b64_tr_b16 v[120:121], v150 offset:4096
    ds_read_b64_tr_b16 v[122:123], v150 offset:4608
    ds_read_b64_tr_b16 v[124:125], v151 offset:4096
    ds_read_b64_tr_b16 v[126:127], v151 offset:4608
    s_waitcnt lgkmcnt(6)
    v_mfma_f32_16x16x32_bf16 v[80:83], v[112:115], v[96:99], v[80:83]
    v_mfma_f32_16x16x32_bf16 v[84:87], v[112:115], v[100:103], v[84:87]
    v_mfma_f32_16x16x32_bf16 v[88:91], v[116:119], v[96:99], v[88:91]
    v_mfma_f32_16x16x32_bf16 v[92:95], v[116:119], v[100:103], v[92:95]
    s_waitcnt lgkmcnt(0)
    v_mfma_f32_16x16x32_bf16 v[80:83], v[120:123], v[104:107], v[80:83]
    v_mfma_f32_16x16x32_bf16 v[84:87], v[120:123], v[108:111], v[84:87]
    v_mfma_f32_16x16x32_bf16 v[88:91], v[124:127], v[104:107], v[88:91]
    v_mfma_f32_16x16x32_bf16 v[92:95], v[124:127], v[108:111], v[92:95]
    s_waitcnt vmcnt(8)
    ds_write_b128 v147, v[184:187] offset:8192
    ds_write_b128 v147, v[188:191] offset:12288
    ds_write_b128 v146, v[176:179] offset:8192
    ds_write_b128 v146, v[180:183] offset:12288
    s_waitcnt lgkmcnt(0)
    s_mov_b32 s40, 1572864
    buffer_load_dwordx4 v[184:187], v145, s[24:27], s40 offen
    s_mov_b32 s40, 1605632
    buffer_load_dwordx4 v[188:191], v145, s[24:27], s40 offen
    s_mov_b32 s40, 6291456
    buffer_load_dwordx4 v[176:179], v144, s[16:19], s40 offen offset:3072
    s_mov_b32 s40, 6406144
    buffer_load_dwordx4 v[180:183], v144, s[16:19], s40 offen offset:3072
    s_barrier
    ds_read_b128 v[96:99], v156 offset:8192
    ds_read_b128 v[100:103], v156 offset:10240
    ds_read_b64_tr_b16 v[112:113], v150 offset:8192
    ds_read_b64_tr_b16 v[114:115], v150 offset:8704
    ds_read_b64_tr_b16 v[116:117], v151 offset:8192
    ds_read_b64_tr_b16 v[118:119], v151 offset:8704
    ds_read_b128 v[104:107], v157 offset:8192
    ds_read_b128 v[108:111], v157 offset:10240
    ds_read_b64_tr_b16 v[120:121], v150 offset:12288
    ds_read_b64_tr_b16 v[122:123], v150 offset:12800
    ds_read_b64_tr_b16 v[124:125], v151 offset:12288
    ds_read_b64_tr_b16 v[126:127], v151 offset:12800
    s_waitcnt lgkmcnt(6)
    v_mfma_f32_16x16x32_bf16 v[80:83], v[112:115], v[96:99], v[80:83]
    v_mfma_f32_16x16x32_bf16 v[84:87], v[112:115], v[100:103], v[84:87]
    v_mfma_f32_16x16x32_bf16 v[88:91], v[116:119], v[96:99], v[88:91]
    v_mfma_f32_16x16x32_bf16 v[92:95], v[116:119], v[100:103], v[92:95]
    s_waitcnt lgkmcnt(0)
    v_mfma_f32_16x16x32_bf16 v[80:83], v[120:123], v[104:107], v[80:83]
    v_mfma_f32_16x16x32_bf16 v[84:87], v[120:123], v[108:111], v[84:87]
    v_mfma_f32_16x16x32_bf16 v[88:91], v[124:127], v[104:107], v[88:91]
    v_mfma_f32_16x16x32_bf16 v[92:95], v[124:127], v[108:111], v[92:95]
    s_waitcnt vmcnt(8)
    ds_write_b128 v147, v[136:139] offset:0
    ds_write_b128 v147, v[140:143] offset:4096
    ds_write_b128 v146, v[128:131] offset:0
    ds_write_b128 v146, v[132:135] offset:4096
    s_waitcnt lgkmcnt(0)
    s_mov_b32 s40, 1638400
    buffer_load_dwordx4 v[136:139], v145, s[24:27], s40 offen
    s_mov_b32 s40, 1671168
    buffer_load_dwordx4 v[140:143], v145, s[24:27], s40 offen
    s_mov_b32 s40, 6291456
    buffer_load_dwordx4 v[128:131], v144, s[16:19], s40 offen offset:3200
    s_mov_b32 s40, 6406144
    buffer_load_dwordx4 v[132:135], v144, s[16:19], s40 offen offset:3200
    s_barrier
    ds_read_b128 v[96:99], v156 offset:0
    ds_read_b128 v[100:103], v156 offset:2048
    ds_read_b64_tr_b16 v[112:113], v150 offset:0
    ds_read_b64_tr_b16 v[114:115], v150 offset:512
    ds_read_b64_tr_b16 v[116:117], v151 offset:0
    ds_read_b64_tr_b16 v[118:119], v151 offset:512
    ds_read_b128 v[104:107], v157 offset:0
    ds_read_b128 v[108:111], v157 offset:2048
    ds_read_b64_tr_b16 v[120:121], v150 offset:4096
    ds_read_b64_tr_b16 v[122:123], v150 offset:4608
    ds_read_b64_tr_b16 v[124:125], v151 offset:4096
    ds_read_b64_tr_b16 v[126:127], v151 offset:4608
    s_waitcnt lgkmcnt(6)
    v_mfma_f32_16x16x32_bf16 v[80:83], v[112:115], v[96:99], v[80:83]
    v_mfma_f32_16x16x32_bf16 v[84:87], v[112:115], v[100:103], v[84:87]
    v_mfma_f32_16x16x32_bf16 v[88:91], v[116:119], v[96:99], v[88:91]
    v_mfma_f32_16x16x32_bf16 v[92:95], v[116:119], v[100:103], v[92:95]
    s_waitcnt lgkmcnt(0)
    v_mfma_f32_16x16x32_bf16 v[80:83], v[120:123], v[104:107], v[80:83]
    v_mfma_f32_16x16x32_bf16 v[84:87], v[120:123], v[108:111], v[84:87]
    v_mfma_f32_16x16x32_bf16 v[88:91], v[124:127], v[104:107], v[88:91]
    v_mfma_f32_16x16x32_bf16 v[92:95], v[124:127], v[108:111], v[92:95]
    s_waitcnt vmcnt(8)
    ds_write_b128 v147, v[168:171] offset:8192
    ds_write_b128 v147, v[172:175] offset:12288
    ds_write_b128 v146, v[160:163] offset:8192
    ds_write_b128 v146, v[164:167] offset:12288
    s_waitcnt lgkmcnt(0)
    s_mov_b32 s40, 1703936
    buffer_load_dwordx4 v[168:171], v145, s[24:27], s40 offen
    s_mov_b32 s40, 1736704
    buffer_load_dwordx4 v[172:175], v145, s[24:27], s40 offen
    s_mov_b32 s40, 6291456
    buffer_load_dwordx4 v[160:163], v144, s[16:19], s40 offen offset:3328
    s_mov_b32 s40, 6406144
    buffer_load_dwordx4 v[164:167], v144, s[16:19], s40 offen offset:3328
    s_barrier
    ds_read_b128 v[96:99], v156 offset:8192
    ds_read_b128 v[100:103], v156 offset:10240
    ds_read_b64_tr_b16 v[112:113], v150 offset:8192
    ds_read_b64_tr_b16 v[114:115], v150 offset:8704
    ds_read_b64_tr_b16 v[116:117], v151 offset:8192
    ds_read_b64_tr_b16 v[118:119], v151 offset:8704
    ds_read_b128 v[104:107], v157 offset:8192
    ds_read_b128 v[108:111], v157 offset:10240
    ds_read_b64_tr_b16 v[120:121], v150 offset:12288
    ds_read_b64_tr_b16 v[122:123], v150 offset:12800
    ds_read_b64_tr_b16 v[124:125], v151 offset:12288
    ds_read_b64_tr_b16 v[126:127], v151 offset:12800
    s_waitcnt lgkmcnt(6)
    v_mfma_f32_16x16x32_bf16 v[80:83], v[112:115], v[96:99], v[80:83]
    v_mfma_f32_16x16x32_bf16 v[84:87], v[112:115], v[100:103], v[84:87]
    v_mfma_f32_16x16x32_bf16 v[88:91], v[116:119], v[96:99], v[88:91]
    v_mfma_f32_16x16x32_bf16 v[92:95], v[116:119], v[100:103], v[92:95]
    s_waitcnt lgkmcnt(0)
    v_mfma_f32_16x16x32_bf16 v[80:83], v[120:123], v[104:107], v[80:83]
    v_mfma_f32_16x16x32_bf16 v[84:87], v[120:123], v[108:111], v[84:87]
    v_mfma_f32_16x16x32_bf16 v[88:91], v[124:127], v[104:107], v[88:91]
    v_mfma_f32_16x16x32_bf16 v[92:95], v[124:127], v[108:111], v[92:95]
    s_waitcnt vmcnt(8)
    ds_write_b128 v147, v[184:187] offset:0
    ds_write_b128 v147, v[188:191] offset:4096
    ds_write_b128 v146, v[176:179] offset:0
    ds_write_b128 v146, v[180:183] offset:4096
    s_waitcnt lgkmcnt(0)
    s_mov_b32 s40, 1769472
    buffer_load_dwordx4 v[184:187], v145, s[24:27], s40 offen
    s_mov_b32 s40, 1802240
    buffer_load_dwordx4 v[188:191], v145, s[24:27], s40 offen
    s_mov_b32 s40, 6291456
    buffer_load_dwordx4 v[176:179], v144, s[16:19], s40 offen offset:3456
    s_mov_b32 s40, 6406144
    buffer_load_dwordx4 v[180:183], v144, s[16:19], s40 offen offset:3456
    s_barrier
    ds_read_b128 v[96:99], v156 offset:0
    ds_read_b128 v[100:103], v156 offset:2048
    ds_read_b64_tr_b16 v[112:113], v150 offset:0
    ds_read_b64_tr_b16 v[114:115], v150 offset:512
    ds_read_b64_tr_b16 v[116:117], v151 offset:0
    ds_read_b64_tr_b16 v[118:119], v151 offset:512
    ds_read_b128 v[104:107], v157 offset:0
    ds_read_b128 v[108:111], v157 offset:2048
    ds_read_b64_tr_b16 v[120:121], v150 offset:4096
    ds_read_b64_tr_b16 v[122:123], v150 offset:4608
    ds_read_b64_tr_b16 v[124:125], v151 offset:4096
    ds_read_b64_tr_b16 v[126:127], v151 offset:4608
    s_waitcnt lgkmcnt(6)
    v_mfma_f32_16x16x32_bf16 v[80:83], v[112:115], v[96:99], v[80:83]
    v_mfma_f32_16x16x32_bf16 v[84:87], v[112:115], v[100:103], v[84:87]
    v_mfma_f32_16x16x32_bf16 v[88:91], v[116:119], v[96:99], v[88:91]
    v_mfma_f32_16x16x32_bf16 v[92:95], v[116:119], v[100:103], v[92:95]
    s_waitcnt lgkmcnt(0)
    v_mfma_f32_16x16x32_bf16 v[80:83], v[120:123], v[104:107], v[80:83]
    v_mfma_f32_16x16x32_bf16 v[84:87], v[120:123], v[108:111], v[84:87]
    v_mfma_f32_16x16x32_bf16 v[88:91], v[124:127], v[104:107], v[88:91]
    v_mfma_f32_16x16x32_bf16 v[92:95], v[124:127], v[108:111], v[92:95]
    s_waitcnt vmcnt(8)
    ds_write_b128 v147, v[136:139] offset:8192
    ds_write_b128 v147, v[140:143] offset:12288
    ds_write_b128 v146, v[128:131] offset:8192
    ds_write_b128 v146, v[132:135] offset:12288
    s_waitcnt lgkmcnt(0)
    s_barrier
    ds_read_b128 v[96:99], v156 offset:8192
    ds_read_b128 v[100:103], v156 offset:10240
    ds_read_b64_tr_b16 v[112:113], v150 offset:8192
    ds_read_b64_tr_b16 v[114:115], v150 offset:8704
    ds_read_b64_tr_b16 v[116:117], v151 offset:8192
    ds_read_b64_tr_b16 v[118:119], v151 offset:8704
    ds_read_b128 v[104:107], v157 offset:8192
    ds_read_b128 v[108:111], v157 offset:10240
    ds_read_b64_tr_b16 v[120:121], v150 offset:12288
    ds_read_b64_tr_b16 v[122:123], v150 offset:12800
    ds_read_b64_tr_b16 v[124:125], v151 offset:12288
    ds_read_b64_tr_b16 v[126:127], v151 offset:12800
    s_waitcnt lgkmcnt(6)
    v_mfma_f32_16x16x32_bf16 v[80:83], v[112:115], v[96:99], v[80:83]
    v_mfma_f32_16x16x32_bf16 v[84:87], v[112:115], v[100:103], v[84:87]
    v_mfma_f32_16x16x32_bf16 v[88:91], v[116:119], v[96:99], v[88:91]
    v_mfma_f32_16x16x32_bf16 v[92:95], v[116:119], v[100:103], v[92:95]
    s_waitcnt lgkmcnt(0)
    v_mfma_f32_16x16x32_bf16 v[80:83], v[120:123], v[104:107], v[80:83]
    v_mfma_f32_16x16x32_bf16 v[84:87], v[120:123], v[108:111], v[84:87]
    v_mfma_f32_16x16x32_bf16 v[88:91], v[124:127], v[104:107], v[88:91]
    v_mfma_f32_16x16x32_bf16 v[92:95], v[124:127], v[108:111], v[92:95]
    s_waitcnt vmcnt(4)
    ds_write_b128 v147, v[168:171] offset:0
    ds_write_b128 v147, v[172:175] offset:4096
    ds_write_b128 v146, v[160:163] offset:0
    ds_write_b128 v146, v[164:167] offset:4096
    s_waitcnt lgkmcnt(0)
    s_barrier
    ds_read_b128 v[96:99], v156 offset:0
    ds_read_b128 v[100:103], v156 offset:2048
    ds_read_b64_tr_b16 v[112:113], v150 offset:0
    ds_read_b64_tr_b16 v[114:115], v150 offset:512
    ds_read_b64_tr_b16 v[116:117], v151 offset:0
    ds_read_b64_tr_b16 v[118:119], v151 offset:512
    ds_read_b128 v[104:107], v157 offset:0
    ds_read_b128 v[108:111], v157 offset:2048
    ds_read_b64_tr_b16 v[120:121], v150 offset:4096
    ds_read_b64_tr_b16 v[122:123], v150 offset:4608
    ds_read_b64_tr_b16 v[124:125], v151 offset:4096
    ds_read_b64_tr_b16 v[126:127], v151 offset:4608
    s_waitcnt lgkmcnt(6)
    v_mfma_f32_16x16x32_bf16 v[80:83], v[112:115], v[96:99], v[80:83]
    v_mfma_f32_16x16x32_bf16 v[84:87], v[112:115], v[100:103], v[84:87]
    v_mfma_f32_16x16x32_bf16 v[88:91], v[116:119], v[96:99], v[88:91]
    v_mfma_f32_16x16x32_bf16 v[92:95], v[116:119], v[100:103], v[92:95]
    s_waitcnt lgkmcnt(0)
    v_mfma_f32_16x16x32_bf16 v[80:83], v[120:123], v[104:107], v[80:83]
    v_mfma_f32_16x16x32_bf16 v[84:87], v[120:123], v[108:111], v[84:87]
    v_mfma_f32_16x16x32_bf16 v[88:91], v[124:127], v[104:107], v[88:91]
    v_mfma_f32_16x16x32_bf16 v[92:95], v[124:127], v[108:111], v[92:95]
    s_waitcnt vmcnt(0)
    ds_write_b128 v147, v[184:187] offset:8192
    ds_write_b128 v147, v[188:191] offset:12288
    ds_write_b128 v146, v[176:179] offset:8192
    ds_write_b128 v146, v[180:183] offset:12288
    s_waitcnt lgkmcnt(0)
    s_barrier
    ds_read_b128 v[96:99], v156 offset:8192
    ds_read_b128 v[100:103], v156 offset:10240
    ds_read_b64_tr_b16 v[112:113], v150 offset:8192
    ds_read_b64_tr_b16 v[114:115], v150 offset:8704
    ds_read_b64_tr_b16 v[116:117], v151 offset:8192
    ds_read_b64_tr_b16 v[118:119], v151 offset:8704
    ds_read_b128 v[104:107], v157 offset:8192
    ds_read_b128 v[108:111], v157 offset:10240
    ds_read_b64_tr_b16 v[120:121], v150 offset:12288
    ds_read_b64_tr_b16 v[122:123], v150 offset:12800
    ds_read_b64_tr_b16 v[124:125], v151 offset:12288
    ds_read_b64_tr_b16 v[126:127], v151 offset:12800
    s_waitcnt lgkmcnt(6)
    v_mfma_f32_16x16x32_bf16 v[80:83], v[112:115], v[96:99], v[80:83]
    v_mfma_f32_16x16x32_bf16 v[84:87], v[112:115], v[100:103], v[84:87]
    v_mfma_f32_16x16x32_bf16 v[88:91], v[116:119], v[96:99], v[88:91]
    v_mfma_f32_16x16x32_bf16 v[92:95], v[116:119], v[100:103], v[92:95]
    s_waitcnt lgkmcnt(0)
    v_mfma_f32_16x16x32_bf16 v[80:83], v[120:123], v[104:107], v[80:83]
    v_mfma_f32_16x16x32_bf16 v[84:87], v[120:123], v[108:111], v[84:87]
    v_mfma_f32_16x16x32_bf16 v[88:91], v[124:127], v[104:107], v[88:91]
    v_mfma_f32_16x16x32_bf16 v[92:95], v[124:127], v[108:111], v[92:95]
    s_nop 7
    s_nop 7
    v_lshrrev_b32 v5, 1, v2
    v_lshlrev_b32 v5, 5, v5
    v_add_u32 v5, v5, v3
    s_lshl_b32 s38, s36, 6
    v_add_u32 v5, s38, v5
    v_lshlrev_b32 v5, 10, v5
    v_and_b32 v6, 1, v2
    v_lshlrev_b32 v6, 6, v6
    v_lshlrev_b32 v7, 3, v4
    v_add3_u32 v5, v5, v6, v7
    s_lshl_b32 s38, s37, 7
    v_add_u32 v5, s38, v5
    buffer_load_dwordx2 v[8:9], v5, s[28:31], 0 offen offset:0
    buffer_load_dwordx2 v[10:11], v5, s[28:31], 0 offen offset:32
    v_add_u32 v6, 16384, v5
    buffer_load_dwordx2 v[12:13], v6, s[28:31], 0 offen offset:0
    buffer_load_dwordx2 v[14:15], v6, s[28:31], 0 offen offset:32
    s_waitcnt vmcnt(0)
    v_cvt_pk_bf16_f32 v20, v64, v65
    v_lshlrev_b32 v64, 16, v20
    v_and_b32 v65, 0xffff0000, v20
    v_cvt_pk_bf16_f32 v20, v66, v67
    v_lshlrev_b32 v66, 16, v20
    v_and_b32 v67, 0xffff0000, v20
    v_cvt_pk_bf16_f32 v20, v80, v81
    v_lshlrev_b32 v80, 16, v20
    v_and_b32 v81, 0xffff0000, v20
    v_cvt_pk_bf16_f32 v20, v82, v83
    v_lshlrev_b32 v82, 16, v20
    v_and_b32 v83, 0xffff0000, v20
    v_lshlrev_b32 v20, 16, v8
    v_and_b32 v21, 0xffff0000, v8
    v_lshlrev_b32 v22, 16, v9
    v_and_b32 v23, 0xffff0000, v9
    v_add_f32 v20, v20, v64
    v_add_f32 v21, v21, v65
    v_add_f32 v22, v22, v66
    v_add_f32 v23, v23, v67
    v_cvt_pk_bf16_f32 v24, v20, v21
    v_lshlrev_b32 v20, 16, v24
    v_and_b32 v21, 0xffff0000, v24
    v_cvt_pk_bf16_f32 v24, v22, v23
    v_lshlrev_b32 v22, 16, v24
    v_and_b32 v23, 0xffff0000, v24
    v_add_f32 v20, v20, v80
    v_add_f32 v21, v21, v81
    v_add_f32 v22, v22, v82
    v_add_f32 v23, v23, v83
    v_cvt_pk_bf16_f32 v24, v20, v21
    v_cvt_pk_bf16_f32 v25, v22, v23
    buffer_store_dwordx2 v[24:25], v5, s[32:35], 0 offen offset:0
    s_nop 1
    v_cvt_pk_bf16_f32 v20, v72, v73
    v_lshlrev_b32 v72, 16, v20
    v_and_b32 v73, 0xffff0000, v20
    v_cvt_pk_bf16_f32 v20, v74, v75
    v_lshlrev_b32 v74, 16, v20
    v_and_b32 v75, 0xffff0000, v20
    v_cvt_pk_bf16_f32 v20, v88, v89
    v_lshlrev_b32 v88, 16, v20
    v_and_b32 v89, 0xffff0000, v20
    v_cvt_pk_bf16_f32 v20, v90, v91
    v_lshlrev_b32 v90, 16, v20
    v_and_b32 v91, 0xffff0000, v20
    v_lshlrev_b32 v20, 16, v10
    v_and_b32 v21, 0xffff0000, v10
    v_lshlrev_b32 v22, 16, v11
    v_and_b32 v23, 0xffff0000, v11
    v_add_f32 v20, v20, v72
    v_add_f32 v21, v21, v73
    v_add_f32 v22, v22, v74
    v_add_f32 v23, v23, v75
    v_cvt_pk_bf16_f32 v24, v20, v21
    v_lshlrev_b32 v20, 16, v24
    v_and_b32 v21, 0xffff0000, v24
    v_cvt_pk_bf16_f32 v24, v22, v23
    v_lshlrev_b32 v22, 16, v24
    v_and_b32 v23, 0xffff0000, v24
    v_add_f32 v20, v20, v88
    v_add_f32 v21, v21, v89
    v_add_f32 v22, v22, v90
    v_add_f32 v23, v23, v91
    v_cvt_pk_bf16_f32 v24, v20, v21
    v_cvt_pk_bf16_f32 v25, v22, v23
    buffer_store_dwordx2 v[24:25], v5, s[32:35], 0 offen offset:32
    s_nop 1
    v_cvt_pk_bf16_f32 v20, v68, v69
    v_lshlrev_b32 v68, 16, v20
    v_and_b32 v69, 0xffff0000, v20
    v_cvt_pk_bf16_f32 v20, v70, v71
    v_lshlrev_b32 v70, 16, v20
    v_and_b32 v71, 0xffff0000, v20
    v_cvt_pk_bf16_f32 v20, v84, v85
    v_lshlrev_b32 v84, 16, v20
    v_and_b32 v85, 0xffff0000, v20
    v_cvt_pk_bf16_f32 v20, v86, v87
    v_lshlrev_b32 v86, 16, v20
    v_and_b32 v87, 0xffff0000, v20
    v_lshlrev_b32 v20, 16, v12
    v_and_b32 v21, 0xffff0000, v12
    v_lshlrev_b32 v22, 16, v13
    v_and_b32 v23, 0xffff0000, v13
    v_add_f32 v20, v20, v68
    v_add_f32 v21, v21, v69
    v_add_f32 v22, v22, v70
    v_add_f32 v23, v23, v71
    v_cvt_pk_bf16_f32 v24, v20, v21
    v_lshlrev_b32 v20, 16, v24
    v_and_b32 v21, 0xffff0000, v24
    v_cvt_pk_bf16_f32 v24, v22, v23
    v_lshlrev_b32 v22, 16, v24
    v_and_b32 v23, 0xffff0000, v24
    v_add_f32 v20, v20, v84
    v_add_f32 v21, v21, v85
    v_add_f32 v22, v22, v86
    v_add_f32 v23, v23, v87
    v_cvt_pk_bf16_f32 v24, v20, v21
    v_cvt_pk_bf16_f32 v25, v22, v23
    buffer_store_dwordx2 v[24:25], v6, s[32:35], 0 offen offset:0
    s_nop 1
    v_cvt_pk_bf16_f32 v20, v76, v77
    v_lshlrev_b32 v76, 16, v20
    v_and_b32 v77, 0xffff0000, v20
    v_cvt_pk_bf16_f32 v20, v78, v79
    v_lshlrev_b32 v78, 16, v20
    v_and_b32 v79, 0xffff0000, v20
    v_cvt_pk_bf16_f32 v20, v92, v93
    v_lshlrev_b32 v92, 16, v20
    v_and_b32 v93, 0xffff0000, v20
    v_cvt_pk_bf16_f32 v20, v94, v95
    v_lshlrev_b32 v94, 16, v20
    v_and_b32 v95, 0xffff0000, v20
    v_lshlrev_b32 v20, 16, v14
    v_and_b32 v21, 0xffff0000, v14
    v_lshlrev_b32 v22, 16, v15
    v_and_b32 v23, 0xffff0000, v15
    v_add_f32 v20, v20, v76
    v_add_f32 v21, v21, v77
    v_add_f32 v22, v22, v78
    v_add_f32 v23, v23, v79
    v_cvt_pk_bf16_f32 v24, v20, v21
    v_lshlrev_b32 v20, 16, v24
    v_and_b32 v21, 0xffff0000, v24
    v_cvt_pk_bf16_f32 v24, v22, v23
    v_lshlrev_b32 v22, 16, v24
    v_and_b32 v23, 0xffff0000, v24
    v_add_f32 v20, v20, v92
    v_add_f32 v21, v21, v93
    v_add_f32 v22, v22, v94
    v_add_f32 v23, v23, v95
    v_cvt_pk_bf16_f32 v24, v20, v21
    v_cvt_pk_bf16_f32 v25, v22, v23
    buffer_store_dwordx2 v[24:25], v6, s[32:35], 0 offen offset:32
    s_nop 1
    s_waitcnt vmcnt(0)
K2_END:
    s_endpgm
.section .rodata,"a"
.p2align 6
.amdhsa_kernel ln_kernel
  .amdhsa_next_free_vgpr 64
  .amdhsa_next_free_sgpr 102
  .amdhsa_accum_offset 64
  .amdhsa_group_segment_fixed_size 0
  .amdhsa_kernarg_size 88
  .amdhsa_user_sgpr_count 2
  .amdhsa_user_sgpr_kernarg_segment_ptr 1
  .amdhsa_system_sgpr_workgroup_id_x 1
.end_amdhsa_kernel
.p2align 6
.amdhsa_kernel gemm1_kernel
  .amdhsa_next_free_vgpr 244
  .amdhsa_next_free_sgpr 102
  .amdhsa_accum_offset 244
  .amdhsa_group_segment_fixed_size 0
  .amdhsa_kernarg_size 88
  .amdhsa_user_sgpr_count 2
  .amdhsa_user_sgpr_kernarg_segment_ptr 1
  .amdhsa_system_sgpr_workgroup_id_x 1
.end_amdhsa_kernel
.p2align 6
.amdhsa_kernel gemm2_kernel
  .amdhsa_next_free_vgpr 224
  .amdhsa_next_free_sgpr 102
  .amdhsa_accum_offset 224
  .amdhsa_group_segment_fixed_size 0
  .amdhsa_kernarg_size 88
  .amdhsa_user_sgpr_count 2
  .amdhsa_user_sgpr_kernarg_segment_ptr 1
  .amdhsa_system_sgpr_workgroup_id_x 1
.end_amdhsa_kernel
```
